```python
import torch

def _softmax(x, axis=-1):
    return torch.softmax(x, dim=axis)
def _gelu(x):
    return torch.nn.functional.gelu(x, approximate="tanh")
def _silu(x):
    return torch.nn.functional.silu(x)
def _sigmoid(x):
    return torch.sigmoid(x)
def _layernorm(x, axis=-1, eps=1e-5):
    m = x.mean(dim=axis, keepdim=True)
    v = x.var(dim=axis, keepdim=True, unbiased=False)
    return (x - m) / torch.sqrt(v + eps)
def _scatter_add(tgt, idx, src, axis=0):
    return tgt.clone().index_add_(axis, idx, src)
def _segment_sum(src, seg, n):
    out = torch.zeros((n,) + src.shape[1:], dtype=src.dtype)
    return out.index_add_(0, seg, src)
def _pad(x, pw):
    flat = tuple(v for pair in reversed(pw) for v in pair)
    return torch.nn.functional.pad(x, flat)

kernel_name = 'interleave_layers__linear_attn_block__grouped_kv_mqa__prompt'

def setup_inputs():

    _w = (lambda a: (lambda t: t.to(torch.bfloat16) if t.is_floating_point() else t)(torch.as_tensor(a)))
    def _A_setup():
        B, S, D = 1, 2048, 512
        return {
            "x": _w((lambda *s: torch.randn(*s, dtype=torch.bfloat16) * 0.05)(B, S, D)),
            "wqkv": _w((lambda *s: torch.randn(*s, dtype=torch.bfloat16) * 0.05)(D, 3 * D)),
            "wo": _w((lambda *s: torch.randn(*s, dtype=torch.bfloat16) * 0.05)(D, D)),
        }
    _A_in = _A_setup()

    def _B_setup():
        B, S, D, H = 1, 2048, 512, 32
        Dh = D // H
        return {
            "x": _w((lambda *s: torch.randn(*s, dtype=torch.bfloat16) * 0.05)(B, S, D)),
            "wq": _w((lambda *s: torch.randn(*s, dtype=torch.bfloat16) * 0.1)(D, H * Dh)),
            "wk": _w((lambda *s: torch.randn(*s, dtype=torch.bfloat16) * 0.1)(D, Dh)),
            "wv": _w((lambda *s: torch.randn(*s, dtype=torch.bfloat16) * 0.05)(D, Dh)),
            "wo": _w((lambda *s: torch.randn(*s, dtype=torch.bfloat16) * 0.05)(H * Dh, D)),
        }
    _B_in = _B_setup()

    return {
        "A_x": _A_in["x"],
        "A_wqkv": _A_in["wqkv"],
        "A_wo": _A_in["wo"],
        "B_x": _B_in["x"],
        "B_wq": _B_in["wq"],
        "B_wk": _B_in["wk"],
        "B_wv": _B_in["wv"],
        "B_wo": _B_in["wo"],
    }

def reference(A_x, A_wqkv, A_wo, B_x, B_wq, B_wk, B_wv, B_wo):
    def _A_ref(x, wqkv, wo):
        B, S, D = x.shape
        H = 32; Dh = D // H
        qkv = (lambda x, *d: x.permute(*d))((x @ wqkv).reshape(B, S, 3, H, Dh), 2, 0, 3, 1, 4)
        q, k, v = qkv[0], qkv[1], qkv[2]
        phi = lambda t: torch.where(t > 0, t + 1, torch.exp(t)) + 1e-6
        pq, pk = phi(q), phi(k)
        kv = torch.einsum("bhsd,bhse->bhde", pk, v)
        z = torch.einsum("bhsd->bhd", pk)
        num = torch.einsum("bhqd,bhde->bhqe", pq, kv)
        den = torch.einsum("bhqd,bhd->bhq", pq, z)[..., None] + 1e-6
        o = num / den
        return (lambda x, *d: x.permute(*d))(o, 0, 2, 1, 3).reshape(B, S, D) @ wo

    def _B_ref(x, wq, wk, wv, wo):
        B, S, D = x.shape
        H = 32
        Dh = D // H
        q = (lambda x, *d: x.permute(*d))((x @ wq).reshape(B, S, H, Dh), 0, 2, 1, 3)
        k = x @ wk
        v = x @ wv
        scores = torch.einsum("bhqd,bkd->bhqk", q, k) * (Dh ** -0.5)
        p = _softmax(scores, axis=-1)
        o = torch.einsum("bhqk,bkd->bhqd", p, v)
        return (lambda x, *d: x.permute(*d))(o, 0, 2, 1, 3).reshape(B, S, H * Dh) @ wo

    x = A_x
    x = x + _A_ref(_layernorm(x, axis=-1), A_wqkv, A_wo)
    x = x + _B_ref(_layernorm(x, axis=-1), B_wq, B_wk, B_wv, B_wo)
    x = x + _A_ref(_layernorm(x, axis=-1), A_wqkv, A_wo)
    x = x + _B_ref(_layernorm(x, axis=-1), B_wq, B_wk, B_wv, B_wo)
    return x
```

```asm
; @launch grid=(256,1,1) block=(512,1,1) lds=163840
.amdgcn_target "amdgcn-amd-amdhsa--gfx950"
.text
.globl interleave_layers__linear_attn_block__grouped_kv_mqa__prompt_kernel
.p2align 8
.type interleave_layers__linear_attn_block__grouped_kv_mqa__prompt_kernel,@function
interleave_layers__linear_attn_block__grouped_kv_mqa__prompt_kernel:
    s_cmp_ge_u32 s2, 256
    s_cbranch_scc1 L_end
    s_load_dwordx16 s[40:55], s[0:1], 0
    s_load_dwordx4 s[56:59], s[0:1], 64
    s_load_dwordx2 s[60:61], s[0:1], 80
    s_and_b32 s75, s2, 7
    s_lshl_b32 s16, s75, 2
    s_lshr_b32 s24, s2, 6
    s_add_u32 s16, s16, s24
    s_bfe_u32 s17, s2, 0x30003
    v_lshrrev_b32 v5, 6, v0
    v_and_b32 v1, 63, v0
    s_nop 0
    v_readfirstlane_b32 s18, v5
    v_lshlrev_b32 v2, 4, v1
    s_nop 3
    s_and_b32 s19, s18, 1
    s_bfe_u32 s20, s18, 0x10001
    s_lshr_b32 s21, s18, 2
    s_lshl_b32 s24, s16, 1
    s_add_u32 s24, s24, s19
    s_lshl_b32 s24, s24, 5
    s_lshl_b32 s25, s17, 2
    s_add_u32 s24, s24, s25
    s_lshl_b32 s25, s20, 1
    s_add_u32 s24, s24, s25
    s_add_u32 s24, s24, s21
    s_lshl_b32 s22, s24, 10
    s_lshl_b32 s25, s19, 14
    s_mul_i32 s24, s19, 49152
    v_add_u32 v4, s24, v2
    v_xor_b32 v3, 32768, v4
    s_lshl_b32 s24, s17, 1
    s_add_u32 s24, s24, s20
    s_lshl_b32 s80, s24, 6
    s_lshl_b32 s81, s16, 16
    v_mov_b32 v0, 0x3f803f80
    s_mov_b32 s30, 0x0000ffff
    s_mov_b32 s31, 0x0000ffff
    s_and_b32 s34, s17, 1
    s_lshr_b32 s35, s17, 1
    s_mov_b32 s23, 0
    s_mov_b32 s38, 0
    s_mov_b32 s39, 0
    s_mov_b32 s62, 0
    s_mov_b32 s73, 0x0
    s_mov_b32 s74, 0x780000
    s_lshl_b32 s24, s16, 9
    s_add_u32 s24, s24, 0xb00000
    v_lshlrev_b32 v5, 3, v1
    v_add_u32 v98, s24, v5
    s_lshl_b32 s25, s17, 6
    s_add_u32 s24, s24, s25
    s_lshl_b32 s25, s18, 3
    s_add_u32 s24, s24, s25
    v_mov_b32 v96, s24
    s_getreg_b32 s91, hwreg(HW_REG_XCC_ID)
    s_and_b32 s91, s91, 15
    s_lshl_b32 s24, s16, 6
    s_lshl_b32 s25, s17, 3
    s_add_u32 s24, s24, s25
    s_add_u32 s24, s24, 0xb04000
    v_mov_b32 v97, s24
    s_mov_b32 s72, 0
    v_mov_b32 v99, 0
    s_waitcnt lgkmcnt(0)
    s_mov_b32 s4, s60
    s_mov_b32 s5, s61
    s_mov_b32 s6, 0x10000000
    s_mov_b32 s7, 0x00020000
    s_mov_b32 s76, s58
    s_mov_b32 s77, s59
    s_mov_b32 s78, 0x100
    s_mov_b32 s79, 0x00020000
    s_mov_b32 s12, s40
    s_mov_b32 s13, s41
    s_mov_b32 s14, 0x200000
    s_mov_b32 s15, 0x00020000
    s_mov_b32 s8, s42
    s_mov_b32 s9, s43
    s_mov_b32 s10, 0x180000
    s_mov_b32 s11, 0x00020000
    s_cmp_lg_u32 s2, 0
    s_cbranch_scc1 np_1
    s_cmp_lg_u32 s18, 0
    s_cbranch_scc1 np_1
    s_memrealtime s[64:65]
    s_waitcnt lgkmcnt(0)
    s_lshl_b64 s[64:65], s[64:65], 12
    s_or_b32 s65, s65, 0x80000000
    v_mov_b32 v6, s64
    v_mov_b32 v7, s65
    v_mov_b32 v5, 0
    s_mov_b64 exec, 1
    buffer_store_dwordx2 v[6:7], v5, s[76:79], 0 offen sc1
    s_mov_b64 exec, -1
np_1:
    v_lshrrev_b32 v5, 3, v1
    v_and_b32 v6, 7, v1
    v_lshrrev_b32 v7, 4, v1
    v_xor_b32 v8, v6, v7
    v_lshlrev_b32 v8, 4, v8
    v_lshl_add_u32 v116, v5, 10, v8
    v_xor_b32 v117, 64, v116
    v_lshrrev_b32 v5, 2, v1
    v_mul_u32_u24 v5, 3072, v5
    v_and_b32 v6, 3, v1
    v_lshl_add_u32 v118, v6, 4, v5
    s_lshl_b32 s24, s21, 15
    s_lshl_b32 s25, s19, 14
    s_add_u32 s85, s81, s24
    s_add_u32 s85, s85, s25
    s_lshl_b32 s25, s20, 9
    s_add_u32 s85, s85, s25
    s_lshl_b32 s25, s20, 14
    s_add_u32 s87, s24, s25
    s_lshl_b32 s25, s19, 11
    s_add_u32 s87, s87, s25
    s_mul_i32 s88, s19, 786432
    s_lshl_b32 s24, s17, 7
    s_add_u32 s88, s88, s24
    s_lshl_b32 s24, s20, 6
    s_add_u32 s88, s88, s24
    s_lshl_b32 s94, s21, 10
    s_add_u32 s94, s94, s88
    s_add_u32 s94, s94, 1024
    s_and_b32 s26, s18, 3
    s_mul_i32 s89, s26, 11264
    s_add_u32 s89, s89, 65536
    s_add_u32 s90, s89, 3072
    s_mul_i32 s24, s26, 3072
    s_add_u32 s24, s24, 110592
    s_lshl_b32 s25, s26, 13
    s_add_u32 s25, s25, 131072
    s_cmp_eq_u32 s21, 1
    s_cselect_b32 s89, s24, s89
    s_cselect_b32 s90, s25, s90
    s_add_u32 s3, s16, s75
    s_and_b32 s3, s3, 3
    s_add_u32 s25, s3, 0
    s_and_b32 s25, s25, 3
    s_lshl_b32 s25, s25, 7
    s_add_u32 s25, s25, s85
    s_add_u32 s24, s25, 0
    s_add_u32 m0, s87, 0
    s_nop 0
    buffer_load_dwordx4 v116, s[12:15], s24 offen lds
    s_add_u32 s24, s25, 8192
    s_add_u32 m0, s87, 1024
    s_nop 0
    buffer_load_dwordx4 v117, s[12:15], s24 offen lds
    s_add_u32 s25, s3, 1
    s_and_b32 s25, s25, 3
    s_lshl_b32 s25, s25, 7
    s_add_u32 s25, s25, s85
    s_add_u32 s24, s25, 0
    s_add_u32 m0, s87, 4096
    s_nop 0
    buffer_load_dwordx4 v116, s[12:15], s24 offen lds
    s_add_u32 s24, s25, 8192
    s_add_u32 m0, s87, 5120
    s_nop 0
    buffer_load_dwordx4 v117, s[12:15], s24 offen lds
    s_add_u32 s25, s3, 2
    s_and_b32 s25, s25, 3
    s_lshl_b32 s25, s25, 7
    s_add_u32 s25, s25, s85
    s_add_u32 s24, s25, 0
    s_add_u32 m0, s87, 8192
    s_nop 0
    buffer_load_dwordx4 v116, s[12:15], s24 offen lds
    s_add_u32 s24, s25, 8192
    s_add_u32 m0, s87, 9216
    s_nop 0
    buffer_load_dwordx4 v117, s[12:15], s24 offen lds
    s_add_u32 s25, s3, 3
    s_and_b32 s25, s25, 3
    s_lshl_b32 s25, s25, 7
    s_add_u32 s25, s25, s85
    s_add_u32 s24, s25, 0
    s_add_u32 m0, s87, 12288
    s_nop 0
    buffer_load_dwordx4 v116, s[12:15], s24 offen lds
    s_add_u32 s24, s25, 8192
    s_add_u32 m0, s87, 13312
    s_nop 0
    buffer_load_dwordx4 v117, s[12:15], s24 offen lds
    s_add_u32 s25, s3, 0
    s_and_b32 s25, s25, 3
    s_mul_i32 s25, s25, 196608
    s_add_u32 s25, s25, s94
    s_add_u32 s24, s25, 0
    s_add_u32 m0, s89, 0
    s_nop 0
    buffer_load_dwordx4 v118, s[8:11], s24 offen lds
    s_add_u32 s25, s3, 0
    s_and_b32 s25, s25, 3
    s_mul_i32 s25, s25, 196608
    s_add_u32 s25, s25, s94
    s_add_u32 s24, s25, 49152
    s_add_u32 m0, s89, 1024
    s_nop 0
    buffer_load_dwordx4 v118, s[8:11], s24 offen lds
    s_add_u32 s25, s3, 0
    s_and_b32 s25, s25, 3
    s_mul_i32 s25, s25, 196608
    s_add_u32 s25, s25, s94
    s_add_u32 s24, s25, 98304
    s_add_u32 m0, s89, 2048
    s_nop 0
    buffer_load_dwordx4 v118, s[8:11], s24 offen lds
    s_getpc_b64 s[64:65]
L_pcref:
    s_lshr_b32 s24, s2, 3
    s_lshl_b32 s24, s24, 3
    s_add_u32 s24, s24, s18
    s_lshl_b32 s24, s24, 8
    s_min_u32 s24, s24, L_end - L_pcref - 256
    v_lshlrev_b32 v5, 2, v1
    v_add_u32 v5, s24, v5
    global_load_dword v127, v5, s[64:65]
    s_add_u32 s25, s3, 0
    s_and_b32 s25, s25, 3
    s_mul_i32 s25, s25, 196608
    s_add_u32 s25, s25, s94
    s_add_u32 s24, s25, 147456
    s_add_u32 m0, s90, 0
    s_nop 0
    buffer_load_dwordx4 v118, s[8:11], s24 offen lds
    s_add_u32 s25, s3, 1
    s_and_b32 s25, s25, 3
    s_mul_i32 s25, s25, 196608
    s_add_u32 s25, s25, s94
    s_add_u32 s24, s25, 0
    s_add_u32 m0, s90, 1024
    s_nop 0
    buffer_load_dwordx4 v118, s[8:11], s24 offen lds
    s_add_u32 s25, s3, 1
    s_and_b32 s25, s25, 3
    s_mul_i32 s25, s25, 196608
    s_add_u32 s25, s25, s94
    s_add_u32 s24, s25, 49152
    s_add_u32 m0, s90, 2048
    s_nop 0
    buffer_load_dwordx4 v118, s[8:11], s24 offen lds
    v_and_b32 v5, 31, v1
    v_bfe_u32 v6, v1, 1, 3
    v_lshrrev_b32 v7, 5, v1
    v_xor_b32 v6, v6, v7
    s_mul_i32 s24, s19, 49152
    v_lshlrev_b32 v5, 7, v5
    v_add_u32 v5, s24, v5
    v_xor_b32 v7, 0, v6
    v_lshl_add_u32 v120, v7, 4, v5
    v_xor_b32 v112, 32768, v120
    v_xor_b32 v7, 2, v6
    v_lshl_add_u32 v121, v7, 4, v5
    v_xor_b32 v113, 32768, v121
    v_xor_b32 v7, 4, v6
    v_lshl_add_u32 v122, v7, 4, v5
    v_xor_b32 v114, 32768, v122
    v_xor_b32 v7, 6, v6
    v_lshl_add_u32 v123, v7, 4, v5
    v_xor_b32 v115, 32768, v123
    v_lshrrev_b32 v5, 5, v1
    v_lshlrev_b32 v5, 9, v5
    v_bfe_u32 v6, v1, 2, 2
    v_lshl_add_u32 v5, v6, 6, v5
    v_bfe_u32 v6, v1, 4, 1
    v_lshl_add_u32 v5, v6, 5, v5
    v_and_b32 v6, 3, v1
    v_lshl_add_u32 v5, v6, 3, v5
    v_add_u32 v124, s89, v5
    v_add_u32 v125, s90, v5
    v_mov_b32 v126, 0
    v_mov_b32 v127, 0
    s_lshl_b32 s95, s21, 1
    s_add_u32 s95, s95, s20
    s_waitcnt vmcnt(7)
    v_add_u32 v5, s87, v2
    ds_read_b128 v[128:131], v5 offset:0
    ds_read_b128 v[132:135], v5 offset:1024
    ds_read_b128 v[136:139], v5 offset:4096
    ds_read_b128 v[140:143], v5 offset:5120
    ds_read_b128 v[144:147], v5 offset:8192
    ds_read_b128 v[148:151], v5 offset:9216
    ds_read_b128 v[152:155], v5 offset:12288
    ds_read_b128 v[156:159], v5 offset:13312
    v_mov_b32 v40, 0
    v_mov_b32 v41, 0
    v_mov_b32 v42, 0
    v_mov_b32 v43, 0
    s_waitcnt lgkmcnt(0)
    v_dot2_f32_bf16 v40, v128, v0, v40
    v_dot2_f32_bf16 v41, v128, v128, v41
    v_dot2_f32_bf16 v40, v129, v0, v40
    v_dot2_f32_bf16 v41, v129, v129, v41
    v_dot2_f32_bf16 v40, v130, v0, v40
    v_dot2_f32_bf16 v41, v130, v130, v41
    v_dot2_f32_bf16 v40, v131, v0, v40
    v_dot2_f32_bf16 v41, v131, v131, v41
    v_dot2_f32_bf16 v42, v132, v0, v42
    v_dot2_f32_bf16 v43, v132, v132, v43
    v_dot2_f32_bf16 v42, v133, v0, v42
    v_dot2_f32_bf16 v43, v133, v133, v43
    v_dot2_f32_bf16 v42, v134, v0, v42
    v_dot2_f32_bf16 v43, v134, v134, v43
    v_dot2_f32_bf16 v42, v135, v0, v42
    v_dot2_f32_bf16 v43, v135, v135, v43
    v_dot2_f32_bf16 v40, v136, v0, v40
    v_dot2_f32_bf16 v41, v136, v136, v41
    v_dot2_f32_bf16 v40, v137, v0, v40
    v_dot2_f32_bf16 v41, v137, v137, v41
    v_dot2_f32_bf16 v40, v138, v0, v40
    v_dot2_f32_bf16 v41, v138, v138, v41
    v_dot2_f32_bf16 v40, v139, v0, v40
    v_dot2_f32_bf16 v41, v139, v139, v41
    v_dot2_f32_bf16 v42, v140, v0, v42
    v_dot2_f32_bf16 v43, v140, v140, v43
    v_dot2_f32_bf16 v42, v141, v0, v42
    v_dot2_f32_bf16 v43, v141, v141, v43
    v_dot2_f32_bf16 v42, v142, v0, v42
    v_dot2_f32_bf16 v43, v142, v142, v43
    v_dot2_f32_bf16 v42, v143, v0, v42
    v_dot2_f32_bf16 v43, v143, v143, v43
    v_dot2_f32_bf16 v40, v144, v0, v40
    v_dot2_f32_bf16 v41, v144, v144, v41
    v_dot2_f32_bf16 v40, v145, v0, v40
    v_dot2_f32_bf16 v41, v145, v145, v41
    v_dot2_f32_bf16 v40, v146, v0, v40
    v_dot2_f32_bf16 v41, v146, v146, v41
    v_dot2_f32_bf16 v40, v147, v0, v40
    v_dot2_f32_bf16 v41, v147, v147, v41
    v_dot2_f32_bf16 v42, v148, v0, v42
    v_dot2_f32_bf16 v43, v148, v148, v43
    v_dot2_f32_bf16 v42, v149, v0, v42
    v_dot2_f32_bf16 v43, v149, v149, v43
    v_dot2_f32_bf16 v42, v150, v0, v42
    v_dot2_f32_bf16 v43, v150, v150, v43
    v_dot2_f32_bf16 v42, v151, v0, v42
    v_dot2_f32_bf16 v43, v151, v151, v43
    v_dot2_f32_bf16 v40, v152, v0, v40
    v_dot2_f32_bf16 v41, v152, v152, v41
    v_dot2_f32_bf16 v40, v153, v0, v40
    v_dot2_f32_bf16 v41, v153, v153, v41
    v_dot2_f32_bf16 v40, v154, v0, v40
    v_dot2_f32_bf16 v41, v154, v154, v41
    v_dot2_f32_bf16 v40, v155, v0, v40
    v_dot2_f32_bf16 v41, v155, v155, v41
    v_dot2_f32_bf16 v42, v156, v0, v42
    v_dot2_f32_bf16 v43, v156, v156, v43
    v_dot2_f32_bf16 v42, v157, v0, v42
    v_dot2_f32_bf16 v43, v157, v157, v43
    v_dot2_f32_bf16 v42, v158, v0, v42
    v_dot2_f32_bf16 v43, v158, v158, v43
    v_dot2_f32_bf16 v42, v159, v0, v42
    v_dot2_f32_bf16 v43, v159, v159, v43
    v_lshrrev_b32 v5, 3, v1
    v_lshlrev_b32 v5, 3, v5
    s_lshl_b32 s24, s21, 8
    s_lshl_b32 s25, s19, 7
    s_add_u32 s24, s24, s25
    s_lshl_b32 s25, s20, 9
    s_add_u32 s24, s24, s25
    s_add_u32 s24, s24, 122880
    v_add_u32 v5, s24, v5
    s_nop 1
    v_add_f32_dpp v40, v40, v40 quad_perm:[1,0,3,2] row_mask:0xf bank_mask:0xf
    v_add_f32_dpp v41, v41, v41 quad_perm:[1,0,3,2] row_mask:0xf bank_mask:0xf
    v_add_f32_dpp v42, v42, v42 quad_perm:[1,0,3,2] row_mask:0xf bank_mask:0xf
    v_add_f32_dpp v43, v43, v43 quad_perm:[1,0,3,2] row_mask:0xf bank_mask:0xf
    s_nop 1
    v_add_f32_dpp v40, v40, v40 quad_perm:[2,3,0,1] row_mask:0xf bank_mask:0xf
    v_add_f32_dpp v41, v41, v41 quad_perm:[2,3,0,1] row_mask:0xf bank_mask:0xf
    v_add_f32_dpp v42, v42, v42 quad_perm:[2,3,0,1] row_mask:0xf bank_mask:0xf
    v_add_f32_dpp v43, v43, v43 quad_perm:[2,3,0,1] row_mask:0xf bank_mask:0xf
    s_nop 1
    v_add_f32_dpp v40, v40, v40 row_half_mirror row_mask:0xf bank_mask:0xf
    v_add_f32_dpp v41, v41, v41 row_half_mirror row_mask:0xf bank_mask:0xf
    v_add_f32_dpp v42, v42, v42 row_half_mirror row_mask:0xf bank_mask:0xf
    v_add_f32_dpp v43, v43, v43 row_half_mirror row_mask:0xf bank_mask:0xf
    ds_write_b64 v5, v[40:41]
    ds_write_b64 v5, v[42:43] offset:64
    s_waitcnt lgkmcnt(0)
    s_barrier
    s_waitcnt vmcnt(6)
    ds_read_b64_tr_b16 v[200:201], v124 offset:0
    ds_read_b64_tr_b16 v[202:203], v124 offset:256
    ds_read_b128 v[192:195], v120 offset:0
    ds_read_b128 v[196:199], v112 offset:0
    v_lshlrev_b32 v5, 3, v1
    v_add_u32 v5, 122880, v5
    ds_read2st64_b64 v[80:83], v5 offset0:0 offset1:1
    s_add_u32 s25, s3, 1
    s_and_b32 s25, s25, 3
    s_mul_i32 s25, s25, 196608
    s_add_u32 s25, s25, s94
    s_add_u32 s24, s25, 98304
    s_add_u32 m0, s90, 3072
    s_nop 0
    buffer_load_dwordx4 v118, s[8:11], s24 offen lds
    s_add_u32 s25, s3, 1
    s_and_b32 s25, s25, 3
    s_mul_i32 s25, s25, 196608
    s_add_u32 s25, s25, s94
    s_add_u32 s24, s25, 147456
    s_add_u32 m0, s90, 4096
    s_nop 0
    buffer_load_dwordx4 v118, s[8:11], s24 offen lds
    s_add_u32 s25, s3, 2
    s_and_b32 s25, s25, 3
    s_mul_i32 s25, s25, 196608
    s_add_u32 s25, s25, s94
    s_add_u32 s24, s25, 0
    s_add_u32 m0, s90, 5120
    s_nop 0
    buffer_load_dwordx4 v118, s[8:11], s24 offen lds
    s_waitcnt vmcnt(8)
    ds_read_b64_tr_b16 v[212:213], v124 offset:1024
    ds_read_b64_tr_b16 v[214:215], v124 offset:1280
    ds_read_b128 v[204:207], v121 offset:0
    ds_read_b128 v[208:211], v113 offset:0
    s_waitcnt lgkmcnt(4)
    s_add_u32 s25, s3, 2
    s_and_b32 s25, s25, 3
    s_mul_i32 s25, s25, 196608
    s_add_u32 s25, s25, s94
    s_add_u32 s24, s25, 147456
    s_add_u32 m0, s89, 0
    s_nop 0
    buffer_load_dwordx4 v118, s[8:11], s24 offen lds
    v_mov_b32 v119, 0
    v_mfma_f32_32x32x16_bf16 v[40:55], v[200:203], v[192:195], 0
    v_mfma_f32_32x32x16_bf16 v[56:71], v[200:203], v[196:199], 0
    v_dot2_f32_bf16 v119, v200, v0, v119
    v_dot2_f32_bf16 v119, v201, v0, v119
    v_dot2_f32_bf16 v119, v202, v0, v119
    v_dot2_f32_bf16 v119, v203, v0, v119
    s_add_u32 s25, s3, 2
    s_and_b32 s25, s25, 3
    s_mul_i32 s25, s25, 196608
    s_add_u32 s25, s25, s94
    s_add_u32 s24, s25, 49152
    s_add_u32 m0, s90, 6144
    s_nop 0
    buffer_load_dwordx4 v118, s[8:11], s24 offen lds
    s_add_u32 s25, s3, 2
    s_and_b32 s25, s25, 3
    s_mul_i32 s25, s25, 196608
    s_add_u32 s25, s25, s94
    s_add_u32 s24, s25, 98304
    s_add_u32 m0, s90, 7168
    s_nop 0
    buffer_load_dwordx4 v118, s[8:11], s24 offen lds
    s_waitcnt vmcnt(10)
    ds_read_b64_tr_b16 v[224:225], v124 offset:2048
    ds_read_b64_tr_b16 v[226:227], v124 offset:2304
    ds_read_b128 v[216:219], v122 offset:0
    ds_read_b128 v[220:223], v114 offset:0
    s_waitcnt lgkmcnt(4)
    s_add_u32 s25, s3, 3
    s_and_b32 s25, s25, 3
    s_mul_i32 s25, s25, 196608
    s_add_u32 s25, s25, s94
    s_add_u32 s24, s25, 0
    s_add_u32 m0, s89, 1024
    s_nop 0
    buffer_load_dwordx4 v118, s[8:11], s24 offen lds
    v_mfma_f32_32x32x16_bf16 v[40:55], v[212:215], v[204:207], v[40:55]
    v_mfma_f32_32x32x16_bf16 v[56:71], v[212:215], v[208:211], v[56:71]
    v_dot2_f32_bf16 v119, v212, v0, v119
    v_dot2_f32_bf16 v119, v213, v0, v119
    v_dot2_f32_bf16 v119, v214, v0, v119
    v_dot2_f32_bf16 v119, v215, v0, v119
    v_pk_add_f32 v[10:11], v[80:81], v[82:83]
    v_mul_f32 v10, 0x3b000000, v10
    v_mul_f32 v11, 0x3b000000, v11
    v_fma_f32 v11, -v10, v10, v11
    v_max_f32 v11, 0, v11
    v_cvt_pk_bf16_f32 v11, v11, v11
    v_and_b32 v11, 0xffff0000, v11
    v_add_f32 v11, 0x3727c5ac, v11
    v_cvt_pk_bf16_f32 v11, v11, v11
    v_and_b32 v11, 0xffff0000, v11
    v_sqrt_f32 v11, v11
    s_nop 0
    v_cvt_pk_bf16_f32 v11, v11, v11
    v_and_b32 v11, 0xffff0000, v11
    v_rcp_f32 v11, v11
    v_cvt_pk_bf16_f32 v10, v10, v10
    v_and_b32 v10, 0xffff0000, v10
    v_mov_b32 v8, v10
    v_mov_b32 v9, v11
    s_cmp_eq_u32 s19, 1
    s_cselect_b64 s[26:27], -1, 0
    v_permlane32_swap_b32 v10, v8
    v_permlane32_swap_b32 v11, v9
    s_nop 1
    v_cndmask_b32_e64 v11, v11, v9, s[26:27]
    v_cndmask_b32_e64 v9, v10, v8, s[26:27]
    v_cndmask_b32_e64 v8, v8, v10, s[26:27]
    v_cvt_pk_bf16_f32 v72, -v9, -v9
    v_cvt_pk_bf16_f32 v73, -v9, -v9
    v_mov_b32 v74, 0
    v_mov_b32 v75, 0
    v_cvt_pk_bf16_f32 v76, -v8, -v8
    v_cvt_pk_bf16_f32 v77, -v8, -v8
    v_mov_b32 v78, 0
    v_mov_b32 v79, 0
    v_mov_b32 v14, 0
    v_mov_b32 v15, 0
    v_mov_b32 v16, 0
    v_mov_b32 v17, 0
    s_waitcnt vmcnt(9)
    ds_read_b64_tr_b16 v[236:237], v125 offset:0
    ds_read_b64_tr_b16 v[238:239], v125 offset:256
    ds_read_b128 v[228:231], v123 offset:0
    ds_read_b128 v[232:235], v115 offset:0
    s_waitcnt lgkmcnt(4)
    s_add_u32 s25, s3, 3
    s_and_b32 s25, s25, 3
    s_mul_i32 s25, s25, 196608
    s_add_u32 s25, s25, s94
    s_add_u32 s24, s25, 49152
    s_add_u32 m0, s89, 2048
    s_nop 0
    buffer_load_dwordx4 v118, s[8:11], s24 offen lds
    v_mfma_f32_32x32x16_bf16 v[40:55], v[224:227], v[216:219], v[40:55]
    v_mfma_f32_32x32x16_bf16 v[56:71], v[224:227], v[220:223], v[56:71]
    v_dot2_f32_bf16 v119, v224, v0, v119
    v_dot2_f32_bf16 v119, v225, v0, v119
    v_dot2_f32_bf16 v119, v226, v0, v119
    v_dot2_f32_bf16 v119, v227, v0, v119
    s_waitcnt vmcnt(9)
    ds_read_b64_tr_b16 v[200:201], v125 offset:1024
    ds_read_b64_tr_b16 v[202:203], v125 offset:1280
    ds_read_b128 v[192:195], v120 offset:4096
    ds_read_b128 v[196:199], v112 offset:4096
    s_waitcnt lgkmcnt(4)
    s_add_u32 s25, s3, 3
    s_and_b32 s25, s25, 3
    s_mul_i32 s25, s25, 196608
    s_add_u32 s25, s25, s94
    s_add_u32 s24, s25, 98304
    s_add_u32 m0, s90, 0
    s_nop 0
    buffer_load_dwordx4 v118, s[8:11], s24 offen lds
    v_mfma_f32_32x32x16_bf16 v[40:55], v[236:239], v[228:231], v[40:55]
    v_mfma_f32_32x32x16_bf16 v[56:71], v[236:239], v[232:235], v[56:71]
    v_dot2_f32_bf16 v119, v236, v0, v119
    v_dot2_f32_bf16 v119, v237, v0, v119
    v_dot2_f32_bf16 v119, v238, v0, v119
    v_dot2_f32_bf16 v119, v239, v0, v119
    s_waitcnt vmcnt(9)
    ds_read_b64_tr_b16 v[212:213], v125 offset:2048
    ds_read_b64_tr_b16 v[214:215], v125 offset:2304
    ds_read_b128 v[204:207], v121 offset:4096
    ds_read_b128 v[208:211], v113 offset:4096
    s_waitcnt lgkmcnt(4)
    s_add_u32 s25, s3, 3
    s_and_b32 s25, s25, 3
    s_mul_i32 s25, s25, 196608
    s_add_u32 s25, s25, s94
    s_add_u32 s24, s25, 147456
    s_add_u32 m0, s90, 1024
    s_nop 0
    buffer_load_dwordx4 v118, s[8:11], s24 offen lds
    v_mfma_f32_32x32x16_bf16 v[40:55], v[200:203], v[192:195], v[40:55]
    v_mfma_f32_32x32x16_bf16 v[56:71], v[200:203], v[196:199], v[56:71]
    v_dot2_f32_bf16 v119, v200, v0, v119
    v_dot2_f32_bf16 v119, v201, v0, v119
    v_dot2_f32_bf16 v119, v202, v0, v119
    v_dot2_f32_bf16 v119, v203, v0, v119
    s_waitcnt vmcnt(9)
    ds_read_b64_tr_b16 v[224:225], v125 offset:3072
    ds_read_b64_tr_b16 v[226:227], v125 offset:3328
    ds_read_b128 v[216:219], v122 offset:4096
    ds_read_b128 v[220:223], v114 offset:4096
    s_waitcnt lgkmcnt(4)
    v_mfma_f32_32x32x16_bf16 v[40:55], v[212:215], v[204:207], v[40:55]
    v_mfma_f32_32x32x16_bf16 v[56:71], v[212:215], v[208:211], v[56:71]
    v_dot2_f32_bf16 v119, v212, v0, v119
    v_dot2_f32_bf16 v119, v213, v0, v119
    v_dot2_f32_bf16 v119, v214, v0, v119
    v_dot2_f32_bf16 v119, v215, v0, v119
    v_and_b32 v5, 31, v1
    v_lshlrev_b32 v5, 10, v5
    v_lshrrev_b32 v6, 5, v1
    v_lshl_add_u32 v5, v6, 3, v5
    s_lshl_b32 s25, s19, 15
    s_add_u32 s24, s81, s25
    s_lshl_b32 s25, s17, 7
    s_add_u32 s24, s24, s25
    s_lshl_b32 s25, s20, 6
    s_add_u32 s24, s24, s25
    s_lshl_b32 s25, s21, 5
    s_add_u32 s24, s24, s25
    buffer_load_dwordx2 v[20:21], v5, s[12:15], s24 offen
    buffer_load_dwordx2 v[22:23], v5, s[12:15], s24 offen offset:16
    s_lshl_b32 s26, s17, 2
    s_add_u32 s26, s26, s18
    s_lshl_b32 s27, s26, 14
    s_add_u32 s27, s27, s23
    s_add_u32 s27, s27, 0x8a8000
    s_lshl_b32 s28, s26, 11
    s_add_u32 s28, s28, s23
    s_add_u32 s28, s28, 0x9a8000
    s_lshl_b32 s29, s26, 12
    s_add_u32 s29, s29, 0xb20000
    s_lshl_b32 s24, s16, 9
    s_add_u32 s24, s24, s27
    s_lshl_b32 s25, s16, 6
    s_add_u32 s25, s25, s28
    s_cmp_eq_u32 s21, 0
    s_cselect_b32 s24, s24, 0x7fff0000
    s_cselect_b32 s25, s25, 0x7fff0000
    v_mov_b32 v144, -1
    v_mov_b32 v145, -1
    v_mov_b32 v146, -1
    v_mov_b32 v147, -1
    s_mov_b32 exec_hi, 0
    buffer_store_dwordx4 v[144:147], v2, s[4:7], s24 offen sc1
    s_mov_b64 exec, 15
    buffer_store_dwordx4 v[144:147], v2, s[4:7], s25 offen sc1
    s_mov_b64 exec, -1
    s_add_u32 s24, s24, 0x140000
    s_add_u32 s25, s25, 0x140000
    s_mov_b32 exec_hi, 0
    buffer_store_dwordx4 v[144:147], v2, s[4:7], s24 offen sc1
    s_mov_b64 exec, 15
    buffer_store_dwordx4 v[144:147], v2, s[4:7], s25 offen sc1
    s_mov_b64 exec, -1
    v_and_b32 v5, 7, v1
    v_lshlrev_b32 v5, 21, v5
    buffer_load_dword v148, v5, s[4:7], 0 offen
    v_mov_b32 v5, 0
    buffer_load_dwordx2 v[18:19], v5, s[76:79], 0 offen sc1
    s_waitcnt vmcnt(16)
    ds_read_b64_tr_b16 v[236:237], v125 offset:4096
    ds_read_b64_tr_b16 v[238:239], v125 offset:4352
    ds_read_b128 v[228:231], v123 offset:4096
    ds_read_b128 v[232:235], v115 offset:4096
    s_waitcnt lgkmcnt(4)
    v_mfma_f32_32x32x16_bf16 v[40:55], v[224:227], v[216:219], v[40:55]
    v_mfma_f32_32x32x16_bf16 v[56:71], v[224:227], v[220:223], v[56:71]
    v_dot2_f32_bf16 v119, v224, v0, v119
    v_dot2_f32_bf16 v119, v225, v0, v119
    v_dot2_f32_bf16 v119, v226, v0, v119
    v_dot2_f32_bf16 v119, v227, v0, v119
    s_waitcnt vmcnt(15)
    ds_read_b64_tr_b16 v[200:201], v125 offset:5120
    ds_read_b64_tr_b16 v[202:203], v125 offset:5376
    ds_read_b128 v[192:195], v120 offset:8192
    ds_read_b128 v[196:199], v112 offset:8192
    s_waitcnt lgkmcnt(4)
    v_mfma_f32_32x32x16_bf16 v[40:55], v[236:239], v[228:231], v[40:55]
    v_mfma_f32_32x32x16_bf16 v[56:71], v[236:239], v[232:235], v[56:71]
    v_dot2_f32_bf16 v119, v236, v0, v119
    v_dot2_f32_bf16 v119, v237, v0, v119
    v_dot2_f32_bf16 v119, v238, v0, v119
    v_dot2_f32_bf16 v119, v239, v0, v119
    s_waitcnt vmcnt(13)
    ds_read_b64_tr_b16 v[212:213], v125 offset:6144
    ds_read_b64_tr_b16 v[214:215], v125 offset:6400
    ds_read_b128 v[204:207], v121 offset:8192
    ds_read_b128 v[208:211], v113 offset:8192
    s_waitcnt lgkmcnt(4)
    v_mfma_f32_32x32x16_bf16 v[40:55], v[200:203], v[192:195], v[40:55]
    v_mfma_f32_32x32x16_bf16 v[56:71], v[200:203], v[196:199], v[56:71]
    v_dot2_f32_bf16 v119, v200, v0, v119
    v_dot2_f32_bf16 v119, v201, v0, v119
    v_dot2_f32_bf16 v119, v202, v0, v119
    v_dot2_f32_bf16 v119, v203, v0, v119
    s_waitcnt vmcnt(12)
    ds_read_b64_tr_b16 v[224:225], v125 offset:7168
    ds_read_b64_tr_b16 v[226:227], v125 offset:7424
    ds_read_b128 v[216:219], v122 offset:8192
    ds_read_b128 v[220:223], v114 offset:8192
    s_waitcnt lgkmcnt(4)
    v_mfma_f32_32x32x16_bf16 v[40:55], v[212:215], v[204:207], v[40:55]
    v_mfma_f32_32x32x16_bf16 v[56:71], v[212:215], v[208:211], v[56:71]
    v_dot2_f32_bf16 v119, v212, v0, v119
    v_dot2_f32_bf16 v119, v213, v0, v119
    v_dot2_f32_bf16 v119, v214, v0, v119
    v_dot2_f32_bf16 v119, v215, v0, v119
    ds_read_b64_tr_b16 v[236:237], v124 offset:0
    ds_read_b64_tr_b16 v[238:239], v124 offset:256
    ds_read_b128 v[228:231], v123 offset:8192
    ds_read_b128 v[232:235], v115 offset:8192
    s_waitcnt lgkmcnt(4)
    v_mfma_f32_32x32x16_bf16 v[40:55], v[224:227], v[216:219], v[40:55]
    v_mfma_f32_32x32x16_bf16 v[56:71], v[224:227], v[220:223], v[56:71]
    v_dot2_f32_bf16 v119, v224, v0, v119
    v_dot2_f32_bf16 v119, v225, v0, v119
    v_dot2_f32_bf16 v119, v226, v0, v119
    v_dot2_f32_bf16 v119, v227, v0, v119
    s_lshr_b32 s26, s2, 3
    s_lshl_b32 s26, s26, 3
    s_add_u32 s26, s26, s18
    v_lshlrev_b32 v151, 7, v1
    s_lshr_b32 s25, s26, 6
    s_mov_b32 s64, s44
    s_mov_b32 s65, s45
    s_mov_b32 s66, 0x80000
    s_mov_b32 s67, 0x00020000
    s_cmp_eq_u32 s25, 1
    s_cselect_b32 s64, s48, s64
    s_cselect_b32 s65, s49, s65
    s_cmp_eq_u32 s25, 2
    s_cselect_b32 s64, s54, s64
    s_cselect_b32 s65, s55, s65
    s_cmp_eq_u32 s25, 3
    s_cselect_b32 s64, s50, s64
    s_cselect_b32 s65, s51, s65
    s_cselect_b32 s66, 0x4000, s66
    s_cmp_ge_u32 s26, 224
    s_cselect_b32 s64, s52, s64
    s_cselect_b32 s65, s53, s65
    s_cselect_b32 s25, 31, 63
    s_and_b32 s24, s26, s25
    s_lshl_b32 s24, s24, 13
    s_lshr_b32 s25, s26, 6
    s_cmp_lg_u32 s25, 2
    s_cbranch_scc1 wq_2
    s_mov_b32 s64, s42
    s_mov_b32 s65, s43
    s_mov_b32 s66, 0x180000
    s_mul_i32 s24, s24, 3
    v_lshrrev_b32 v150, 3, v1
    v_mul_u32_u24 v150, 3072, v150
    v_and_b32 v151, 7, v1
    v_lshl_add_u32 v151, v151, 7, v150
wq_2:
    buffer_load_dword v150, v151, s[64:67], s24 offen
    s_waitcnt vmcnt(12)
    ds_read_b64_tr_b16 v[200:201], v124 offset:1024
    ds_read_b64_tr_b16 v[202:203], v124 offset:1280
    ds_read_b128 v[192:195], v120 offset:12288
    ds_read_b128 v[196:199], v112 offset:12288
    s_waitcnt lgkmcnt(4)
    v_mfma_f32_32x32x16_bf16 v[40:55], v[236:239], v[228:231], v[40:55]
    v_mfma_f32_32x32x16_bf16 v[56:71], v[236:239], v[232:235], v[56:71]
    v_dot2_f32_bf16 v119, v236, v0, v119
    v_dot2_f32_bf16 v119, v237, v0, v119
    v_dot2_f32_bf16 v119, v238, v0, v119
    v_dot2_f32_bf16 v119, v239, v0, v119
    s_cmp_lg_u32 s21, 1
    s_cbranch_scc1 role_3
    s_waitcnt vmcnt(9)
    s_add_u32 s25, s3, 0
    s_and_b32 s25, s25, 3
    s_mul_i32 s25, s25, 196608
    s_add_u32 s25, s25, s88
    s_add_u32 s24, s25, 0
    s_add_u32 m0, s90, 2048
    s_nop 0
    buffer_load_dwordx4 v118, s[8:11], s24 offen lds
    s_add_u32 s25, s3, 0
    s_and_b32 s25, s25, 3
    s_mul_i32 s25, s25, 196608
    s_add_u32 s25, s25, s88
    s_add_u32 s24, s25, 49152
    s_add_u32 m0, s90, 3072
    s_nop 0
    buffer_load_dwordx4 v118, s[8:11], s24 offen lds
    s_add_u32 s25, s3, 0
    s_and_b32 s25, s25, 3
    s_mul_i32 s25, s25, 196608
    s_add_u32 s25, s25, s88
    s_add_u32 s24, s25, 98304
    s_add_u32 m0, s90, 4096
    s_nop 0
    buffer_load_dwordx4 v118, s[8:11], s24 offen lds
    s_add_u32 s25, s3, 0
    s_and_b32 s25, s25, 3
    s_mul_i32 s25, s25, 196608
    s_add_u32 s25, s25, s88
    s_add_u32 s24, s25, 147456
    s_add_u32 m0, s90, 5120
    s_nop 0
    buffer_load_dwordx4 v118, s[8:11], s24 offen lds
    s_add_u32 s25, s3, 1
    s_and_b32 s25, s25, 3
    s_mul_i32 s25, s25, 196608
    s_add_u32 s25, s25, s88
    s_add_u32 s24, s25, 0
    s_add_u32 m0, s90, 6144
    s_nop 0
    buffer_load_dwordx4 v118, s[8:11], s24 offen lds
    s_add_u32 s25, s3, 1
    s_and_b32 s25, s25, 3
    s_mul_i32 s25, s25, 196608
    s_add_u32 s25, s25, s88
    s_add_u32 s24, s25, 49152
    s_add_u32 m0, s90, 7168
    s_nop 0
    buffer_load_dwordx4 v118, s[8:11], s24 offen lds
role_3:
    s_waitcnt vmcnt(11)
    ds_read_b64_tr_b16 v[212:213], v124 offset:2048
    ds_read_b64_tr_b16 v[214:215], v124 offset:2304
    ds_read_b128 v[204:207], v121 offset:12288
    ds_read_b128 v[208:211], v113 offset:12288
    s_waitcnt lgkmcnt(4)
    v_mfma_f32_32x32x16_bf16 v[40:55], v[200:203], v[192:195], v[40:55]
    v_mfma_f32_32x32x16_bf16 v[56:71], v[200:203], v[196:199], v[56:71]
    v_dot2_f32_bf16 v119, v200, v0, v119
    v_dot2_f32_bf16 v119, v201, v0, v119
    v_dot2_f32_bf16 v119, v202, v0, v119
    v_dot2_f32_bf16 v119, v203, v0, v119
    s_waitcnt vmcnt(10)
    ds_read_b64_tr_b16 v[224:225], v125 offset:0
    ds_read_b64_tr_b16 v[226:227], v125 offset:256
    ds_read_b128 v[216:219], v122 offset:12288
    ds_read_b128 v[220:223], v114 offset:12288
    s_waitcnt lgkmcnt(4)
    v_mfma_f32_32x32x16_bf16 v[40:55], v[212:215], v[204:207], v[40:55]
    v_mfma_f32_32x32x16_bf16 v[56:71], v[212:215], v[208:211], v[56:71]
    v_dot2_f32_bf16 v119, v212, v0, v119
    v_dot2_f32_bf16 v119, v213, v0, v119
    v_dot2_f32_bf16 v119, v214, v0, v119
    v_dot2_f32_bf16 v119, v215, v0, v119
    s_waitcnt vmcnt(9)
    ds_read_b64_tr_b16 v[236:237], v125 offset:1024
    ds_read_b64_tr_b16 v[238:239], v125 offset:1280
    ds_read_b128 v[228:231], v123 offset:12288
    ds_read_b128 v[232:235], v115 offset:12288
    s_waitcnt lgkmcnt(4)
    v_mfma_f32_32x32x16_bf16 v[40:55], v[224:227], v[216:219], v[40:55]
    v_mfma_f32_32x32x16_bf16 v[56:71], v[224:227], v[220:223], v[56:71]
    v_dot2_f32_bf16 v119, v224, v0, v119
    v_dot2_f32_bf16 v119, v225, v0, v119
    v_dot2_f32_bf16 v119, v226, v0, v119
    v_dot2_f32_bf16 v119, v227, v0, v119
    s_waitcnt lgkmcnt(0)
    v_mfma_f32_32x32x16_bf16 v[40:55], v[236:239], v[228:231], v[40:55]
    v_mfma_f32_32x32x16_bf16 v[56:71], v[236:239], v[232:235], v[56:71]
    v_dot2_f32_bf16 v119, v236, v0, v119
    v_dot2_f32_bf16 v119, v237, v0, v119
    v_dot2_f32_bf16 v119, v238, v0, v119
    v_dot2_f32_bf16 v119, v239, v0, v119
    s_cmp_lg_u32 s21, 1
    s_cbranch_scc1 role_4
    s_add_u32 s25, s3, 1
    s_and_b32 s25, s25, 3
    s_mul_i32 s25, s25, 196608
    s_add_u32 s25, s25, s88
    s_add_u32 s24, s25, 98304
    s_add_u32 m0, s90, 0
    s_nop 0
    buffer_load_dwordx4 v118, s[8:11], s24 offen lds
    s_add_u32 s25, s3, 1
    s_and_b32 s25, s25, 3
    s_mul_i32 s25, s25, 196608
    s_add_u32 s25, s25, s88
    s_add_u32 s24, s25, 147456
    s_add_u32 m0, s90, 1024
    s_nop 0
    buffer_load_dwordx4 v118, s[8:11], s24 offen lds
role_4:
    s_nop 2
    v_cvt_pk_bf16_f32 v6, v119, v119
    v_and_b32 v6, 0xffff0000, v6
    v_sub_f32 v7, v119, v6
    v_cvt_pk_bf16_f32 v12, v6, v7
    v_and_b32 v6, 0xffff0000, v12
    v_sub_f32 v7, v7, v6
    v_cvt_pk_bf16_f32 v13, v7, 0
    s_nop 1
    v_mfma_f32_32x32x16_bf16 v[40:55], v[12:15], v[72:75], v[40:55]
    v_mfma_f32_32x32x16_bf16 v[56:71], v[12:15], v[76:79], v[56:71]
    s_barrier
    s_xor_b32 s24, s18, 1
    s_lshl_b32 s24, s24, 12
    s_add_u32 s24, s24, 65536
    v_add_u32 v5, s24, v2
    s_nop 8
    ds_write_b128 v5, v[56:59] offset:0
    ds_write_b128 v5, v[60:63] offset:1024
    ds_write_b128 v5, v[64:67] offset:2048
    ds_write_b128 v5, v[68:71] offset:3072
    s_cmp_lg_u32 s21, 0
    s_cbranch_scc1 role_5
    s_waitcnt vmcnt(1)
    v_cmp_eq_u32 vcc, 0, v19
    s_cbranch_vccz nok_6
    v_mov_b32 v5, 0
    s_mov_b32 s63, 0
pl_7:
    s_add_u32 s63, s63, 1
    s_cmp_gt_u32 s63, 200000
    s_cbranch_scc1 L_end
    buffer_load_dwordx2 v[18:19], v5, s[76:79], 0 offen sc1
    s_waitcnt vmcnt(0)
    v_cmp_eq_u32 vcc, 0, v19
    s_cbranch_vccz po_8
    s_sleep 2
    s_branch pl_7
po_8:
nok_6:
    v_readfirstlane_b32 s32, v18
    v_readfirstlane_b32 s33, v19
    s_nop 3
role_5:
    s_cmp_lg_u32 s21, 1
    s_cbranch_scc1 role_9
    s_waitcnt vmcnt(9)
    v_cmp_eq_u32 vcc, 0, v19
    s_cbranch_vccz nok_10
    v_mov_b32 v5, 0
    s_mov_b32 s63, 0
pl_11:
    s_add_u32 s63, s63, 1
    s_cmp_gt_u32 s63, 200000
    s_cbranch_scc1 L_end
    buffer_load_dwordx2 v[18:19], v5, s[76:79], 0 offen sc1
    s_waitcnt vmcnt(0)
    v_cmp_eq_u32 vcc, 0, v19
    s_cbranch_vccz po_12
    s_sleep 2
    s_branch pl_11
po_12:
nok_10:
    v_readfirstlane_b32 s32, v18
    v_readfirstlane_b32 s33, v19
    s_nop 3
role_9:
    v_mov_b32 v18, 0
    v_mov_b32 v19, 0
    s_mov_b32 s39, 1
    s_cmp_lg_u32 s18, 0
    s_cbranch_scc1 role_13
    s_lshl_b32 s24, s39, 4
    s_add_u32 s24, s24, s32
    s_add_u32 s24, s24, s91
    v_mov_b32 v6, s24
    v_mov_b32 v7, s33
    s_mov_b64 exec, 1
    s_cmp_eq_u32 s62, 1
    s_cbranch_scc1 fs_14
    buffer_store_dwordx2 v[6:7], v97, s[4:7], 0 offen sc1
    s_branch fs_15
fs_14:
    buffer_store_dwordx2 v[6:7], v97, s[4:7], 0 offen
fs_15:
    s_mov_b64 exec, -1
role_13:
    s_cmp_lg_u32 s21, 0
    s_cbranch_scc1 role_16
    s_lshl_b32 s26, s17, 2
    s_add_u32 s26, s26, s18
    s_lshl_b32 s27, s26, 14
    s_add_u32 s27, s27, s23
    s_add_u32 s27, s27, 0x8a8000
    s_lshl_b32 s28, s26, 11
    s_add_u32 s28, s28, s23
    s_add_u32 s28, s28, 0x9a8000
    s_lshl_b32 s29, s26, 12
    s_add_u32 s29, s29, 0xb20000
    s_mov_b32 s64, 1
    s_lshl_b32 s24, s64, 4
    s_add_u32 s24, s24, s32
    v_mov_b32 v8, s24
    v_mov_b32 v9, s33
    s_lshl_b32 s24, s16, 7
    s_add_u32 s24, s24, s29
    v_mov_b32 v5, 0
    s_mov_b64 exec, 1
    buffer_store_dwordx2 v[8:9], v5, s[4:7], s24 offen sc1
    s_mov_b64 exec, -1
role_16:
    s_waitcnt lgkmcnt(0)
    s_barrier
    s_lshl_b32 s24, s18, 12
    s_add_u32 s24, s24, 65536
    v_add_u32 v5, s24, v2
    ds_read_b128 v[56:59], v5 offset:0
    ds_read_b128 v[60:63], v5 offset:1024
    ds_read_b128 v[64:67], v5 offset:2048
    ds_read_b128 v[68:71], v5 offset:3072
    s_lshl_b32 s24, s20, 12
    s_lshl_b32 s25, s21, 13
    s_add_u32 s24, s24, s25
    s_lshl_b32 s25, s19, 10
    s_add_u32 s24, s24, s25
    s_add_u32 s24, s24, 98304
    v_and_b32 v7, 31, v1
    v_lshlrev_b32 v7, 5, v7
    v_lshrrev_b32 v6, 5, v1
    v_lshl_add_u32 v7, v6, 4, v7
    v_add_u32 v7, s24, v7
    s_waitcnt lgkmcnt(0)
    v_pk_add_f32 v[40:41], v[40:41], v[56:57]
    v_pk_add_f32 v[42:43], v[42:43], v[58:59]
    v_pk_add_f32 v[44:45], v[44:45], v[60:61]
    v_pk_add_f32 v[46:47], v[46:47], v[62:63]
    v_pk_add_f32 v[48:49], v[48:49], v[64:65]
    v_pk_add_f32 v[50:51], v[50:51], v[66:67]
    v_pk_add_f32 v[52:53], v[52:53], v[68:69]
    v_pk_add_f32 v[54:55], v[54:55], v[70:71]
    s_cmp_lg_u32 s21, 0
    s_cbranch_scc1 role_17
    v_mul_f32 v9, 0x3fb8aa3b, v11
    v_mul_f32 v56, v40, v9
    v_mul_f32 v57, v41, v9
    v_mul_f32 v58, v42, v9
    v_mul_f32 v59, v43, v9
    v_mul_f32 v60, v44, v9
    v_mul_f32 v61, v45, v9
    v_mul_f32 v62, v46, v9
    v_mul_f32 v63, v47, v9
    v_mul_f32 v64, v48, v9
    v_mul_f32 v65, v49, v9
    v_mul_f32 v66, v50, v9
    v_mul_f32 v67, v51, v9
    v_mul_f32 v68, v52, v9
    v_mul_f32 v69, v53, v9
    v_mul_f32 v70, v54, v9
    v_mul_f32 v71, v55, v9
    v_exp_f32_e64 v56, v56 clamp
    v_exp_f32_e64 v57, v57 clamp
    v_exp_f32_e64 v58, v58 clamp
    v_exp_f32_e64 v59, v59 clamp
    v_exp_f32_e64 v60, v60 clamp
    v_exp_f32_e64 v61, v61 clamp
    v_exp_f32_e64 v62, v62 clamp
    v_exp_f32_e64 v63, v63 clamp
    v_exp_f32_e64 v64, v64 clamp
    v_exp_f32_e64 v65, v65 clamp
    v_exp_f32_e64 v66, v66 clamp
    v_exp_f32_e64 v67, v67 clamp
    v_exp_f32_e64 v68, v68 clamp
    v_exp_f32_e64 v69, v69 clamp
    v_exp_f32_e64 v70, v70 clamp
    v_exp_f32_e64 v71, v71 clamp
    v_fmaak_f32 v40, v40, v11, 0x358637bd
    v_max_f32 v40, 0x358637bd, v40
    v_fmaak_f32 v41, v41, v11, 0x358637bd
    v_max_f32 v41, 0x358637bd, v41
    v_fmaak_f32 v42, v42, v11, 0x358637bd
    v_max_f32 v42, 0x358637bd, v42
    v_fmaak_f32 v43, v43, v11, 0x358637bd
    v_max_f32 v43, 0x358637bd, v43
    v_fmaak_f32 v44, v44, v11, 0x358637bd
    v_max_f32 v44, 0x358637bd, v44
    v_fmaak_f32 v45, v45, v11, 0x358637bd
    v_max_f32 v45, 0x358637bd, v45
    v_fmaak_f32 v46, v46, v11, 0x358637bd
    v_max_f32 v46, 0x358637bd, v46
    v_fmaak_f32 v47, v47, v11, 0x358637bd
    v_max_f32 v47, 0x358637bd, v47
    v_fmaak_f32 v48, v48, v11, 0x358637bd
    v_max_f32 v48, 0x358637bd, v48
    v_fmaak_f32 v49, v49, v11, 0x358637bd
    v_max_f32 v49, 0x358637bd, v49
    v_fmaak_f32 v50, v50, v11, 0x358637bd
    v_max_f32 v50, 0x358637bd, v50
    v_fmaak_f32 v51, v51, v11, 0x358637bd
    v_max_f32 v51, 0x358637bd, v51
    v_fmaak_f32 v52, v52, v11, 0x358637bd
    v_max_f32 v52, 0x358637bd, v52
    v_fmaak_f32 v53, v53, v11, 0x358637bd
    v_max_f32 v53, 0x358637bd, v53
    v_fmaak_f32 v54, v54, v11, 0x358637bd
    v_max_f32 v54, 0x358637bd, v54
    v_fmaak_f32 v55, v55, v11, 0x358637bd
    v_max_f32 v55, 0x358637bd, v55
    v_pk_add_f32 v[40:41], v[40:41], v[56:57]
    v_pk_add_f32 v[42:43], v[42:43], v[58:59]
    v_pk_add_f32 v[44:45], v[44:45], v[60:61]
    v_pk_add_f32 v[46:47], v[46:47], v[62:63]
    v_pk_add_f32 v[48:49], v[48:49], v[64:65]
    v_pk_add_f32 v[50:51], v[50:51], v[66:67]
    v_pk_add_f32 v[52:53], v[52:53], v[68:69]
    v_pk_add_f32 v[54:55], v[54:55], v[70:71]
    v_cvt_pk_bf16_f32 v24, v40, v41
    v_cvt_pk_bf16_f32 v25, v42, v43
    v_cvt_pk_bf16_f32 v26, v44, v45
    v_cvt_pk_bf16_f32 v27, v46, v47
    v_cvt_pk_bf16_f32 v28, v48, v49
    v_cvt_pk_bf16_f32 v29, v50, v51
    v_cvt_pk_bf16_f32 v30, v52, v53
    v_cvt_pk_bf16_f32 v31, v54, v55
role_17:
    s_cmp_lg_u32 s21, 1
    s_cbranch_scc1 role_18
    v_mul_f32 v40, v40, v11
    v_mul_f32 v41, v41, v11
    v_mul_f32 v42, v42, v11
    v_mul_f32 v43, v43, v11
    v_mul_f32 v44, v44, v11
    v_mul_f32 v45, v45, v11
    v_mul_f32 v46, v46, v11
    v_mul_f32 v47, v47, v11
    v_mul_f32 v48, v48, v11
    v_mul_f32 v49, v49, v11
    v_mul_f32 v50, v50, v11
    v_mul_f32 v51, v51, v11
    v_mul_f32 v52, v52, v11
    v_mul_f32 v53, v53, v11
    v_mul_f32 v54, v54, v11
    v_mul_f32 v55, v55, v11
    v_cvt_pk_bf16_f32 v24, v40, v41
    v_cvt_pk_bf16_f32 v25, v42, v43
    v_cvt_pk_bf16_f32 v26, v44, v45
    v_cvt_pk_bf16_f32 v27, v46, v47
    v_cvt_pk_bf16_f32 v28, v48, v49
    v_cvt_pk_bf16_f32 v29, v50, v51
    v_cvt_pk_bf16_f32 v30, v52, v53
    v_cvt_pk_bf16_f32 v31, v54, v55
role_18:
    ds_write_b128 v7, v[24:27]
    ds_write_b128 v7, v[28:31] offset:2048
    s_waitcnt lgkmcnt(0)
    s_barrier
    s_cmp_lg_u32 s21, 1
    s_cbranch_scc1 role_19
    s_waitcnt vmcnt(0)
role_19:
    s_cmp_lg_u32 s21, 1
    s_cbranch_scc1 ie_20
    ds_read_b64_tr_b16 v[200:201], v125 offset:2048
    ds_read_b64_tr_b16 v[202:203], v125 offset:2304
    ds_read_b128 v[192:195], v120 offset:0
    ds_read_b128 v[196:199], v112 offset:0
    ds_read_b64_tr_b16 v[212:213], v125 offset:3072
    ds_read_b64_tr_b16 v[214:215], v125 offset:3328
    ds_read_b128 v[204:207], v121 offset:0
    ds_read_b128 v[208:211], v113 offset:0
    s_waitcnt lgkmcnt(4)
    s_add_u32 s25, s3, 2
    s_and_b32 s25, s25, 3
    s_mul_i32 s25, s25, 196608
    s_add_u32 s25, s25, s88
    s_add_u32 s24, s25, 0
    s_add_u32 m0, s90, 2048
    s_nop 0
    buffer_load_dwordx4 v118, s[8:11], s24 offen lds
    v_mov_b32 v119, 0
    v_mfma_f32_32x32x16_bf16 v[40:55], v[200:203], v[192:195], 0
    v_mfma_f32_32x32x16_bf16 v[56:71], v[200:203], v[196:199], 0
    v_dot2_f32_bf16 v119, v200, v0, v119
    v_dot2_f32_bf16 v119, v201, v0, v119
    v_dot2_f32_bf16 v119, v202, v0, v119
    v_dot2_f32_bf16 v119, v203, v0, v119
    ds_read_b64_tr_b16 v[224:225], v125 offset:4096
    ds_read_b64_tr_b16 v[226:227], v125 offset:4352
    ds_read_b128 v[216:219], v122 offset:0
    ds_read_b128 v[220:223], v114 offset:0
    s_waitcnt lgkmcnt(4)
    s_add_u32 s25, s3, 2
    s_and_b32 s25, s25, 3
    s_mul_i32 s25, s25, 196608
    s_add_u32 s25, s25, s88
    s_add_u32 s24, s25, 49152
    s_add_u32 m0, s90, 3072
    s_nop 0
    buffer_load_dwordx4 v118, s[8:11], s24 offen lds
    v_mfma_f32_32x32x16_bf16 v[40:55], v[212:215], v[204:207], v[40:55]
    v_mfma_f32_32x32x16_bf16 v[56:71], v[212:215], v[208:211], v[56:71]
    v_dot2_f32_bf16 v119, v212, v0, v119
    v_dot2_f32_bf16 v119, v213, v0, v119
    v_dot2_f32_bf16 v119, v214, v0, v119
    v_dot2_f32_bf16 v119, v215, v0, v119
    ds_read_b64_tr_b16 v[236:237], v125 offset:5120
    ds_read_b64_tr_b16 v[238:239], v125 offset:5376
    ds_read_b128 v[228:231], v123 offset:0
    ds_read_b128 v[232:235], v115 offset:0
    s_waitcnt lgkmcnt(4)
    s_add_u32 s25, s3, 2
    s_and_b32 s25, s25, 3
    s_mul_i32 s25, s25, 196608
    s_add_u32 s25, s25, s88
    s_add_u32 s24, s25, 98304
    s_add_u32 m0, s90, 4096
    s_nop 0
    buffer_load_dwordx4 v118, s[8:11], s24 offen lds
    v_mfma_f32_32x32x16_bf16 v[40:55], v[224:227], v[216:219], v[40:55]
    v_mfma_f32_32x32x16_bf16 v[56:71], v[224:227], v[220:223], v[56:71]
    v_dot2_f32_bf16 v119, v224, v0, v119
    v_dot2_f32_bf16 v119, v225, v0, v119
    v_dot2_f32_bf16 v119, v226, v0, v119
    v_dot2_f32_bf16 v119, v227, v0, v119
    ds_read_b64_tr_b16 v[200:201], v125 offset:6144
    ds_read_b64_tr_b16 v[202:203], v125 offset:6400
    ds_read_b128 v[192:195], v120 offset:4096
    ds_read_b128 v[196:199], v112 offset:4096
    s_waitcnt lgkmcnt(4)
    s_add_u32 s25, s3, 2
    s_and_b32 s25, s25, 3
    s_mul_i32 s25, s25, 196608
    s_add_u32 s25, s25, s88
    s_add_u32 s24, s25, 147456
    s_add_u32 m0, s90, 5120
    s_nop 0
    buffer_load_dwordx4 v118, s[8:11], s24 offen lds
    v_mfma_f32_32x32x16_bf16 v[40:55], v[236:239], v[228:231], v[40:55]
    v_mfma_f32_32x32x16_bf16 v[56:71], v[236:239], v[232:235], v[56:71]
    v_dot2_f32_bf16 v119, v236, v0, v119
    v_dot2_f32_bf16 v119, v237, v0, v119
    v_dot2_f32_bf16 v119, v238, v0, v119
    v_dot2_f32_bf16 v119, v239, v0, v119
    ds_read_b64_tr_b16 v[212:213], v125 offset:7168
    ds_read_b64_tr_b16 v[214:215], v125 offset:7424
    ds_read_b128 v[204:207], v121 offset:4096
    ds_read_b128 v[208:211], v113 offset:4096
    s_waitcnt lgkmcnt(4)
    s_add_u32 s25, s3, 3
    s_and_b32 s25, s25, 3
    s_mul_i32 s25, s25, 196608
    s_add_u32 s25, s25, s88
    s_add_u32 s24, s25, 0
    s_add_u32 m0, s90, 6144
    s_nop 0
    buffer_load_dwordx4 v118, s[8:11], s24 offen lds
    v_mfma_f32_32x32x16_bf16 v[40:55], v[200:203], v[192:195], v[40:55]
    v_mfma_f32_32x32x16_bf16 v[56:71], v[200:203], v[196:199], v[56:71]
    v_dot2_f32_bf16 v119, v200, v0, v119
    v_dot2_f32_bf16 v119, v201, v0, v119
    v_dot2_f32_bf16 v119, v202, v0, v119
    v_dot2_f32_bf16 v119, v203, v0, v119
    ds_read_b64_tr_b16 v[224:225], v125 offset:0
    ds_read_b64_tr_b16 v[226:227], v125 offset:256
    ds_read_b128 v[216:219], v122 offset:4096
    ds_read_b128 v[220:223], v114 offset:4096
    s_waitcnt lgkmcnt(4)
    s_add_u32 s25, s3, 3
    s_and_b32 s25, s25, 3
    s_mul_i32 s25, s25, 196608
    s_add_u32 s25, s25, s88
    s_add_u32 s24, s25, 49152
    s_add_u32 m0, s90, 7168
    s_nop 0
    buffer_load_dwordx4 v118, s[8:11], s24 offen lds
    v_mfma_f32_32x32x16_bf16 v[40:55], v[212:215], v[204:207], v[40:55]
    v_mfma_f32_32x32x16_bf16 v[56:71], v[212:215], v[208:211], v[56:71]
    v_dot2_f32_bf16 v119, v212, v0, v119
    v_dot2_f32_bf16 v119, v213, v0, v119
    v_dot2_f32_bf16 v119, v214, v0, v119
    v_dot2_f32_bf16 v119, v215, v0, v119
    ds_read_b64_tr_b16 v[236:237], v125 offset:1024
    ds_read_b64_tr_b16 v[238:239], v125 offset:1280
    ds_read_b128 v[228:231], v123 offset:4096
    ds_read_b128 v[232:235], v115 offset:4096
    s_waitcnt lgkmcnt(4)
    s_add_u32 s25, s3, 3
    s_and_b32 s25, s25, 3
    s_mul_i32 s25, s25, 196608
    s_add_u32 s25, s25, s88
    s_add_u32 s24, s25, 98304
    s_add_u32 m0, s90, 0
    s_nop 0
    buffer_load_dwordx4 v118, s[8:11], s24 offen lds
    v_mfma_f32_32x32x16_bf16 v[40:55], v[224:227], v[216:219], v[40:55]
    v_mfma_f32_32x32x16_bf16 v[56:71], v[224:227], v[220:223], v[56:71]
    v_dot2_f32_bf16 v119, v224, v0, v119
    v_dot2_f32_bf16 v119, v225, v0, v119
    v_dot2_f32_bf16 v119, v226, v0, v119
    v_dot2_f32_bf16 v119, v227, v0, v119
    s_waitcnt vmcnt(6)
    ds_read_b64_tr_b16 v[200:201], v125 offset:2048
    ds_read_b64_tr_b16 v[202:203], v125 offset:2304
    ds_read_b128 v[192:195], v120 offset:8192
    ds_read_b128 v[196:199], v112 offset:8192
    s_waitcnt lgkmcnt(4)
    s_add_u32 s25, s3, 3
    s_and_b32 s25, s25, 3
    s_mul_i32 s25, s25, 196608
    s_add_u32 s25, s25, s88
    s_add_u32 s24, s25, 147456
    s_add_u32 m0, s90, 1024
    s_nop 0
    buffer_load_dwordx4 v118, s[8:11], s24 offen lds
    v_mfma_f32_32x32x16_bf16 v[40:55], v[236:239], v[228:231], v[40:55]
    v_mfma_f32_32x32x16_bf16 v[56:71], v[236:239], v[232:235], v[56:71]
    v_dot2_f32_bf16 v119, v236, v0, v119
    v_dot2_f32_bf16 v119, v237, v0, v119
    v_dot2_f32_bf16 v119, v238, v0, v119
    v_dot2_f32_bf16 v119, v239, v0, v119
    s_waitcnt vmcnt(6)
    ds_read_b64_tr_b16 v[212:213], v125 offset:3072
    ds_read_b64_tr_b16 v[214:215], v125 offset:3328
    ds_read_b128 v[204:207], v121 offset:8192
    ds_read_b128 v[208:211], v113 offset:8192
    s_waitcnt lgkmcnt(4)
    v_mfma_f32_32x32x16_bf16 v[40:55], v[200:203], v[192:195], v[40:55]
    v_mfma_f32_32x32x16_bf16 v[56:71], v[200:203], v[196:199], v[56:71]
    v_dot2_f32_bf16 v119, v200, v0, v119
    v_dot2_f32_bf16 v119, v201, v0, v119
    v_dot2_f32_bf16 v119, v202, v0, v119
    v_dot2_f32_bf16 v119, v203, v0, v119
    s_waitcnt vmcnt(5)
    ds_read_b64_tr_b16 v[224:225], v125 offset:4096
    ds_read_b64_tr_b16 v[226:227], v125 offset:4352
    ds_read_b128 v[216:219], v122 offset:8192
    ds_read_b128 v[220:223], v114 offset:8192
    s_waitcnt lgkmcnt(4)
    v_mfma_f32_32x32x16_bf16 v[40:55], v[212:215], v[204:207], v[40:55]
    v_mfma_f32_32x32x16_bf16 v[56:71], v[212:215], v[208:211], v[56:71]
    v_dot2_f32_bf16 v119, v212, v0, v119
    v_dot2_f32_bf16 v119, v213, v0, v119
    v_dot2_f32_bf16 v119, v214, v0, v119
    v_dot2_f32_bf16 v119, v215, v0, v119
    s_waitcnt vmcnt(4)
    ds_read_b64_tr_b16 v[236:237], v125 offset:5120
    ds_read_b64_tr_b16 v[238:239], v125 offset:5376
    ds_read_b128 v[228:231], v123 offset:8192
    ds_read_b128 v[232:235], v115 offset:8192
    s_waitcnt lgkmcnt(4)
    v_mfma_f32_32x32x16_bf16 v[40:55], v[224:227], v[216:219], v[40:55]
    v_mfma_f32_32x32x16_bf16 v[56:71], v[224:227], v[220:223], v[56:71]
    v_dot2_f32_bf16 v119, v224, v0, v119
    v_dot2_f32_bf16 v119, v225, v0, v119
    v_dot2_f32_bf16 v119, v226, v0, v119
    v_dot2_f32_bf16 v119, v227, v0, v119
    s_waitcnt vmcnt(3)
    ds_read_b64_tr_b16 v[200:201], v125 offset:6144
    ds_read_b64_tr_b16 v[202:203], v125 offset:6400
    ds_read_b128 v[192:195], v120 offset:12288
    ds_read_b128 v[196:199], v112 offset:12288
    s_waitcnt lgkmcnt(4)
    v_mfma_f32_32x32x16_bf16 v[40:55], v[236:239], v[228:231], v[40:55]
    v_mfma_f32_32x32x16_bf16 v[56:71], v[236:239], v[232:235], v[56:71]
    v_dot2_f32_bf16 v119, v236, v0, v119
    v_dot2_f32_bf16 v119, v237, v0, v119
    v_dot2_f32_bf16 v119, v238, v0, v119
    v_dot2_f32_bf16 v119, v239, v0, v119
    s_waitcnt vmcnt(2)
    ds_read_b64_tr_b16 v[212:213], v125 offset:7168
    ds_read_b64_tr_b16 v[214:215], v125 offset:7424
    ds_read_b128 v[204:207], v121 offset:12288
    ds_read_b128 v[208:211], v113 offset:12288
    s_waitcnt lgkmcnt(4)
    v_mfma_f32_32x32x16_bf16 v[40:55], v[200:203], v[192:195], v[40:55]
    v_mfma_f32_32x32x16_bf16 v[56:71], v[200:203], v[196:199], v[56:71]
    v_dot2_f32_bf16 v119, v200, v0, v119
    v_dot2_f32_bf16 v119, v201, v0, v119
    v_dot2_f32_bf16 v119, v202, v0, v119
    v_dot2_f32_bf16 v119, v203, v0, v119
    s_waitcnt vmcnt(1)
    ds_read_b64_tr_b16 v[224:225], v125 offset:0
    ds_read_b64_tr_b16 v[226:227], v125 offset:256
    ds_read_b128 v[216:219], v122 offset:12288
    ds_read_b128 v[220:223], v114 offset:12288
    s_waitcnt lgkmcnt(4)
    v_mfma_f32_32x32x16_bf16 v[40:55], v[212:215], v[204:207], v[40:55]
    v_mfma_f32_32x32x16_bf16 v[56:71], v[212:215], v[208:211], v[56:71]
    v_dot2_f32_bf16 v119, v212, v0, v119
    v_dot2_f32_bf16 v119, v213, v0, v119
    v_dot2_f32_bf16 v119, v214, v0, v119
    v_dot2_f32_bf16 v119, v215, v0, v119
    s_waitcnt vmcnt(0)
    ds_read_b64_tr_b16 v[236:237], v125 offset:1024
    ds_read_b64_tr_b16 v[238:239], v125 offset:1280
    ds_read_b128 v[228:231], v123 offset:12288
    ds_read_b128 v[232:235], v115 offset:12288
    s_waitcnt lgkmcnt(4)
    v_mfma_f32_32x32x16_bf16 v[40:55], v[224:227], v[216:219], v[40:55]
    v_mfma_f32_32x32x16_bf16 v[56:71], v[224:227], v[220:223], v[56:71]
    v_dot2_f32_bf16 v119, v224, v0, v119
    v_dot2_f32_bf16 v119, v225, v0, v119
    v_dot2_f32_bf16 v119, v226, v0, v119
    v_dot2_f32_bf16 v119, v227, v0, v119
    s_waitcnt lgkmcnt(0)
    v_mfma_f32_32x32x16_bf16 v[40:55], v[236:239], v[228:231], v[40:55]
    v_mfma_f32_32x32x16_bf16 v[56:71], v[236:239], v[232:235], v[56:71]
    v_dot2_f32_bf16 v119, v236, v0, v119
    v_dot2_f32_bf16 v119, v237, v0, v119
    v_dot2_f32_bf16 v119, v238, v0, v119
    v_dot2_f32_bf16 v119, v239, v0, v119
    s_nop 2
    v_cvt_pk_bf16_f32 v6, v119, v119
    v_and_b32 v6, 0xffff0000, v6
    v_sub_f32 v7, v119, v6
    v_cvt_pk_bf16_f32 v14, v6, v7
    v_and_b32 v6, 0xffff0000, v14
    v_sub_f32 v7, v7, v6
    v_cvt_pk_bf16_f32 v15, v7, 0
    s_nop 1
    v_mfma_f32_32x32x16_bf16 v[40:55], v[14:17], v[72:75], v[40:55]
    v_mfma_f32_32x32x16_bf16 v[56:71], v[14:17], v[76:79], v[56:71]
    s_lshl_b32 s24, s20, 13
    s_mul_i32 s25, s19, 6144
    s_add_u32 s24, s24, s25
    s_add_u32 s24, s24, 65536
    v_add_u32 v5, s24, v2
    v_xor_b32 v6, 4096, v5
    s_nop 6
    ds_write_b128 v5, v[40:43] offset:0
    ds_write_b128 v5, v[44:47] offset:1024
    ds_write_b128 v6, v[56:59] offset:0
    ds_write_b128 v6, v[60:63] offset:1024
    ds_write_b128 v6, v[64:67] offset:16384
    ds_write_b128 v6, v[68:71] offset:17408
    s_waitcnt lgkmcnt(0)
    s_barrier
    v_and_b32 v86, 31, v1
    v_lshlrev_b32 v86, 3, v86
    s_lshl_b32 s66, s75, 8
    s_add_u32 s66, s66, 0xb04000
    buffer_load_dwordx2 v[82:83], v86, s[4:7], s66 offen sc1
    s_lshl_b32 s24, s18, 12
    s_add_u32 s24, s24, 65536
    v_add_u32 v5, s24, v2
    s_cmp_eq_u32 s21, 1
    s_cbranch_scc1 rr_22
    ds_read_b128 v[40:43], v5 offset:0
    ds_read_b128 v[44:47], v5 offset:1024
    ds_read_b128 v[48:51], v5 offset:2048
    ds_read_b128 v[52:55], v5 offset:3072
    s_waitcnt lgkmcnt(0)
    v_pk_add_f32 v[40:41], v[40:41], v[48:49]
    v_pk_add_f32 v[42:43], v[42:43], v[50:51]
    v_pk_add_f32 v[44:45], v[44:45], v[52:53]
    v_pk_add_f32 v[46:47], v[46:47], v[54:55]
    s_branch rr_23
rr_22:
    s_xor_b32 s24, s19, 1
    s_lshl_b32 s24, s24, 11
    v_add_u32 v5, s24, v5
    ds_read_b128 v[56:59], v5
    ds_read_b128 v[60:63], v5 offset:1024
    s_waitcnt lgkmcnt(0)
    v_pk_add_f32 v[40:41], v[48:49], v[56:57]
    v_pk_add_f32 v[42:43], v[50:51], v[58:59]
    v_pk_add_f32 v[44:45], v[52:53], v[60:61]
    v_pk_add_f32 v[46:47], v[54:55], v[62:63]
rr_23:
    v_mul_f32 v9, 0x3fb8aa3b, v11
    v_mul_f32 v48, v40, v9
    v_mul_f32 v49, v41, v9
    v_mul_f32 v50, v42, v9
    v_mul_f32 v51, v43, v9
    v_mul_f32 v52, v44, v9
    v_mul_f32 v53, v45, v9
    v_mul_f32 v54, v46, v9
    v_mul_f32 v55, v47, v9
    v_exp_f32_e64 v48, v48 clamp
    v_exp_f32_e64 v49, v49 clamp
    v_exp_f32_e64 v50, v50 clamp
    v_exp_f32_e64 v51, v51 clamp
    v_exp_f32_e64 v52, v52 clamp
    v_exp_f32_e64 v53, v53 clamp
    v_exp_f32_e64 v54, v54 clamp
    v_exp_f32_e64 v55, v55 clamp
    v_fmaak_f32 v40, v40, v11, 0x358637bd
    v_max_f32 v40, 0x358637bd, v40
    v_fmaak_f32 v41, v41, v11, 0x358637bd
    v_max_f32 v41, 0x358637bd, v41
    v_fmaak_f32 v42, v42, v11, 0x358637bd
    v_max_f32 v42, 0x358637bd, v42
    v_fmaak_f32 v43, v43, v11, 0x358637bd
    v_max_f32 v43, 0x358637bd, v43
    v_fmaak_f32 v44, v44, v11, 0x358637bd
    v_max_f32 v44, 0x358637bd, v44
    v_fmaak_f32 v45, v45, v11, 0x358637bd
    v_max_f32 v45, 0x358637bd, v45
    v_fmaak_f32 v46, v46, v11, 0x358637bd
    v_max_f32 v46, 0x358637bd, v46
    v_fmaak_f32 v47, v47, v11, 0x358637bd
    v_max_f32 v47, 0x358637bd, v47
    v_pk_add_f32 v[40:41], v[40:41], v[48:49]
    v_pk_add_f32 v[42:43], v[42:43], v[50:51]
    v_pk_add_f32 v[44:45], v[44:45], v[52:53]
    v_pk_add_f32 v[46:47], v[46:47], v[54:55]
    v_cvt_pk_bf16_f32 v88, v40, v41
    v_cvt_pk_bf16_f32 v89, v42, v43
    v_cvt_pk_bf16_f32 v90, v44, v45
    v_cvt_pk_bf16_f32 v91, v46, v47
    s_waitcnt vmcnt(0)
    s_lshl_b32 s65, s39, 4
    s_add_u32 s65, s65, s32
    v_mov_b32 v84, v82
    v_subrev_u32 v82, s65, v82
    v_xor_b32 v83, s33, v83
    v_lshrrev_b32 v82, 12, v82
    v_or_b32 v7, v82, v83
    v_cmp_ne_u32 vcc, 0, v7
    s_cbranch_vccz pc_24
    s_mov_b32 s63, 0
pl_25:
    s_add_u32 s63, s63, 1
    s_cmp_gt_u32 s63, 200000
    s_cbranch_scc1 L_end
    buffer_load_dwordx2 v[82:83], v86, s[4:7], s66 offen sc1
    s_waitcnt vmcnt(0)
    v_mov_b32 v84, v82
    v_subrev_u32 v82, s65, v82
    v_xor_b32 v83, s33, v83
    v_lshrrev_b32 v82, 12, v82
    v_or_b32 v7, v82, v83
    v_cmp_ne_u32 vcc, 0, v7
    s_cbranch_vccz po_26
    s_sleep 1
    s_branch pl_25
po_26:
pc_24:
    v_and_b32 v84, 15, v84
    v_cmp_ne_u32 vcc, s91, v84
    s_nop 3
    s_cmp_eq_u64 vcc, 0
    s_cselect_b32 s62, 1, 0
    s_and_b32 s70, s18, 3
    s_lshl_b32 s70, s70, 14
    s_mov_b32 s12, s48
    s_mov_b32 s13, s49
    s_mov_b32 s14, 0x80000
    s_mov_b32 s15, 0x00020000
    s_mov_b32 s69, 1024
    s_mov_b32 s68, 0
    v_lshrrev_b32 v94, 2, v1
    v_mul_lo_u32 v94, v94, s69
    v_and_b32 v7, 3, v1
    v_lshl_add_u32 v94, v7, 4, v94
    s_lshl_b32 s69, s69, 4
    s_lshl_b32 s24, s19, 4
    s_mul_i32 s24, s24, s69
    s_add_u32 s68, s68, s24
    s_add_u32 s68, s68, s80
    v_lshrrev_b32 v95, 5, v1
    v_lshlrev_b32 v95, 8, v95
    v_bfe_u32 v7, v1, 2, 2
    v_lshl_add_u32 v95, v7, 6, v95
    v_bfe_u32 v7, v1, 4, 1
    v_lshl_add_u32 v95, v7, 5, v95
    v_and_b32 v7, 3, v1
    v_lshl_add_u32 v95, v7, 3, v95
    v_add_u32 v95, s70, v95
    s_add_u32 m0, s70, 0
    s_nop 0
    buffer_load_dwordx4 v94, s[12:15], s68 offen lds
    s_add_u32 s68, s68, s69
    s_add_u32 m0, s70, 1024
    s_nop 0
    buffer_load_dwordx4 v94, s[12:15], s68 offen lds
    s_add_u32 s68, s68, s69
    s_add_u32 m0, s70, 2048
    s_nop 0
    buffer_load_dwordx4 v94, s[12:15], s68 offen lds
    s_add_u32 s68, s68, s69
    s_add_u32 m0, s70, 3072
    s_nop 0
    buffer_load_dwordx4 v94, s[12:15], s68 offen lds
    s_add_u32 s68, s68, s69
    s_add_u32 m0, s70, 4096
    s_nop 0
    buffer_load_dwordx4 v94, s[12:15], s68 offen lds
    s_add_u32 s68, s68, s69
    s_add_u32 m0, s70, 5120
    s_nop 0
    buffer_load_dwordx4 v94, s[12:15], s68 offen lds
    s_add_u32 s68, s68, s69
    s_add_u32 m0, s70, 6144
    s_nop 0
    buffer_load_dwordx4 v94, s[12:15], s68 offen lds
    s_add_u32 s68, s68, s69
    s_add_u32 m0, s70, 7168
    s_nop 0
    buffer_load_dwordx4 v94, s[12:15], s68 offen lds
    s_add_u32 s68, s68, s69
    s_add_u32 m0, s70, 8192
    s_nop 0
    buffer_load_dwordx4 v94, s[12:15], s68 offen lds
    s_add_u32 s68, s68, s69
    s_add_u32 m0, s70, 9216
    s_nop 0
    buffer_load_dwordx4 v94, s[12:15], s68 offen lds
    s_add_u32 s68, s68, s69
    s_add_u32 m0, s70, 10240
    s_nop 0
    buffer_load_dwordx4 v94, s[12:15], s68 offen lds
    s_add_u32 s68, s68, s69
    s_add_u32 m0, s70, 11264
    s_nop 0
    buffer_load_dwordx4 v94, s[12:15], s68 offen lds
    s_add_u32 s68, s68, s69
    s_add_u32 m0, s70, 12288
    s_nop 0
    buffer_load_dwordx4 v94, s[12:15], s68 offen lds
    s_add_u32 s68, s68, s69
    s_add_u32 m0, s70, 13312
    s_nop 0
    buffer_load_dwordx4 v94, s[12:15], s68 offen lds
    s_add_u32 s68, s68, s69
    s_add_u32 m0, s70, 14336
    s_nop 0
    buffer_load_dwordx4 v94, s[12:15], s68 offen lds
    s_add_u32 s68, s68, s69
    s_add_u32 m0, s70, 15360
    s_nop 0
    buffer_load_dwordx4 v94, s[12:15], s68 offen lds
    s_add_u32 s68, s68, s69
    s_waitcnt vmcnt(15)
    ds_read_b64_tr_b16 v[192:193], v95 offset:0
    ds_read_b64_tr_b16 v[194:195], v95 offset:512
    s_waitcnt vmcnt(14)
    ds_read_b64_tr_b16 v[196:197], v95 offset:1024
    ds_read_b64_tr_b16 v[198:199], v95 offset:1536
    s_waitcnt vmcnt(13)
    ds_read_b64_tr_b16 v[200:201], v95 offset:2048
    ds_read_b64_tr_b16 v[202:203], v95 offset:2560
    s_waitcnt vmcnt(12)
    ds_read_b64_tr_b16 v[204:205], v95 offset:3072
    ds_read_b64_tr_b16 v[206:207], v95 offset:3584
    s_waitcnt vmcnt(11)
    ds_read_b64_tr_b16 v[208:209], v95 offset:4096
    ds_read_b64_tr_b16 v[210:211], v95 offset:4608
    s_waitcnt vmcnt(10)
    ds_read_b64_tr_b16 v[212:213], v95 offset:5120
    ds_read_b64_tr_b16 v[214:215], v95 offset:5632
    s_waitcnt vmcnt(9)
    ds_read_b64_tr_b16 v[216:217], v95 offset:6144
    ds_read_b64_tr_b16 v[218:219], v95 offset:6656
    s_waitcnt vmcnt(8)
    ds_read_b64_tr_b16 v[220:221], v95 offset:7168
    ds_read_b64_tr_b16 v[222:223], v95 offset:7680
    s_waitcnt vmcnt(7)
    ds_read_b64_tr_b16 v[224:225], v95 offset:8192
    ds_read_b64_tr_b16 v[226:227], v95 offset:8704
    s_waitcnt vmcnt(6)
    ds_read_b64_tr_b16 v[228:229], v95 offset:9216
    ds_read_b64_tr_b16 v[230:231], v95 offset:9728
    s_waitcnt vmcnt(5)
    ds_read_b64_tr_b16 v[232:233], v95 offset:10240
    ds_read_b64_tr_b16 v[234:235], v95 offset:10752
    s_waitcnt vmcnt(4)
    ds_read_b64_tr_b16 v[236:237], v95 offset:11264
    ds_read_b64_tr_b16 v[238:239], v95 offset:11776
    s_waitcnt vmcnt(3)
    ds_read_b64_tr_b16 v[240:241], v95 offset:12288
    ds_read_b64_tr_b16 v[242:243], v95 offset:12800
    s_waitcnt vmcnt(2)
    ds_read_b64_tr_b16 v[244:245], v95 offset:13312
    ds_read_b64_tr_b16 v[246:247], v95 offset:13824
    s_waitcnt vmcnt(1)
    ds_read_b64_tr_b16 v[248:249], v95 offset:14336
    ds_read_b64_tr_b16 v[250:251], v95 offset:14848
    s_waitcnt vmcnt(0)
    ds_read_b64_tr_b16 v[252:253], v95 offset:15360
    ds_read_b64_tr_b16 v[254:255], v95 offset:15872
    s_waitcnt lgkmcnt(0)
    v_mov_b32 v9, 0
    s_nop 1
    v_dot2_f32_bf16 v9, v192, v0, v9
    v_dot2_f32_bf16 v9, v193, v0, v9
    v_dot2_f32_bf16 v9, v194, v0, v9
    v_dot2_f32_bf16 v9, v195, v0, v9
    v_dot2_f32_bf16 v9, v196, v0, v9
    v_dot2_f32_bf16 v9, v197, v0, v9
    v_dot2_f32_bf16 v9, v198, v0, v9
    v_dot2_f32_bf16 v9, v199, v0, v9
    v_dot2_f32_bf16 v9, v200, v0, v9
    v_dot2_f32_bf16 v9, v201, v0, v9
    v_dot2_f32_bf16 v9, v202, v0, v9
    v_dot2_f32_bf16 v9, v203, v0, v9
    v_dot2_f32_bf16 v9, v204, v0, v9
    v_dot2_f32_bf16 v9, v205, v0, v9
    v_dot2_f32_bf16 v9, v206, v0, v9
    v_dot2_f32_bf16 v9, v207, v0, v9
    v_dot2_f32_bf16 v9, v208, v0, v9
    v_dot2_f32_bf16 v9, v209, v0, v9
    v_dot2_f32_bf16 v9, v210, v0, v9
    v_dot2_f32_bf16 v9, v211, v0, v9
    v_dot2_f32_bf16 v9, v212, v0, v9
    v_dot2_f32_bf16 v9, v213, v0, v9
    v_dot2_f32_bf16 v9, v214, v0, v9
    v_dot2_f32_bf16 v9, v215, v0, v9
    v_dot2_f32_bf16 v9, v216, v0, v9
    v_dot2_f32_bf16 v9, v217, v0, v9
    v_dot2_f32_bf16 v9, v218, v0, v9
    v_dot2_f32_bf16 v9, v219, v0, v9
    v_dot2_f32_bf16 v9, v220, v0, v9
    v_dot2_f32_bf16 v9, v221, v0, v9
    v_dot2_f32_bf16 v9, v222, v0, v9
    v_dot2_f32_bf16 v9, v223, v0, v9
    v_dot2_f32_bf16 v9, v224, v0, v9
    v_dot2_f32_bf16 v9, v225, v0, v9
    v_dot2_f32_bf16 v9, v226, v0, v9
    v_dot2_f32_bf16 v9, v227, v0, v9
    v_dot2_f32_bf16 v9, v228, v0, v9
    v_dot2_f32_bf16 v9, v229, v0, v9
    v_dot2_f32_bf16 v9, v230, v0, v9
    v_dot2_f32_bf16 v9, v231, v0, v9
    v_dot2_f32_bf16 v9, v232, v0, v9
    v_dot2_f32_bf16 v9, v233, v0, v9
    v_dot2_f32_bf16 v9, v234, v0, v9
    v_dot2_f32_bf16 v9, v235, v0, v9
    v_dot2_f32_bf16 v9, v236, v0, v9
    v_dot2_f32_bf16 v9, v237, v0, v9
    v_dot2_f32_bf16 v9, v238, v0, v9
    v_dot2_f32_bf16 v9, v239, v0, v9
    v_dot2_f32_bf16 v9, v240, v0, v9
    v_dot2_f32_bf16 v9, v241, v0, v9
    v_dot2_f32_bf16 v9, v242, v0, v9
    v_dot2_f32_bf16 v9, v243, v0, v9
    v_dot2_f32_bf16 v9, v244, v0, v9
    v_dot2_f32_bf16 v9, v245, v0, v9
    v_dot2_f32_bf16 v9, v246, v0, v9
    v_dot2_f32_bf16 v9, v247, v0, v9
    v_dot2_f32_bf16 v9, v248, v0, v9
    v_dot2_f32_bf16 v9, v249, v0, v9
    v_dot2_f32_bf16 v9, v250, v0, v9
    v_dot2_f32_bf16 v9, v251, v0, v9
    v_dot2_f32_bf16 v9, v252, v0, v9
    v_dot2_f32_bf16 v9, v253, v0, v9
    v_dot2_f32_bf16 v9, v254, v0, v9
    v_dot2_f32_bf16 v9, v255, v0, v9
    s_nop 2
    v_cvt_pk_bf16_f32 v6, v9, v9
    v_and_b32 v6, 0xffff0000, v6
    v_sub_f32 v7, v9, v6
    v_cvt_pk_bf16_f32 v16, v6, v7
    v_and_b32 v6, 0xffff0000, v16
    v_sub_f32 v7, v7, v6
    v_cvt_pk_bf16_f32 v17, v7, 0
    s_branch ie_21
ie_20:
    v_lshrrev_b32 v5, 4, v1
    v_lshlrev_b32 v5, 8, v5
    v_bfe_u32 v6, v1, 2, 2
    v_lshl_add_u32 v5, v6, 5, v5
    v_and_b32 v6, 1, v1
    v_lshl_add_u32 v5, v6, 4, v5
    v_bfe_u32 v6, v1, 1, 1
    v_lshl_add_u32 v5, v6, 3, v5
    s_lshl_b32 s24, s18, 11
    s_add_u32 s24, s24, 98304
    v_add_u32 v5, s24, v5
    ds_read_b64_tr_b16 v[24:25], v5 offset:0
    ds_read_b64_tr_b16 v[32:33], v5 offset:8192
    ds_read_b64_tr_b16 v[26:27], v5 offset:128
    ds_read_b64_tr_b16 v[34:35], v5 offset:8320
    ds_read_b64_tr_b16 v[28:29], v5 offset:1024
    ds_read_b64_tr_b16 v[36:37], v5 offset:9216
    ds_read_b64_tr_b16 v[30:31], v5 offset:1152
    ds_read_b64_tr_b16 v[38:39], v5 offset:9344
    v_mov_b32 v48, v0
    v_mov_b32 v49, v0
    v_mov_b32 v50, v0
    v_mov_b32 v51, v0
    s_lshl_b32 s26, s17, 2
    s_add_u32 s26, s26, s18
    s_lshl_b32 s27, s26, 14
    s_add_u32 s27, s27, s23
    s_add_u32 s27, s27, 0x8a8000
    s_lshl_b32 s28, s26, 11
    s_add_u32 s28, s28, s23
    s_add_u32 s28, s28, 0x9a8000
    s_lshl_b32 s29, s26, 12
    s_add_u32 s29, s29, 0xb20000
    s_waitcnt lgkmcnt(0)
    v_mfma_f32_16x16x32_bf16 v[40:43], v[24:27], v[32:35], 0
    v_mfma_f32_16x16x32_bf16 v[44:47], v[24:27], v[48:51], 0
    v_mfma_f32_16x16x32_bf16 v[40:43], v[28:31], v[36:39], v[40:43]
    v_mfma_f32_16x16x32_bf16 v[44:47], v[28:31], v[48:51], v[44:47]
    s_lshl_b32 s24, s16, 9
    s_add_u32 s24, s24, s27
    s_lshl_b32 s25, s16, 6
    s_add_u32 s25, s25, s28
    v_and_b32 v6, 48, v1
    v_lshlrev_b32 v5, 3, v1
    s_nop 2
    v_cvt_pk_bf16_f32 v40, v40, v41
    v_cvt_pk_bf16_f32 v41, v42, v43
    v_min_u32 v40, -2, v40
    v_min_u32 v41, -2, v41
    v_min_u32 v44, -2, v44
    v_min_u32 v45, -2, v45
    v_min_u32 v46, -2, v46
    v_min_u32 v47, -2, v47
    buffer_store_dwordx2 v[40:41], v5, s[4:7], s24 offen sc1
    s_mov_b32 exec_lo, 0x00010001
    s_mov_b32 exec_hi, 0x00010001
    buffer_store_dwordx4 v[44:47], v6, s[4:7], s25 offen sc1
    s_mov_b64 exec, -1
    s_mov_b32 s64, 1
    s_lshl_b32 s65, s64, 4
    s_add_u32 s65, s65, s32
    v_and_b32 v5, 31, v1
    v_lshlrev_b32 v5, 7, v5
    s_mov_b32 s63, 0
pl_27:
    s_add_u32 s63, s63, 1
    s_cmp_gt_u32 s63, 200000
    s_cbranch_scc1 L_end
    buffer_load_dwordx2 v[8:9], v5, s[4:7], s29 offen sc1
    s_waitcnt vmcnt(0)
    v_subrev_u32 v8, s65, v8
    v_xor_b32 v9, s33, v9
    v_lshrrev_b32 v8, 12, v8
    v_or_b32 v7, v8, v9
    v_cmp_ne_u32 vcc, 0, v7
    s_cbranch_vccnz pl_27
    s_lshl_b32 s26, s17, 2
    s_add_u32 s26, s26, s18
    s_lshl_b32 s27, s26, 14
    s_add_u32 s27, s27, s23
    s_add_u32 s27, s27, 0x8a8000
    s_lshl_b32 s28, s26, 11
    s_add_u32 s28, s28, s23
    s_add_u32 s28, s28, 0x9a8000
    s_lshl_b32 s29, s26, 12
    s_add_u32 s29, s29, 0xb20000
    s_mov_b32 s71, s27
    v_and_b32 v6, 48, v1
    v_and_b32 v5, 15, v1
    v_lshl_add_u32 v5, v5, 6, v6
    s_mov_b32 s63, 0
pl_29:
    s_add_u32 s63, s63, 1
    s_cmp_gt_u32 s63, 200000
    s_cbranch_scc1 L_end
    buffer_load_dwordx4 v[100:103], v5, s[4:7], s28 offen sc1
    buffer_load_dwordx4 v[104:107], v5, s[4:7], s28 offen offset:1024 sc1
    s_waitcnt vmcnt(0)
    v_max3_u32 v7, v100, v101, v102
    v_max3_u32 v8, v103, v104, v105
    v_max3_u32 v7, v7, v106, v107
    v_max_u32 v7, v7, v8
    v_cmp_eq_u32 vcc, -1, v7
    s_cbranch_vccnz pl_29
    s_mov_b32 s86, 0
    s_mov_b32 s87, 0
gat_31:
    s_add_u32 s87, s87, 1
    s_cmp_gt_u32 s87, 200000
    s_cbranch_scc1 L_end
    s_mov_b32 s24, s71
    buffer_load_dwordx4 v[192:195], v2, s[4:7], s24 offen offset:0 sc1
    buffer_load_dwordx4 v[196:199], v2, s[4:7], s24 offen offset:1024 sc1
    buffer_load_dwordx4 v[200:203], v2, s[4:7], s24 offen offset:2048 sc1
    buffer_load_dwordx4 v[204:207], v2, s[4:7], s24 offen offset:3072 sc1
    s_add_u32 s24, s24, 4096
    buffer_load_dwordx4 v[208:211], v2, s[4:7], s24 offen offset:0 sc1
    buffer_load_dwordx4 v[212:215], v2, s[4:7], s24 offen offset:1024 sc1
    buffer_load_dwordx4 v[216:219], v2, s[4:7], s24 offen offset:2048 sc1
    buffer_load_dwordx4 v[220:223], v2, s[4:7], s24 offen offset:3072 sc1
    s_add_u32 s24, s24, 4096
    buffer_load_dwordx4 v[224:227], v2, s[4:7], s24 offen offset:0 sc1
    buffer_load_dwordx4 v[228:231], v2, s[4:7], s24 offen offset:1024 sc1
    buffer_load_dwordx4 v[232:235], v2, s[4:7], s24 offen offset:2048 sc1
    buffer_load_dwordx4 v[236:239], v2, s[4:7], s24 offen offset:3072 sc1
    s_add_u32 s24, s24, 4096
    buffer_load_dwordx4 v[240:243], v2, s[4:7], s24 offen offset:0 sc1
    buffer_load_dwordx4 v[244:247], v2, s[4:7], s24 offen offset:1024 sc1
    buffer_load_dwordx4 v[248:251], v2, s[4:7], s24 offen offset:2048 sc1
    buffer_load_dwordx4 v[252:255], v2, s[4:7], s24 offen offset:3072 sc1
    s_cmp_lg_u32 s86, 0
    s_cbranch_scc1 gs_32
    s_mov_b32 s86, 1
    s_waitcnt lgkmcnt(0)
    s_barrier
    v_and_b32 v86, 31, v1
    v_lshlrev_b32 v86, 3, v86
    s_lshl_b32 s66, s75, 8
    s_add_u32 s66, s66, 0xb04000
    buffer_load_dwordx2 v[82:83], v86, s[4:7], s66 offen sc1
    s_mov_b32 s12, s44
    s_mov_b32 s13, s45
    s_mov_b32 s14, 0x80000
    s_mov_b32 s15, 0x00020000
    s_mov_b32 s69, 1024
    s_mov_b32 s68, 0
    v_lshrrev_b32 v94, 2, v1
    v_mul_lo_u32 v94, v94, s69
    v_and_b32 v7, 3, v1
    v_lshl_add_u32 v94, v7, 4, v94
    s_lshl_b32 s69, s69, 4
    s_lshl_b32 s24, s19, 4
    s_mul_i32 s24, s24, s69
    s_add_u32 s68, s68, s24
    s_add_u32 s68, s68, s80
    s_and_b32 s70, s18, 3
    s_lshl_b32 s70, s70, 13
    s_add_u32 s70, s70, 131072
    v_lshrrev_b32 v95, 5, v1
    v_lshlrev_b32 v95, 8, v95
    v_bfe_u32 v7, v1, 2, 2
    v_lshl_add_u32 v95, v7, 6, v95
    v_bfe_u32 v7, v1, 4, 1
    v_lshl_add_u32 v95, v7, 5, v95
    v_and_b32 v7, 3, v1
    v_lshl_add_u32 v95, v7, 3, v95
    v_add_u32 v95, s70, v95
    s_add_u32 m0, s70, 0
    s_nop 0
    buffer_load_dwordx4 v94, s[12:15], s68 offen lds
    s_add_u32 s68, s68, s69
    s_add_u32 m0, s70, 1024
    s_nop 0
    buffer_load_dwordx4 v94, s[12:15], s68 offen lds
    s_add_u32 s68, s68, s69
    s_add_u32 m0, s70, 2048
    s_nop 0
    buffer_load_dwordx4 v94, s[12:15], s68 offen lds
    s_add_u32 s68, s68, s69
    s_add_u32 m0, s70, 3072
    s_nop 0
    buffer_load_dwordx4 v94, s[12:15], s68 offen lds
    s_add_u32 s68, s68, s69
    s_add_u32 m0, s70, 4096
    s_nop 0
    buffer_load_dwordx4 v94, s[12:15], s68 offen lds
    s_add_u32 s68, s68, s69
    s_add_u32 m0, s70, 5120
    s_nop 0
    buffer_load_dwordx4 v94, s[12:15], s68 offen lds
    s_add_u32 s68, s68, s69
    s_add_u32 m0, s70, 6144
    s_nop 0
    buffer_load_dwordx4 v94, s[12:15], s68 offen lds
    s_add_u32 s68, s68, s69
    s_add_u32 m0, s70, 7168
    s_nop 0
    buffer_load_dwordx4 v94, s[12:15], s68 offen lds
    s_add_u32 s68, s68, s69
    s_lshl_b32 s24, s18, 12
    s_add_u32 s24, s24, 65536
    v_add_u32 v5, s24, v2
    s_cmp_eq_u32 s21, 1
    s_cbranch_scc1 rr_33
    ds_read_b128 v[40:43], v5 offset:0
    ds_read_b128 v[44:47], v5 offset:1024
    ds_read_b128 v[48:51], v5 offset:2048
    ds_read_b128 v[52:55], v5 offset:3072
    s_waitcnt lgkmcnt(0)
    v_pk_add_f32 v[40:41], v[40:41], v[48:49]
    v_pk_add_f32 v[42:43], v[42:43], v[50:51]
    v_pk_add_f32 v[44:45], v[44:45], v[52:53]
    v_pk_add_f32 v[46:47], v[46:47], v[54:55]
    s_branch rr_34
rr_33:
    s_xor_b32 s24, s19, 1
    s_lshl_b32 s24, s24, 11
    v_add_u32 v5, s24, v5
    ds_read_b128 v[56:59], v5
    ds_read_b128 v[60:63], v5 offset:1024
    s_waitcnt lgkmcnt(0)
    v_pk_add_f32 v[40:41], v[48:49], v[56:57]
    v_pk_add_f32 v[42:43], v[50:51], v[58:59]
    v_pk_add_f32 v[44:45], v[52:53], v[60:61]
    v_pk_add_f32 v[46:47], v[54:55], v[62:63]
rr_34:
    v_mul_f32 v9, 0x3fb8aa3b, v11
    v_mul_f32 v48, v40, v9
    v_mul_f32 v49, v41, v9
    v_mul_f32 v50, v42, v9
    v_mul_f32 v51, v43, v9
    v_mul_f32 v52, v44, v9
    v_mul_f32 v53, v45, v9
    v_mul_f32 v54, v46, v9
    v_mul_f32 v55, v47, v9
    v_exp_f32_e64 v48, v48 clamp
    v_exp_f32_e64 v49, v49 clamp
    v_exp_f32_e64 v50, v50 clamp
    v_exp_f32_e64 v51, v51 clamp
    v_exp_f32_e64 v52, v52 clamp
    v_exp_f32_e64 v53, v53 clamp
    v_exp_f32_e64 v54, v54 clamp
    v_exp_f32_e64 v55, v55 clamp
    v_fmaak_f32 v40, v40, v11, 0x358637bd
    v_max_f32 v40, 0x358637bd, v40
    v_fmaak_f32 v41, v41, v11, 0x358637bd
    v_max_f32 v41, 0x358637bd, v41
    v_fmaak_f32 v42, v42, v11, 0x358637bd
    v_max_f32 v42, 0x358637bd, v42
    v_fmaak_f32 v43, v43, v11, 0x358637bd
    v_max_f32 v43, 0x358637bd, v43
    v_fmaak_f32 v44, v44, v11, 0x358637bd
    v_max_f32 v44, 0x358637bd, v44
    v_fmaak_f32 v45, v45, v11, 0x358637bd
    v_max_f32 v45, 0x358637bd, v45
    v_fmaak_f32 v46, v46, v11, 0x358637bd
    v_max_f32 v46, 0x358637bd, v46
    v_fmaak_f32 v47, v47, v11, 0x358637bd
    v_max_f32 v47, 0x358637bd, v47
    v_pk_add_f32 v[40:41], v[40:41], v[48:49]
    v_pk_add_f32 v[42:43], v[42:43], v[50:51]
    v_pk_add_f32 v[44:45], v[44:45], v[52:53]
    v_pk_add_f32 v[46:47], v[46:47], v[54:55]
    v_cvt_pk_bf16_f32 v88, v40, v41
    v_cvt_pk_bf16_f32 v89, v42, v43
    v_cvt_pk_bf16_f32 v90, v44, v45
    v_cvt_pk_bf16_f32 v91, v46, v47
    s_waitcnt vmcnt(8)
    s_lshl_b32 s65, s39, 4
    s_add_u32 s65, s65, s32
    v_mov_b32 v84, v82
    v_subrev_u32 v82, s65, v82
    v_xor_b32 v83, s33, v83
    v_lshrrev_b32 v82, 12, v82
    v_or_b32 v7, v82, v83
    v_cmp_ne_u32 vcc, 0, v7
    s_cbranch_vccz pc_35
    s_mov_b32 s63, 0
pl_36:
    s_add_u32 s63, s63, 1
    s_cmp_gt_u32 s63, 200000
    s_cbranch_scc1 L_end
    buffer_load_dwordx2 v[82:83], v86, s[4:7], s66 offen sc1
    s_waitcnt vmcnt(0)
    v_mov_b32 v84, v82
    v_subrev_u32 v82, s65, v82
    v_xor_b32 v83, s33, v83
    v_lshrrev_b32 v82, 12, v82
    v_or_b32 v7, v82, v83
    v_cmp_ne_u32 vcc, 0, v7
    s_cbranch_vccz po_37
    s_sleep 1
    s_branch pl_36
po_37:
pc_35:
    v_and_b32 v84, 15, v84
    v_cmp_ne_u32 vcc, s91, v84
    s_nop 3
    s_cmp_eq_u64 vcc, 0
    s_cselect_b32 s62, 1, 0
    s_branch gs_32_j
gs_32:
    s_waitcnt vmcnt(0)
gs_32_j:
    v_pk_add_f32 v[108:109], v[100:101], v[104:105]
    v_pk_add_f32 v[110:111], v[102:103], v[106:107]
    s_nop 1
    v_add_f32_dpp v108, v108, v108 row_ror:8 row_mask:0xf bank_mask:0xf
    v_add_f32_dpp v109, v109, v109 row_ror:8 row_mask:0xf bank_mask:0xf
    v_add_f32_dpp v110, v110, v110 row_ror:8 row_mask:0xf bank_mask:0xf
    v_add_f32_dpp v111, v111, v111 row_ror:8 row_mask:0xf bank_mask:0xf
    s_nop 1
    v_add_f32_dpp v108, v108, v108 row_ror:4 row_mask:0xf bank_mask:0xf
    v_add_f32_dpp v109, v109, v109 row_ror:4 row_mask:0xf bank_mask:0xf
    v_add_f32_dpp v110, v110, v110 row_ror:4 row_mask:0xf bank_mask:0xf
    v_add_f32_dpp v111, v111, v111 row_ror:4 row_mask:0xf bank_mask:0xf
    s_nop 1
    v_add_f32_dpp v108, v108, v108 row_ror:2 row_mask:0xf bank_mask:0xf
    v_add_f32_dpp v109, v109, v109 row_ror:2 row_mask:0xf bank_mask:0xf
    v_add_f32_dpp v110, v110, v110 row_ror:2 row_mask:0xf bank_mask:0xf
    v_add_f32_dpp v111, v111, v111 row_ror:2 row_mask:0xf bank_mask:0xf
    s_nop 1
    v_add_f32_dpp v108, v108, v108 row_ror:1 row_mask:0xf bank_mask:0xf
    v_add_f32_dpp v109, v109, v109 row_ror:1 row_mask:0xf bank_mask:0xf
    v_add_f32_dpp v110, v110, v110 row_ror:1 row_mask:0xf bank_mask:0xf
    v_add_f32_dpp v111, v111, v111 row_ror:1 row_mask:0xf bank_mask:0xf
    v_cvt_pk_bf16_f32 v108, v108, v109
    v_cvt_pk_bf16_f32 v109, v110, v111
    s_mov_b32 s24, 0x00110011
    s_mov_b32 s25, 0x00110011
    v_cndmask_b32_e64 v108, 0, v108, s[24:25]
    v_cndmask_b32_e64 v109, 0, v109, s[24:25]
    v_and_b32 v5, 15, v1
    v_lshlrev_b32 v5, 4, v5
    v_bfe_u32 v6, v1, 4, 1
    v_lshl_add_u32 v5, v6, 9, v5
    v_lshrrev_b32 v6, 5, v1
    v_lshl_add_u32 v5, v6, 3, v5
    s_lshl_b32 s24, s18, 11
    s_add_u32 s24, s24, 98304
    v_add_u32 v5, s24, v5
    ds_write_b64 v5, v[108:109] offset:256
    v_and_b32 v5, 7, v1
    v_lshlrev_b32 v5, 5, v5
    v_bfe_u32 v6, v1, 3, 1
    v_lshl_add_u32 v5, v6, 9, v5
    v_bfe_u32 v6, v1, 4, 1
    v_lshl_add_u32 v5, v6, 3, v5
    v_add_u32 v5, s24, v5
    v_mov_b32 v7, 0
    v_mov_b32 v48, 0x00003f80
    v_mov_b32 v49, 0x3f800000
    v_mov_b32 v40, 0
    v_mov_b32 v41, 0
    v_mov_b32 v42, 0
    v_mov_b32 v43, 0
    v_mov_b32 v44, 0
    v_mov_b32 v45, 0
    v_mov_b32 v46, 0
    v_mov_b32 v47, 0
    s_waitcnt vmcnt(23)
    v_max3_u32 v7, v7, v192, v193
    v_max3_u32 v7, v7, v194, v195
    v_dot2_f32_bf16 v40, v192, v48, v40
    v_dot2_f32_bf16 v41, v192, v49, v41
    v_dot2_f32_bf16 v42, v193, v48, v42
    v_dot2_f32_bf16 v43, v193, v49, v43
    v_dot2_f32_bf16 v44, v194, v48, v44
    v_dot2_f32_bf16 v45, v194, v49, v45
    v_dot2_f32_bf16 v46, v195, v48, v46
    v_dot2_f32_bf16 v47, v195, v49, v47
    s_waitcnt vmcnt(22)
    v_max3_u32 v7, v7, v196, v197
    v_max3_u32 v7, v7, v198, v199
    v_dot2_f32_bf16 v40, v196, v48, v40
    v_dot2_f32_bf16 v41, v196, v49, v41
    v_dot2_f32_bf16 v42, v197, v48, v42
    v_dot2_f32_bf16 v43, v197, v49, v43
    v_dot2_f32_bf16 v44, v198, v48, v44
    v_dot2_f32_bf16 v45, v198, v49, v45
    v_dot2_f32_bf16 v46, v199, v48, v46
    v_dot2_f32_bf16 v47, v199, v49, v47
    s_waitcnt vmcnt(21)
    v_max3_u32 v7, v7, v200, v201
    v_max3_u32 v7, v7, v202, v203
    v_dot2_f32_bf16 v40, v200, v48, v40
    v_dot2_f32_bf16 v41, v200, v49, v41
    v_dot2_f32_bf16 v42, v201, v48, v42
    v_dot2_f32_bf16 v43, v201, v49, v43
    v_dot2_f32_bf16 v44, v202, v48, v44
    v_dot2_f32_bf16 v45, v202, v49, v45
    v_dot2_f32_bf16 v46, v203, v48, v46
    v_dot2_f32_bf16 v47, v203, v49, v47
    s_waitcnt vmcnt(20)
    v_max3_u32 v7, v7, v204, v205
    v_max3_u32 v7, v7, v206, v207
    v_dot2_f32_bf16 v40, v204, v48, v40
    v_dot2_f32_bf16 v41, v204, v49, v41
    v_dot2_f32_bf16 v42, v205, v48, v42
    v_dot2_f32_bf16 v43, v205, v49, v43
    v_dot2_f32_bf16 v44, v206, v48, v44
    v_dot2_f32_bf16 v45, v206, v49, v45
    v_dot2_f32_bf16 v46, v207, v48, v46
    v_dot2_f32_bf16 v47, v207, v49, v47
    s_waitcnt vmcnt(19)
    v_max3_u32 v7, v7, v208, v209
    v_max3_u32 v7, v7, v210, v211
    v_dot2_f32_bf16 v40, v208, v48, v40
    v_dot2_f32_bf16 v41, v208, v49, v41
    v_dot2_f32_bf16 v42, v209, v48, v42
    v_dot2_f32_bf16 v43, v209, v49, v43
    v_dot2_f32_bf16 v44, v210, v48, v44
    v_dot2_f32_bf16 v45, v210, v49, v45
    v_dot2_f32_bf16 v46, v211, v48, v46
    v_dot2_f32_bf16 v47, v211, v49, v47
    s_waitcnt vmcnt(18)
    v_max3_u32 v7, v7, v212, v213
    v_max3_u32 v7, v7, v214, v215
    v_dot2_f32_bf16 v40, v212, v48, v40
    v_dot2_f32_bf16 v41, v212, v49, v41
    v_dot2_f32_bf16 v42, v213, v48, v42
    v_dot2_f32_bf16 v43, v213, v49, v43
    v_dot2_f32_bf16 v44, v214, v48, v44
    v_dot2_f32_bf16 v45, v214, v49, v45
    v_dot2_f32_bf16 v46, v215, v48, v46
    v_dot2_f32_bf16 v47, v215, v49, v47
    s_waitcnt vmcnt(17)
    v_max3_u32 v7, v7, v216, v217
    v_max3_u32 v7, v7, v218, v219
    v_dot2_f32_bf16 v40, v216, v48, v40
    v_dot2_f32_bf16 v41, v216, v49, v41
    v_dot2_f32_bf16 v42, v217, v48, v42
    v_dot2_f32_bf16 v43, v217, v49, v43
    v_dot2_f32_bf16 v44, v218, v48, v44
    v_dot2_f32_bf16 v45, v218, v49, v45
    v_dot2_f32_bf16 v46, v219, v48, v46
    v_dot2_f32_bf16 v47, v219, v49, v47
    s_waitcnt vmcnt(16)
    v_max3_u32 v7, v7, v220, v221
    v_max3_u32 v7, v7, v222, v223
    v_dot2_f32_bf16 v40, v220, v48, v40
    v_dot2_f32_bf16 v41, v220, v49, v41
    v_dot2_f32_bf16 v42, v221, v48, v42
    v_dot2_f32_bf16 v43, v221, v49, v43
    v_dot2_f32_bf16 v44, v222, v48, v44
    v_dot2_f32_bf16 v45, v222, v49, v45
    v_dot2_f32_bf16 v46, v223, v48, v46
    v_dot2_f32_bf16 v47, v223, v49, v47
    s_waitcnt vmcnt(15)
    v_max3_u32 v7, v7, v224, v225
    v_max3_u32 v7, v7, v226, v227
    v_dot2_f32_bf16 v40, v224, v48, v40
    v_dot2_f32_bf16 v41, v224, v49, v41
    v_dot2_f32_bf16 v42, v225, v48, v42
    v_dot2_f32_bf16 v43, v225, v49, v43
    v_dot2_f32_bf16 v44, v226, v48, v44
    v_dot2_f32_bf16 v45, v226, v49, v45
    v_dot2_f32_bf16 v46, v227, v48, v46
    v_dot2_f32_bf16 v47, v227, v49, v47
    s_waitcnt vmcnt(14)
    v_max3_u32 v7, v7, v228, v229
    v_max3_u32 v7, v7, v230, v231
    v_dot2_f32_bf16 v40, v228, v48, v40
    v_dot2_f32_bf16 v41, v228, v49, v41
    v_dot2_f32_bf16 v42, v229, v48, v42
    v_dot2_f32_bf16 v43, v229, v49, v43
    v_dot2_f32_bf16 v44, v230, v48, v44
    v_dot2_f32_bf16 v45, v230, v49, v45
    v_dot2_f32_bf16 v46, v231, v48, v46
    v_dot2_f32_bf16 v47, v231, v49, v47
    s_waitcnt vmcnt(13)
    v_max3_u32 v7, v7, v232, v233
    v_max3_u32 v7, v7, v234, v235
    v_dot2_f32_bf16 v40, v232, v48, v40
    v_dot2_f32_bf16 v41, v232, v49, v41
    v_dot2_f32_bf16 v42, v233, v48, v42
    v_dot2_f32_bf16 v43, v233, v49, v43
    v_dot2_f32_bf16 v44, v234, v48, v44
    v_dot2_f32_bf16 v45, v234, v49, v45
    v_dot2_f32_bf16 v46, v235, v48, v46
    v_dot2_f32_bf16 v47, v235, v49, v47
    s_waitcnt vmcnt(12)
    v_max3_u32 v7, v7, v236, v237
    v_max3_u32 v7, v7, v238, v239
    v_dot2_f32_bf16 v40, v236, v48, v40
    v_dot2_f32_bf16 v41, v236, v49, v41
    v_dot2_f32_bf16 v42, v237, v48, v42
    v_dot2_f32_bf16 v43, v237, v49, v43
    v_dot2_f32_bf16 v44, v238, v48, v44
    v_dot2_f32_bf16 v45, v238, v49, v45
    v_dot2_f32_bf16 v46, v239, v48, v46
    v_dot2_f32_bf16 v47, v239, v49, v47
    s_waitcnt vmcnt(11)
    v_max3_u32 v7, v7, v240, v241
    v_max3_u32 v7, v7, v242, v243
    v_dot2_f32_bf16 v40, v240, v48, v40
    v_dot2_f32_bf16 v41, v240, v49, v41
    v_dot2_f32_bf16 v42, v241, v48, v42
    v_dot2_f32_bf16 v43, v241, v49, v43
    v_dot2_f32_bf16 v44, v242, v48, v44
    v_dot2_f32_bf16 v45, v242, v49, v45
    v_dot2_f32_bf16 v46, v243, v48, v46
    v_dot2_f32_bf16 v47, v243, v49, v47
    s_waitcnt vmcnt(10)
    v_max3_u32 v7, v7, v244, v245
    v_max3_u32 v7, v7, v246, v247
    v_dot2_f32_bf16 v40, v244, v48, v40
    v_dot2_f32_bf16 v41, v244, v49, v41
    v_dot2_f32_bf16 v42, v245, v48, v42
    v_dot2_f32_bf16 v43, v245, v49, v43
    v_dot2_f32_bf16 v44, v246, v48, v44
    v_dot2_f32_bf16 v45, v246, v49, v45
    v_dot2_f32_bf16 v46, v247, v48, v46
    v_dot2_f32_bf16 v47, v247, v49, v47
    s_waitcnt vmcnt(9)
    v_max3_u32 v7, v7, v248, v249
    v_max3_u32 v7, v7, v250, v251
    v_dot2_f32_bf16 v40, v248, v48, v40
    v_dot2_f32_bf16 v41, v248, v49, v41
    v_dot2_f32_bf16 v42, v249, v48, v42
    v_dot2_f32_bf16 v43, v249, v49, v43
    v_dot2_f32_bf16 v44, v250, v48, v44
    v_dot2_f32_bf16 v45, v250, v49, v45
    v_dot2_f32_bf16 v46, v251, v48, v46
    v_dot2_f32_bf16 v47, v251, v49, v47
    s_waitcnt vmcnt(8)
    v_max3_u32 v7, v7, v252, v253
    v_max3_u32 v7, v7, v254, v255
    v_dot2_f32_bf16 v40, v252, v48, v40
    v_dot2_f32_bf16 v41, v252, v49, v41
    v_dot2_f32_bf16 v42, v253, v48, v42
    v_dot2_f32_bf16 v43, v253, v49, v43
    v_dot2_f32_bf16 v44, v254, v48, v44
    v_dot2_f32_bf16 v45, v254, v49, v45
    v_dot2_f32_bf16 v46, v255, v48, v46
    v_dot2_f32_bf16 v47, v255, v49, v47
    v_cmp_eq_u32 vcc, -1, v7
    s_cbranch_vccnz gat_31
    s_nop 1
    v_mov_b32 v56, v40
    v_mov_b32 v57, v41
    v_mov_b32 v58, v42
    v_mov_b32 v59, v43
    v_mov_b32 v60, v44
    v_mov_b32 v61, v45
    v_mov_b32 v62, v46
    v_mov_b32 v63, v47
    s_nop 1
    v_permlane32_swap_b32 v40, v56
    v_permlane32_swap_b32 v41, v57
    v_permlane32_swap_b32 v42, v58
    v_permlane32_swap_b32 v43, v59
    v_permlane32_swap_b32 v44, v60
    v_permlane32_swap_b32 v45, v61
    v_permlane32_swap_b32 v46, v62
    v_permlane32_swap_b32 v47, v63
    s_nop 1
    v_pk_add_f32 v[40:41], v[40:41], v[56:57]
    v_pk_add_f32 v[42:43], v[42:43], v[58:59]
    v_pk_add_f32 v[44:45], v[44:45], v[60:61]
    v_pk_add_f32 v[46:47], v[46:47], v[62:63]
    v_cvt_pk_bf16_f32 v40, v40, v41
    v_cvt_pk_bf16_f32 v41, v42, v43
    v_cvt_pk_bf16_f32 v42, v44, v45
    v_cvt_pk_bf16_f32 v43, v46, v47
    ds_write_b64 v5, v[40:41]
    ds_write_b64 v5, v[42:43] offset:16
    s_waitcnt vmcnt(0)
    ds_read_b64_tr_b16 v[128:129], v95 offset:0
    ds_read_b64_tr_b16 v[130:131], v95 offset:512
    ds_read_b64_tr_b16 v[132:133], v95 offset:1024
    ds_read_b64_tr_b16 v[134:135], v95 offset:1536
    ds_read_b64_tr_b16 v[136:137], v95 offset:2048
    ds_read_b64_tr_b16 v[138:139], v95 offset:2560
    ds_read_b64_tr_b16 v[140:141], v95 offset:3072
    ds_read_b64_tr_b16 v[142:143], v95 offset:3584
    ds_read_b64_tr_b16 v[144:145], v95 offset:4096
    ds_read_b64_tr_b16 v[146:147], v95 offset:4608
    ds_read_b64_tr_b16 v[148:149], v95 offset:5120
    ds_read_b64_tr_b16 v[150:151], v95 offset:5632
    ds_read_b64_tr_b16 v[152:153], v95 offset:6144
    ds_read_b64_tr_b16 v[154:155], v95 offset:6656
    ds_read_b64_tr_b16 v[156:157], v95 offset:7168
    ds_read_b64_tr_b16 v[158:159], v95 offset:7680
    s_waitcnt lgkmcnt(0)
    s_add_u32 m0, s70, 0
    s_nop 0
    buffer_load_dwordx4 v94, s[12:15], s68 offen lds
    s_add_u32 s68, s68, s69
    s_add_u32 m0, s70, 1024
    s_nop 0
    buffer_load_dwordx4 v94, s[12:15], s68 offen lds
    s_add_u32 s68, s68, s69
    s_add_u32 m0, s70, 2048
    s_nop 0
    buffer_load_dwordx4 v94, s[12:15], s68 offen lds
    s_add_u32 s68, s68, s69
    s_add_u32 m0, s70, 3072
    s_nop 0
    buffer_load_dwordx4 v94, s[12:15], s68 offen lds
    s_add_u32 s68, s68, s69
    s_add_u32 m0, s70, 4096
    s_nop 0
    buffer_load_dwordx4 v94, s[12:15], s68 offen lds
    s_add_u32 s68, s68, s69
    s_add_u32 m0, s70, 5120
    s_nop 0
    buffer_load_dwordx4 v94, s[12:15], s68 offen lds
    s_add_u32 s68, s68, s69
    s_add_u32 m0, s70, 6144
    s_nop 0
    buffer_load_dwordx4 v94, s[12:15], s68 offen lds
    s_add_u32 s68, s68, s69
    s_add_u32 m0, s70, 7168
    s_nop 0
    buffer_load_dwordx4 v94, s[12:15], s68 offen lds
    s_add_u32 s68, s68, s69
ie_21:
    s_waitcnt lgkmcnt(0)
    s_barrier
    s_lshl_b32 s24, s20, 1
    s_add_u32 s24, s24, s21
    s_lshl_b32 s24, s24, 11
    s_add_u32 s24, s24, 98304
    v_add_u32 v6, s24, v2
    ds_read_b128 v[28:31], v6
    s_waitcnt lgkmcnt(0)
    v_mfma_f32_32x32x16_bf16 v[56:71], v[28:31], v[88:91], 0
    s_nop 11
    v_add_f32 v8, 0x358637bd, v64
    v_rcp_f32 v8, v8
    s_nop 0
    v_mul_f32 v56, v56, v8
    v_mul_f32 v57, v57, v8
    v_mul_f32 v58, v58, v8
    v_mul_f32 v59, v59, v8
    v_mul_f32 v60, v60, v8
    v_mul_f32 v61, v61, v8
    v_mul_f32 v62, v62, v8
    v_mul_f32 v63, v63, v8
    v_cvt_pk_bf16_f32 v32, v56, v57
    v_cvt_pk_bf16_f32 v33, v58, v59
    v_cvt_pk_bf16_f32 v34, v60, v61
    v_cvt_pk_bf16_f32 v35, v62, v63
    s_add_u32 s24, s22, s73
    s_cmp_eq_u32 s62, 1
    s_cbranch_scc1 fs_38
    buffer_store_dwordx4 v[32:35], v2, s[4:7], s24 offen sc1
    s_branch fs_39
fs_38:
    buffer_store_dwordx4 v[32:35], v2, s[4:7], s24 offen
fs_39:
    s_add_u32 s38, s38, 1
    s_lshl_b32 s24, s38, 4
    s_add_u32 s24, s24, s32
    s_add_u32 s24, s24, s91
    v_mov_b32 v6, s24
    v_mov_b32 v7, s33
    s_waitcnt vmcnt(0) lgkmcnt(0)
    s_mov_b64 exec, 1
    s_cmp_eq_u32 s62, 1
    s_cbranch_scc1 fs_40
    buffer_store_dwordx2 v[6:7], v96, s[4:7], 0 offen sc1
    s_branch fs_41
fs_40:
    buffer_store_dwordx2 v[6:7], v96, s[4:7], 0 offen
fs_41:
    s_mov_b64 exec, -1
    s_cmp_lg_u32 s21, 0
    s_cbranch_scc1 role_42
    ds_read_b64_tr_b16 v[160:161], v95 offset:0
    ds_read_b64_tr_b16 v[162:163], v95 offset:512
    ds_read_b64_tr_b16 v[164:165], v95 offset:1024
    ds_read_b64_tr_b16 v[166:167], v95 offset:1536
    ds_read_b64_tr_b16 v[168:169], v95 offset:2048
    ds_read_b64_tr_b16 v[170:171], v95 offset:2560
    ds_read_b64_tr_b16 v[172:173], v95 offset:3072
    ds_read_b64_tr_b16 v[174:175], v95 offset:3584
    ds_read_b64_tr_b16 v[176:177], v95 offset:4096
    ds_read_b64_tr_b16 v[178:179], v95 offset:4608
    ds_read_b64_tr_b16 v[180:181], v95 offset:5120
    ds_read_b64_tr_b16 v[182:183], v95 offset:5632
    ds_read_b64_tr_b16 v[184:185], v95 offset:6144
    ds_read_b64_tr_b16 v[186:187], v95 offset:6656
    ds_read_b64_tr_b16 v[188:189], v95 offset:7168
    ds_read_b64_tr_b16 v[190:191], v95 offset:7680
    s_waitcnt lgkmcnt(0)
role_42:
L_layer:
    s_cmp_lg_u32 s21, 0
    s_cbranch_scc1 ie_43
    s_barrier
    ds_read_b128 v[24:27], v4 offset:0
    ds_read_b128 v[28:31], v3 offset:0
    ds_read_b128 v[32:35], v4 offset:1024
    ds_read_b128 v[36:39], v3 offset:1024
    ds_read_b128 v[100:103], v4 offset:2048
    ds_read_b128 v[104:107], v3 offset:2048
    ds_read_b128 v[108:111], v4 offset:3072
    ds_read_b128 v[112:115], v3 offset:3072
    s_waitcnt lgkmcnt(6)
    v_mfma_f32_32x32x16_bf16 v[40:55], v[128:131], v[24:27], 0
    v_mfma_f32_32x32x16_bf16 v[56:71], v[128:131], v[28:31], 0
    s_barrier
    ds_read_b128 v[24:27], v4 offset:4096
    ds_read_b128 v[28:31], v3 offset:4096
    s_waitcnt lgkmcnt(6)
    v_mfma_f32_32x32x16_bf16 v[40:55], v[132:135], v[32:35], v[40:55]
    v_mfma_f32_32x32x16_bf16 v[56:71], v[132:135], v[36:39], v[56:71]
    ds_read_b128 v[32:35], v4 offset:5120
    ds_read_b128 v[36:39], v3 offset:5120
    s_waitcnt lgkmcnt(6)
    v_mfma_f32_32x32x16_bf16 v[40:55], v[136:139], v[100:103], v[40:55]
    v_mfma_f32_32x32x16_bf16 v[56:71], v[136:139], v[104:107], v[56:71]
    ds_read_b128 v[100:103], v4 offset:6144
    ds_read_b128 v[104:107], v3 offset:6144
    s_waitcnt lgkmcnt(6)
    v_mfma_f32_32x32x16_bf16 v[40:55], v[140:143], v[108:111], v[40:55]
    v_mfma_f32_32x32x16_bf16 v[56:71], v[140:143], v[112:115], v[56:71]
    ds_read_b128 v[108:111], v4 offset:7168
    ds_read_b128 v[112:115], v3 offset:7168
    s_waitcnt lgkmcnt(6)
    v_mfma_f32_32x32x16_bf16 v[40:55], v[144:147], v[24:27], v[40:55]
    v_mfma_f32_32x32x16_bf16 v[56:71], v[144:147], v[28:31], v[56:71]
    s_barrier
    ds_read_b128 v[24:27], v4 offset:8192
    ds_read_b128 v[28:31], v3 offset:8192
    s_waitcnt lgkmcnt(6)
    v_mfma_f32_32x32x16_bf16 v[40:55], v[148:151], v[32:35], v[40:55]
    v_mfma_f32_32x32x16_bf16 v[56:71], v[148:151], v[36:39], v[56:71]
    ds_read_b128 v[32:35], v4 offset:9216
    ds_read_b128 v[36:39], v3 offset:9216
    s_waitcnt lgkmcnt(6)
    v_mfma_f32_32x32x16_bf16 v[40:55], v[152:155], v[100:103], v[40:55]
    v_mfma_f32_32x32x16_bf16 v[56:71], v[152:155], v[104:107], v[56:71]
    ds_read_b128 v[100:103], v4 offset:10240
    ds_read_b128 v[104:107], v3 offset:10240
    s_waitcnt lgkmcnt(6)
    v_mfma_f32_32x32x16_bf16 v[40:55], v[156:159], v[108:111], v[40:55]
    v_mfma_f32_32x32x16_bf16 v[56:71], v[156:159], v[112:115], v[56:71]
    ds_read_b128 v[108:111], v4 offset:11264
    ds_read_b128 v[112:115], v3 offset:11264
    s_waitcnt lgkmcnt(6)
    v_mfma_f32_32x32x16_bf16 v[40:55], v[160:163], v[24:27], v[40:55]
    v_mfma_f32_32x32x16_bf16 v[56:71], v[160:163], v[28:31], v[56:71]
    s_barrier
    ds_read_b128 v[24:27], v4 offset:12288
    ds_read_b128 v[28:31], v3 offset:12288
    s_waitcnt lgkmcnt(6)
    v_mfma_f32_32x32x16_bf16 v[40:55], v[164:167], v[32:35], v[40:55]
    v_mfma_f32_32x32x16_bf16 v[56:71], v[164:167], v[36:39], v[56:71]
    ds_read_b128 v[32:35], v4 offset:13312
    ds_read_b128 v[36:39], v3 offset:13312
    s_waitcnt lgkmcnt(6)
    v_mfma_f32_32x32x16_bf16 v[40:55], v[168:171], v[100:103], v[40:55]
    v_mfma_f32_32x32x16_bf16 v[56:71], v[168:171], v[104:107], v[56:71]
    ds_read_b128 v[100:103], v4 offset:14336
    ds_read_b128 v[104:107], v3 offset:14336
    s_waitcnt lgkmcnt(6)
    v_mfma_f32_32x32x16_bf16 v[40:55], v[172:175], v[108:111], v[40:55]
    v_mfma_f32_32x32x16_bf16 v[56:71], v[172:175], v[112:115], v[56:71]
    ds_read_b128 v[108:111], v4 offset:15360
    ds_read_b128 v[112:115], v3 offset:15360
    s_waitcnt lgkmcnt(6)
    v_mfma_f32_32x32x16_bf16 v[40:55], v[176:179], v[24:27], v[40:55]
    v_mfma_f32_32x32x16_bf16 v[56:71], v[176:179], v[28:31], v[56:71]
    s_waitcnt lgkmcnt(4)
    v_mfma_f32_32x32x16_bf16 v[40:55], v[180:183], v[32:35], v[40:55]
    v_mfma_f32_32x32x16_bf16 v[56:71], v[180:183], v[36:39], v[56:71]
    s_waitcnt lgkmcnt(2)
    v_mfma_f32_32x32x16_bf16 v[40:55], v[184:187], v[100:103], v[40:55]
    v_mfma_f32_32x32x16_bf16 v[56:71], v[184:187], v[104:107], v[56:71]
    s_waitcnt lgkmcnt(0)
    v_mfma_f32_32x32x16_bf16 v[40:55], v[188:191], v[108:111], v[40:55]
    v_mfma_f32_32x32x16_bf16 v[56:71], v[188:191], v[112:115], v[56:71]
    s_lshl_b32 s24, s20, 13
    s_mul_i32 s25, s19, 6144
    s_add_u32 s24, s24, s25
    s_add_u32 s24, s24, 65536
    v_add_u32 v5, s24, v2
    v_xor_b32 v6, 4096, v5
    s_nop 6
    ds_write_b128 v5, v[48:51] offset:16384
    ds_write_b128 v5, v[52:55] offset:17408
    ds_write_b128 v6, v[56:59] offset:0
    ds_write_b128 v6, v[60:63] offset:1024
    ds_write_b128 v6, v[64:67] offset:16384
    ds_write_b128 v6, v[68:71] offset:17408
    s_branch ie_44
ie_43:
    s_lshl_b32 s65, s38, 4
    s_add_u32 s65, s65, s32
    s_mov_b32 s63, 0
    buffer_load_dwordx2 v[8:9], v98, s[4:7], 0 offen sc1
cw_45:
    s_add_u32 s63, s63, 1
    s_cmp_gt_u32 s63, 200000
    s_cbranch_scc1 L_end
    s_sleep 1
    buffer_load_dwordx2 v[92:93], v98, s[4:7], 0 offen sc1
    s_waitcnt vmcnt(1)
    v_subrev_u32 v8, s65, v8
    v_xor_b32 v9, s33, v9
    v_lshrrev_b32 v8, 12, v8
    v_or_b32 v7, v8, v9
    v_cmp_ne_u32 vcc, 0, v7
    s_cbranch_vccz co_46
    s_sleep 1
    buffer_load_dwordx2 v[8:9], v98, s[4:7], 0 offen sc1
    s_waitcnt vmcnt(1)
    v_subrev_u32 v92, s65, v92
    v_xor_b32 v93, s33, v93
    v_lshrrev_b32 v92, 12, v92
    v_or_b32 v7, v92, v93
    v_cmp_ne_u32 vcc, 0, v7
    s_cbranch_vccnz cw_45
co_46:
    s_lshl_b32 s85, s19, 15
    s_lshl_b32 s26, s20, 14
    s_add_u32 s85, s85, s26
    s_add_u32 s84, s73, s81
    s_add_u32 s84, s84, s85
    s_mov_b32 m0, s85
    s_add_u32 s85, s85, 4096
    buffer_load_dwordx4 v2, s[4:7], s84 offen offset:0 sc1 lds
    buffer_load_dwordx4 v2, s[4:7], s84 offen offset:1024 sc1 lds
    buffer_load_dwordx4 v2, s[4:7], s84 offen offset:2048 sc1 lds
    buffer_load_dwordx4 v2, s[4:7], s84 offen offset:3072 sc1 lds
    s_add_u32 s84, s84, 4096
    s_mov_b32 m0, s85
    s_add_u32 s85, s85, 4096
    buffer_load_dwordx4 v2, s[4:7], s84 offen offset:0 sc1 lds
    buffer_load_dwordx4 v2, s[4:7], s84 offen offset:1024 sc1 lds
    buffer_load_dwordx4 v2, s[4:7], s84 offen offset:2048 sc1 lds
    buffer_load_dwordx4 v2, s[4:7], s84 offen offset:3072 sc1 lds
    s_add_u32 s84, s84, 4096
    s_waitcnt vmcnt(4)
    s_barrier
    s_mov_b32 m0, s85
    s_add_u32 s85, s85, 4096
    buffer_load_dwordx4 v2, s[4:7], s84 offen offset:0 sc1 lds
    buffer_load_dwordx4 v2, s[4:7], s84 offen offset:1024 sc1 lds
    buffer_load_dwordx4 v2, s[4:7], s84 offen offset:2048 sc1 lds
    buffer_load_dwordx4 v2, s[4:7], s84 offen offset:3072 sc1 lds
    s_add_u32 s84, s84, 4096
    s_waitcnt vmcnt(4)
    s_barrier
    s_mov_b32 m0, s85
    s_add_u32 s85, s85, 4096
    buffer_load_dwordx4 v2, s[4:7], s84 offen offset:0 sc1 lds
    buffer_load_dwordx4 v2, s[4:7], s84 offen offset:1024 sc1 lds
    buffer_load_dwordx4 v2, s[4:7], s84 offen offset:2048 sc1 lds
    buffer_load_dwordx4 v2, s[4:7], s84 offen offset:3072 sc1 lds
    s_add_u32 s84, s84, 4096
    s_cmp_eq_u32 s34, 1
    s_cselect_b32 s12, s52, s50
    s_cselect_b32 s13, s53, s51
    s_mov_b32 s14, 0x4000
    s_mov_b32 s15, 0x00020000
    s_and_b32 s24, s18, 3
    s_lshl_b32 s24, s24, 12
    s_add_u32 m0, s24, 135168
    s_nop 0
    buffer_load_dwordx4 v2, s[12:15], s24 offen offset:0 lds
    buffer_load_dwordx4 v2, s[12:15], s24 offen offset:1024 lds
    buffer_load_dwordx4 v2, s[12:15], s24 offen offset:2048 lds
    buffer_load_dwordx4 v2, s[12:15], s24 offen offset:3072 lds
    s_waitcnt vmcnt(8)
    s_barrier
    s_waitcnt vmcnt(4)
    s_barrier
    s_waitcnt vmcnt(0)
ie_44:
    s_xor_b32 s73, s73, 0x200000
    s_waitcnt lgkmcnt(0)
    s_barrier
    s_lshl_b32 s24, s18, 12
    s_add_u32 s24, s24, 65536
    v_add_u32 v5, s24, v2
    s_cmp_eq_u32 s21, 0
    s_cbranch_scc1 rr_47
    ds_read_b128 v[40:43], v5 offset:0
    ds_read_b128 v[44:47], v5 offset:1024
    ds_read_b128 v[48:51], v5 offset:2048
    ds_read_b128 v[52:55], v5 offset:3072
    s_waitcnt lgkmcnt(0)
    v_pk_add_f32 v[40:41], v[40:41], v[48:49]
    v_pk_add_f32 v[42:43], v[42:43], v[50:51]
    v_pk_add_f32 v[44:45], v[44:45], v[52:53]
    v_pk_add_f32 v[46:47], v[46:47], v[54:55]
    s_branch rr_48
rr_47:
    s_xor_b32 s24, s19, 1
    s_lshl_b32 s24, s24, 11
    v_add_u32 v5, s24, v5
    ds_read_b128 v[56:59], v5
    ds_read_b128 v[60:63], v5 offset:1024
    s_waitcnt lgkmcnt(0)
    v_pk_add_f32 v[40:41], v[40:41], v[56:57]
    v_pk_add_f32 v[42:43], v[42:43], v[58:59]
    v_pk_add_f32 v[44:45], v[44:45], v[60:61]
    v_pk_add_f32 v[46:47], v[46:47], v[62:63]
rr_48:
    v_lshlrev_b32 v48, 16, v20
    v_and_b32 v49, 0xffff0000, v20
    v_lshlrev_b32 v50, 16, v21
    v_and_b32 v51, 0xffff0000, v21
    v_lshlrev_b32 v52, 16, v22
    v_and_b32 v53, 0xffff0000, v22
    v_lshlrev_b32 v54, 16, v23
    v_and_b32 v55, 0xffff0000, v23
    v_pk_add_f32 v[40:41], v[40:41], v[48:49]
    v_pk_add_f32 v[42:43], v[42:43], v[50:51]
    v_pk_add_f32 v[44:45], v[44:45], v[52:53]
    v_pk_add_f32 v[46:47], v[46:47], v[54:55]
    v_cvt_pk_bf16_f32 v20, v40, v41
    v_cvt_pk_bf16_f32 v21, v42, v43
    v_cvt_pk_bf16_f32 v22, v44, v45
    v_cvt_pk_bf16_f32 v23, v46, v47
    s_add_u32 s24, s22, s73
    s_cmp_eq_u32 s62, 1
    s_cbranch_scc1 fs_49
    buffer_store_dwordx4 v[20:23], v2, s[4:7], s24 offen sc1
    s_branch fs_50
fs_49:
    buffer_store_dwordx4 v[20:23], v2, s[4:7], s24 offen
fs_50:
    v_mov_b32 v6, 0
    v_mov_b32 v7, 0
    s_nop 0
    v_dot2_f32_bf16 v6, v20, v0, v6
    v_dot2_f32_bf16 v7, v20, v20, v7
    v_dot2_f32_bf16 v6, v21, v0, v6
    v_dot2_f32_bf16 v7, v21, v21, v7
    v_dot2_f32_bf16 v6, v22, v0, v6
    v_dot2_f32_bf16 v7, v22, v22, v7
    v_dot2_f32_bf16 v6, v23, v0, v6
    v_dot2_f32_bf16 v7, v23, v23, v7
    s_bfe_u32 s24, s22, 0x5000a
    s_lshl_b32 s24, s24, 9
    s_lshr_b32 s25, s81, 2
    s_add_u32 s24, s24, s25
    s_lshl_b32 s25, s19, 8
    s_add_u32 s24, s24, s25
    s_add_u32 s24, s24, s74
    v_mov_b32 v8, v6
    v_mov_b32 v9, v7
    v_lshlrev_b32 v5, 3, v1
    s_nop 0
    v_permlane32_swap_b32 v6, v8
    v_permlane32_swap_b32 v7, v9
    s_nop 1
    v_pk_add_f32 v[6:7], v[6:7], v[8:9]
    s_mov_b32 exec_hi, 0
    s_cmp_eq_u32 s62, 1
    s_cbranch_scc1 fs_51
    buffer_store_dwordx2 v[6:7], v5, s[4:7], s24 offen sc1
    s_branch fs_52
fs_51:
    buffer_store_dwordx2 v[6:7], v5, s[4:7], s24 offen
fs_52:
    s_mov_b32 exec_hi, -1
    s_add_u32 s38, s38, 1
    s_lshl_b32 s24, s38, 4
    s_add_u32 s24, s24, s32
    s_add_u32 s24, s24, s91
    v_mov_b32 v6, s24
    v_mov_b32 v7, s33
    s_waitcnt vmcnt(0) lgkmcnt(0)
    s_mov_b64 exec, 1
    s_cmp_eq_u32 s62, 1
    s_cbranch_scc1 fs_53
    buffer_store_dwordx2 v[6:7], v96, s[4:7], 0 offen sc1
    s_branch fs_54
fs_53:
    buffer_store_dwordx2 v[6:7], v96, s[4:7], 0 offen
fs_54:
    s_mov_b64 exec, -1
    s_add_u32 s39, s39, 1
    s_cmp_eq_u32 s21, 1
    s_cbranch_scc1 b1b_55
    s_cmp_eq_u32 s18, 3
    s_cbranch_scc1 b13_56
    s_lshl_b32 s65, s38, 4
    s_add_u32 s65, s65, s32
    s_mov_b32 s63, 0
    buffer_load_dwordx2 v[8:9], v98, s[4:7], 0 offen sc1
cw_59:
    s_add_u32 s63, s63, 1
    s_cmp_gt_u32 s63, 200000
    s_cbranch_scc1 L_end
    s_sleep 1
    buffer_load_dwordx2 v[92:93], v98, s[4:7], 0 offen sc1
    s_waitcnt vmcnt(1)
    v_subrev_u32 v8, s65, v8
    v_xor_b32 v9, s33, v9
    v_lshrrev_b32 v8, 12, v8
    v_or_b32 v7, v8, v9
    v_cmp_ne_u32 vcc, 0, v7
    s_cbranch_vccz co_60
    s_sleep 1
    buffer_load_dwordx2 v[8:9], v98, s[4:7], 0 offen sc1
    s_waitcnt vmcnt(1)
    v_subrev_u32 v92, s65, v92
    v_xor_b32 v93, s33, v93
    v_lshrrev_b32 v92, 12, v92
    v_or_b32 v7, v92, v93
    v_cmp_ne_u32 vcc, 0, v7
    s_cbranch_vccnz cw_59
co_60:
    s_lshl_b32 s85, s19, 15
    s_lshl_b32 s26, s20, 14
    s_add_u32 s85, s85, s26
    s_add_u32 s84, s73, s81
    s_add_u32 s84, s84, s85
    s_mov_b32 m0, s85
    s_add_u32 s85, s85, 4096
    buffer_load_dwordx4 v2, s[4:7], s84 offen offset:0 sc1 lds
    buffer_load_dwordx4 v2, s[4:7], s84 offen offset:1024 sc1 lds
    buffer_load_dwordx4 v2, s[4:7], s84 offen offset:2048 sc1 lds
    buffer_load_dwordx4 v2, s[4:7], s84 offen offset:3072 sc1 lds
    s_add_u32 s84, s84, 4096
    s_mov_b32 m0, s85
    s_add_u32 s85, s85, 4096
    buffer_load_dwordx4 v2, s[4:7], s84 offen offset:0 sc1 lds
    buffer_load_dwordx4 v2, s[4:7], s84 offen offset:1024 sc1 lds
    buffer_load_dwordx4 v2, s[4:7], s84 offen offset:2048 sc1 lds
    buffer_load_dwordx4 v2, s[4:7], s84 offen offset:3072 sc1 lds
    s_add_u32 s84, s84, 4096
    s_waitcnt vmcnt(4)
    s_barrier
    s_mov_b32 m0, s85
    s_add_u32 s85, s85, 4096
    buffer_load_dwordx4 v2, s[4:7], s84 offen offset:0 sc1 lds
    buffer_load_dwordx4 v2, s[4:7], s84 offen offset:1024 sc1 lds
    buffer_load_dwordx4 v2, s[4:7], s84 offen offset:2048 sc1 lds
    buffer_load_dwordx4 v2, s[4:7], s84 offen offset:3072 sc1 lds
    s_add_u32 s84, s84, 4096
    s_waitcnt vmcnt(4)
    s_barrier
    s_mov_b32 m0, s85
    s_add_u32 s85, s85, 4096
    buffer_load_dwordx4 v2, s[4:7], s84 offen offset:0 sc1 lds
    buffer_load_dwordx4 v2, s[4:7], s84 offen offset:1024 sc1 lds
    buffer_load_dwordx4 v2, s[4:7], s84 offen offset:2048 sc1 lds
    buffer_load_dwordx4 v2, s[4:7], s84 offen offset:3072 sc1 lds
    s_add_u32 s84, s84, 4096
    s_waitcnt vmcnt(4)
    s_barrier
    v_lshlrev_b32 v5, 3, v1
    v_add_u32 v5, 131072, v5
    ds_read2st64_b64 v[80:83], v5 offset0:0 offset1:1
    ds_read2st64_b64 v[84:87], v5 offset0:2 offset1:3
    s_waitcnt vmcnt(0)
    s_barrier
    s_waitcnt lgkmcnt(0)
    v_pk_add_f32 v[80:81], v[80:81], v[84:85]
    v_pk_add_f32 v[82:83], v[82:83], v[86:87]
    v_pk_add_f32 v[10:11], v[80:81], v[82:83]
    v_mul_f32 v10, 0x3b000000, v10
    v_mul_f32 v11, 0x3b000000, v11
    v_fma_f32 v11, -v10, v10, v11
    v_max_f32 v11, 0, v11
    v_cvt_pk_bf16_f32 v11, v11, v11
    v_and_b32 v11, 0xffff0000, v11
    v_add_f32 v11, 0x3727c5ac, v11
    v_cvt_pk_bf16_f32 v11, v11, v11
    v_and_b32 v11, 0xffff0000, v11
    v_sqrt_f32 v11, v11
    s_nop 0
    v_cvt_pk_bf16_f32 v11, v11, v11
    v_and_b32 v11, 0xffff0000, v11
    v_rcp_f32 v11, v11
    v_cvt_pk_bf16_f32 v10, v10, v10
    v_and_b32 v10, 0xffff0000, v10
    v_mov_b32 v8, v10
    v_mov_b32 v9, v11
    s_cmp_eq_u32 s19, 1
    s_cselect_b64 s[26:27], -1, 0
    v_permlane32_swap_b32 v10, v8
    v_permlane32_swap_b32 v11, v9
    s_nop 1
    v_cndmask_b32_e64 v11, v11, v9, s[26:27]
    s_branch b1e_58
b1b_55:
    s_lshl_b32 s65, s38, 4
    s_add_u32 s65, s65, s32
    s_mov_b32 s63, 0
    buffer_load_dwordx2 v[8:9], v98, s[4:7], 0 offen sc1
cw_61:
    s_add_u32 s63, s63, 1
    s_cmp_gt_u32 s63, 200000
    s_cbranch_scc1 L_end
    s_sleep 1
    buffer_load_dwordx2 v[92:93], v98, s[4:7], 0 offen sc1
    s_waitcnt vmcnt(1)
    v_subrev_u32 v8, s65, v8
    v_xor_b32 v9, s33, v9
    v_lshrrev_b32 v8, 12, v8
    v_or_b32 v7, v8, v9
    v_cmp_ne_u32 vcc, 0, v7
    s_cbranch_vccz co_62
    s_sleep 1
    buffer_load_dwordx2 v[8:9], v98, s[4:7], 0 offen sc1
    s_waitcnt vmcnt(1)
    v_subrev_u32 v92, s65, v92
    v_xor_b32 v93, s33, v93
    v_lshrrev_b32 v92, 12, v92
    v_or_b32 v7, v92, v93
    v_cmp_ne_u32 vcc, 0, v7
    s_cbranch_vccnz cw_61
co_62:
    v_lshlrev_b32 v5, 3, v1
    s_lshr_b32 s24, s81, 2
    s_and_b32 s25, s18, 3
    s_lshl_b32 s25, s25, 12
    s_add_u32 s24, s24, s25
    s_add_u32 s24, s24, s74
    buffer_load_dwordx2 v[80:81], v5, s[4:7], s24 offen offset:0 sc1
    buffer_load_dwordx2 v[82:83], v5, s[4:7], s24 offen offset:512 sc1
    buffer_load_dwordx2 v[84:85], v5, s[4:7], s24 offen offset:1024 sc1
    buffer_load_dwordx2 v[86:87], v5, s[4:7], s24 offen offset:1536 sc1
    buffer_load_dwordx2 v[88:89], v5, s[4:7], s24 offen offset:2048 sc1
    buffer_load_dwordx2 v[90:91], v5, s[4:7], s24 offen offset:2560 sc1
    buffer_load_dwordx2 v[92:93], v5, s[4:7], s24 offen offset:3072 sc1
    buffer_load_dwordx2 v[94:95], v5, s[4:7], s24 offen offset:3584 sc1
    s_barrier
    ds_read_b128 v[24:27], v4 offset:0
    ds_read_b128 v[28:31], v3 offset:0
    ds_read_b128 v[32:35], v4 offset:1024
    ds_read_b128 v[36:39], v3 offset:1024
    ds_read_b128 v[100:103], v4 offset:2048
    ds_read_b128 v[104:107], v3 offset:2048
    ds_read_b128 v[108:111], v4 offset:3072
    ds_read_b128 v[112:115], v3 offset:3072
    s_waitcnt lgkmcnt(6)
    v_mfma_f32_32x32x16_bf16 v[40:55], v[192:195], v[24:27], 0
    v_mfma_f32_32x32x16_bf16 v[56:71], v[192:195], v[28:31], 0
    s_barrier
    ds_read_b128 v[24:27], v4 offset:4096
    ds_read_b128 v[28:31], v3 offset:4096
    s_waitcnt lgkmcnt(6)
    v_mfma_f32_32x32x16_bf16 v[40:55], v[196:199], v[32:35], v[40:55]
    v_mfma_f32_32x32x16_bf16 v[56:71], v[196:199], v[36:39], v[56:71]
    ds_read_b128 v[32:35], v4 offset:5120
    ds_read_b128 v[36:39], v3 offset:5120
    s_waitcnt lgkmcnt(6)
    v_mfma_f32_32x32x16_bf16 v[40:55], v[200:203], v[100:103], v[40:55]
    v_mfma_f32_32x32x16_bf16 v[56:71], v[200:203], v[104:107], v[56:71]
    ds_read_b128 v[100:103], v4 offset:6144
    ds_read_b128 v[104:107], v3 offset:6144
    s_waitcnt lgkmcnt(6)
    v_mfma_f32_32x32x16_bf16 v[40:55], v[204:207], v[108:111], v[40:55]
    v_mfma_f32_32x32x16_bf16 v[56:71], v[204:207], v[112:115], v[56:71]
    ds_read_b128 v[108:111], v4 offset:7168
    ds_read_b128 v[112:115], v3 offset:7168
    s_waitcnt lgkmcnt(6)
    v_mfma_f32_32x32x16_bf16 v[40:55], v[208:211], v[24:27], v[40:55]
    v_mfma_f32_32x32x16_bf16 v[56:71], v[208:211], v[28:31], v[56:71]
    s_waitcnt vmcnt(0)
    v_pk_add_f32 v[80:81], v[80:81], v[88:89]
    v_pk_add_f32 v[82:83], v[82:83], v[90:91]
    v_pk_add_f32 v[84:85], v[84:85], v[92:93]
    v_pk_add_f32 v[86:87], v[86:87], v[94:95]
    v_pk_add_f32 v[80:81], v[80:81], v[84:85]
    v_pk_add_f32 v[82:83], v[82:83], v[86:87]
    v_pk_add_f32 v[80:81], v[80:81], v[82:83]
    s_and_b32 s24, s18, 3
    s_lshl_b32 s24, s24, 9
    s_add_u32 s24, s24, 131072
    v_lshlrev_b32 v5, 3, v1
    v_add_u32 v5, s24, v5
    ds_write_b64 v5, v[80:81]
    s_waitcnt lgkmcnt(0)
    s_barrier
    ds_read_b128 v[24:27], v4 offset:8192
    ds_read_b128 v[28:31], v3 offset:8192
    s_waitcnt lgkmcnt(6)
    v_mfma_f32_32x32x16_bf16 v[40:55], v[212:215], v[32:35], v[40:55]
    v_mfma_f32_32x32x16_bf16 v[56:71], v[212:215], v[36:39], v[56:71]
    v_lshlrev_b32 v5, 3, v1
    v_add_u32 v5, 131072, v5
    ds_read2st64_b64 v[80:83], v5 offset0:0 offset1:1
    ds_read2st64_b64 v[84:87], v5 offset0:2 offset1:3
    ds_read_b128 v[32:35], v4 offset:9216
    ds_read_b128 v[36:39], v3 offset:9216
    s_waitcnt lgkmcnt(6)
    v_mfma_f32_32x32x16_bf16 v[40:55], v[216:219], v[100:103], v[40:55]
    v_mfma_f32_32x32x16_bf16 v[56:71], v[216:219], v[104:107], v[56:71]
    ds_read_b128 v[100:103], v4 offset:10240
    ds_read_b128 v[104:107], v3 offset:10240
    s_waitcnt lgkmcnt(6)
    v_mfma_f32_32x32x16_bf16 v[40:55], v[220:223], v[108:111], v[40:55]
    v_mfma_f32_32x32x16_bf16 v[56:71], v[220:223], v[112:115], v[56:71]
    ds_read_b128 v[108:111], v4 offset:11264
    ds_read_b128 v[112:115], v3 offset:11264
    s_waitcnt lgkmcnt(6)
    v_mfma_f32_32x32x16_bf16 v[40:55], v[224:227], v[24:27], v[40:55]
    v_mfma_f32_32x32x16_bf16 v[56:71], v[224:227], v[28:31], v[56:71]
    s_barrier
    ds_read_b128 v[24:27], v4 offset:12288
    ds_read_b128 v[28:31], v3 offset:12288
    s_waitcnt lgkmcnt(6)
    v_mfma_f32_32x32x16_bf16 v[40:55], v[228:231], v[32:35], v[40:55]
    v_mfma_f32_32x32x16_bf16 v[56:71], v[228:231], v[36:39], v[56:71]
    ds_read_b128 v[32:35], v4 offset:13312
    ds_read_b128 v[36:39], v3 offset:13312
    s_waitcnt lgkmcnt(6)
    v_mfma_f32_32x32x16_bf16 v[40:55], v[232:235], v[100:103], v[40:55]
    v_mfma_f32_32x32x16_bf16 v[56:71], v[232:235], v[104:107], v[56:71]
    v_pk_add_f32 v[80:81], v[80:81], v[84:85]
    v_pk_add_f32 v[82:83], v[82:83], v[86:87]
    v_pk_add_f32 v[10:11], v[80:81], v[82:83]
    v_mul_f32 v10, 0x3b000000, v10
    v_mul_f32 v11, 0x3b000000, v11
    v_fma_f32 v11, -v10, v10, v11
    v_max_f32 v11, 0, v11
    v_cvt_pk_bf16_f32 v11, v11, v11
    v_and_b32 v11, 0xffff0000, v11
    v_add_f32 v11, 0x3727c5ac, v11
    v_cvt_pk_bf16_f32 v11, v11, v11
    v_and_b32 v11, 0xffff0000, v11
    v_sqrt_f32 v11, v11
    s_nop 0
    v_cvt_pk_bf16_f32 v11, v11, v11
    v_and_b32 v11, 0xffff0000, v11
    v_rcp_f32 v11, v11
    v_cvt_pk_bf16_f32 v10, v10, v10
    v_and_b32 v10, 0xffff0000, v10
    ds_read_b128 v[100:103], v4 offset:14336
    ds_read_b128 v[104:107], v3 offset:14336
    s_waitcnt lgkmcnt(6)
    v_mfma_f32_32x32x16_bf16 v[40:55], v[236:239], v[108:111], v[40:55]
    v_mfma_f32_32x32x16_bf16 v[56:71], v[236:239], v[112:115], v[56:71]
    v_mov_b32 v8, v10
    v_mov_b32 v9, v11
    s_cmp_eq_u32 s19, 1
    s_cselect_b64 s[26:27], -1, 0
    v_permlane32_swap_b32 v10, v8
    v_permlane32_swap_b32 v11, v9
    s_nop 1
    v_cndmask_b32_e64 v11, v11, v9, s[26:27]
    v_cndmask_b32_e64 v9, v10, v8, s[26:27]
    v_cndmask_b32_e64 v8, v8, v10, s[26:27]
    v_cvt_pk_bf16_f32 v72, -v9, -v9
    v_cvt_pk_bf16_f32 v73, -v9, -v9
    v_mov_b32 v74, 0
    v_mov_b32 v75, 0
    v_cvt_pk_bf16_f32 v76, -v8, -v8
    v_cvt_pk_bf16_f32 v77, -v8, -v8
    v_mov_b32 v78, 0
    v_mov_b32 v79, 0
    ds_read_b128 v[108:111], v4 offset:15360
    ds_read_b128 v[112:115], v3 offset:15360
    s_waitcnt lgkmcnt(6)
    v_mfma_f32_32x32x16_bf16 v[40:55], v[240:243], v[24:27], v[40:55]
    v_mfma_f32_32x32x16_bf16 v[56:71], v[240:243], v[28:31], v[56:71]
    s_waitcnt lgkmcnt(4)
    v_mfma_f32_32x32x16_bf16 v[40:55], v[244:247], v[32:35], v[40:55]
    v_mfma_f32_32x32x16_bf16 v[56:71], v[244:247], v[36:39], v[56:71]
    s_waitcnt lgkmcnt(2)
    v_mfma_f32_32x32x16_bf16 v[40:55], v[248:251], v[100:103], v[40:55]
    v_mfma_f32_32x32x16_bf16 v[56:71], v[248:251], v[104:107], v[56:71]
    s_waitcnt lgkmcnt(0)
    v_mfma_f32_32x32x16_bf16 v[40:55], v[252:255], v[108:111], v[40:55]
    v_mfma_f32_32x32x16_bf16 v[56:71], v[252:255], v[112:115], v[56:71]
    v_mfma_f32_32x32x16_bf16 v[40:55], v[16:19], v[72:75], v[40:55]
    v_mfma_f32_32x32x16_bf16 v[56:71], v[16:19], v[76:79], v[56:71]
    s_lshl_b32 s24, s20, 13
    s_mul_i32 s25, s19, 6144
    s_add_u32 s24, s24, s25
    s_add_u32 s24, s24, 65536
    v_add_u32 v5, s24, v2
    v_xor_b32 v6, 4096, v5
    s_nop 6
    ds_write_b128 v5, v[40:43] offset:0
    ds_write_b128 v5, v[44:47] offset:1024
    ds_write_b128 v6, v[56:59] offset:0
    ds_write_b128 v6, v[60:63] offset:1024
    ds_write_b128 v6, v[64:67] offset:16384
    ds_write_b128 v6, v[68:71] offset:17408
    s_branch b1e_58
b13_56:
    v_and_b32 v6, 15, v1
    v_lshlrev_b32 v6, 4, v6
    v_bfe_u32 v5, v1, 4, 1
    v_lshl_add_u32 v6, v5, 9, v6
    v_lshrrev_b32 v5, 5, v1
    v_lshl_add_u32 v6, v5, 10, v6
    s_lshr_b32 s24, s35, 1
    s_lshl_b32 s24, s24, 15
    s_and_b32 s25, s35, 1
    s_lshl_b32 s25, s25, 8
    s_add_u32 s24, s24, s25
    v_add_u32 v6, s24, v6
    s_cmp_eq_u32 s34, 1
    s_cbranch_scc1 b13v_57
    s_lshl_b32 s65, s38, 4
    s_add_u32 s65, s65, s32
    s_mov_b32 s63, 0
    buffer_load_dwordx2 v[8:9], v98, s[4:7], 0 offen sc1
cw_63:
    s_add_u32 s63, s63, 1
    s_cmp_gt_u32 s63, 200000
    s_cbranch_scc1 L_end
    s_sleep 1
    buffer_load_dwordx2 v[92:93], v98, s[4:7], 0 offen sc1
    s_waitcnt vmcnt(1)
    v_subrev_u32 v8, s65, v8
    v_xor_b32 v9, s33, v9
    v_lshrrev_b32 v8, 12, v8
    v_or_b32 v7, v8, v9
    v_cmp_ne_u32 vcc, 0, v7
    s_cbranch_vccz co_64
    s_sleep 1
    buffer_load_dwordx2 v[8:9], v98, s[4:7], 0 offen sc1
    s_waitcnt vmcnt(1)
    v_subrev_u32 v92, s65, v92
    v_xor_b32 v93, s33, v93
    v_lshrrev_b32 v92, 12, v92
    v_or_b32 v7, v92, v93
    v_cmp_ne_u32 vcc, 0, v7
    s_cbranch_vccnz cw_63
co_64:
    s_lshl_b32 s85, s19, 15
    s_lshl_b32 s26, s20, 14
    s_add_u32 s85, s85, s26
    s_add_u32 s84, s73, s81
    s_add_u32 s84, s84, s85
    s_mov_b32 m0, s85
    s_add_u32 s85, s85, 4096
    buffer_load_dwordx4 v2, s[4:7], s84 offen offset:0 sc1 lds
    buffer_load_dwordx4 v2, s[4:7], s84 offen offset:1024 sc1 lds
    buffer_load_dwordx4 v2, s[4:7], s84 offen offset:2048 sc1 lds
    buffer_load_dwordx4 v2, s[4:7], s84 offen offset:3072 sc1 lds
    s_add_u32 s84, s84, 4096
    s_mov_b32 m0, s85
    s_add_u32 s85, s85, 4096
    buffer_load_dwordx4 v2, s[4:7], s84 offen offset:0 sc1 lds
    buffer_load_dwordx4 v2, s[4:7], s84 offen offset:1024 sc1 lds
    buffer_load_dwordx4 v2, s[4:7], s84 offen offset:2048 sc1 lds
    buffer_load_dwordx4 v2, s[4:7], s84 offen offset:3072 sc1 lds
    s_add_u32 s84, s84, 4096
    s_waitcnt vmcnt(4)
    s_barrier
    s_mov_b32 m0, s85
    s_add_u32 s85, s85, 4096
    buffer_load_dwordx4 v2, s[4:7], s84 offen offset:0 sc1 lds
    buffer_load_dwordx4 v2, s[4:7], s84 offen offset:1024 sc1 lds
    buffer_load_dwordx4 v2, s[4:7], s84 offen offset:2048 sc1 lds
    buffer_load_dwordx4 v2, s[4:7], s84 offen offset:3072 sc1 lds
    s_add_u32 s84, s84, 4096
    v_lshrrev_b32 v5, 5, v1
    v_lshlrev_b32 v5, 9, v5
    v_bfe_u32 v7, v1, 4, 1
    v_lshl_add_u32 v5, v7, 7, v5
    v_bfe_u32 v7, v1, 2, 2
    v_lshl_add_u32 v5, v7, 5, v5
    v_and_b32 v7, 3, v1
    v_lshl_add_u32 v5, v7, 3, v5
    v_add_u32 v5, 135168, v5
    ds_read_b64_tr_b16 v[192:193], v5 offset:0
    ds_read_b64_tr_b16 v[194:195], v5 offset:256
    ds_read_b64_tr_b16 v[196:197], v5 offset:1024
    ds_read_b64_tr_b16 v[198:199], v5 offset:1280
    ds_read_b64_tr_b16 v[200:201], v5 offset:2048
    ds_read_b64_tr_b16 v[202:203], v5 offset:2304
    ds_read_b64_tr_b16 v[204:205], v5 offset:3072
    ds_read_b64_tr_b16 v[206:207], v5 offset:3328
    ds_read_b64_tr_b16 v[208:209], v5 offset:4096
    ds_read_b64_tr_b16 v[210:211], v5 offset:4352
    ds_read_b64_tr_b16 v[212:213], v5 offset:5120
    ds_read_b64_tr_b16 v[214:215], v5 offset:5376
    ds_read_b64_tr_b16 v[216:217], v5 offset:6144
    ds_read_b64_tr_b16 v[218:219], v5 offset:6400
    ds_read_b64_tr_b16 v[220:221], v5 offset:7168
    ds_read_b64_tr_b16 v[222:223], v5 offset:7424
    ds_read_b64_tr_b16 v[224:225], v5 offset:8192
    ds_read_b64_tr_b16 v[226:227], v5 offset:8448
    ds_read_b64_tr_b16 v[228:229], v5 offset:9216
    ds_read_b64_tr_b16 v[230:231], v5 offset:9472
    ds_read_b64_tr_b16 v[232:233], v5 offset:10240
    ds_read_b64_tr_b16 v[234:235], v5 offset:10496
    ds_read_b64_tr_b16 v[236:237], v5 offset:11264
    ds_read_b64_tr_b16 v[238:239], v5 offset:11520
    ds_read_b64_tr_b16 v[240:241], v5 offset:12288
    ds_read_b64_tr_b16 v[242:243], v5 offset:12544
    ds_read_b64_tr_b16 v[244:245], v5 offset:13312
    ds_read_b64_tr_b16 v[246:247], v5 offset:13568
    ds_read_b64_tr_b16 v[248:249], v5 offset:14336
    ds_read_b64_tr_b16 v[250:251], v5 offset:14592
    ds_read_b64_tr_b16 v[252:253], v5 offset:15360
    ds_read_b64_tr_b16 v[254:255], v5 offset:15616
    s_cmp_lg_u32 s23, 0
    s_cbranch_scc1 cf2_65
    s_waitcnt lgkmcnt(0)
    v_mov_b32 v40, 0
    s_nop 1
    v_dot2_f32_bf16 v40, v192, v0, v40
    v_dot2_f32_bf16 v40, v193, v0, v40
    v_dot2_f32_bf16 v40, v194, v0, v40
    v_dot2_f32_bf16 v40, v195, v0, v40
    v_dot2_f32_bf16 v40, v196, v0, v40
    v_dot2_f32_bf16 v40, v197, v0, v40
    v_dot2_f32_bf16 v40, v198, v0, v40
    v_dot2_f32_bf16 v40, v199, v0, v40
    v_dot2_f32_bf16 v40, v200, v0, v40
    v_dot2_f32_bf16 v40, v201, v0, v40
    v_dot2_f32_bf16 v40, v202, v0, v40
    v_dot2_f32_bf16 v40, v203, v0, v40
    v_dot2_f32_bf16 v40, v204, v0, v40
    v_dot2_f32_bf16 v40, v205, v0, v40
    v_dot2_f32_bf16 v40, v206, v0, v40
    v_dot2_f32_bf16 v40, v207, v0, v40
    v_dot2_f32_bf16 v40, v208, v0, v40
    v_dot2_f32_bf16 v40, v209, v0, v40
    v_dot2_f32_bf16 v40, v210, v0, v40
    v_dot2_f32_bf16 v40, v211, v0, v40
    v_dot2_f32_bf16 v40, v212, v0, v40
    v_dot2_f32_bf16 v40, v213, v0, v40
    v_dot2_f32_bf16 v40, v214, v0, v40
    v_dot2_f32_bf16 v40, v215, v0, v40
    v_dot2_f32_bf16 v40, v216, v0, v40
    v_dot2_f32_bf16 v40, v217, v0, v40
    v_dot2_f32_bf16 v40, v218, v0, v40
    v_dot2_f32_bf16 v40, v219, v0, v40
    v_dot2_f32_bf16 v40, v220, v0, v40
    v_dot2_f32_bf16 v40, v221, v0, v40
    v_dot2_f32_bf16 v40, v222, v0, v40
    v_dot2_f32_bf16 v40, v223, v0, v40
    v_dot2_f32_bf16 v40, v224, v0, v40
    v_dot2_f32_bf16 v40, v225, v0, v40
    v_dot2_f32_bf16 v40, v226, v0, v40
    v_dot2_f32_bf16 v40, v227, v0, v40
    v_dot2_f32_bf16 v40, v228, v0, v40
    v_dot2_f32_bf16 v40, v229, v0, v40
    v_dot2_f32_bf16 v40, v230, v0, v40
    v_dot2_f32_bf16 v40, v231, v0, v40
    v_dot2_f32_bf16 v40, v232, v0, v40
    v_dot2_f32_bf16 v40, v233, v0, v40
    v_dot2_f32_bf16 v40, v234, v0, v40
    v_dot2_f32_bf16 v40, v235, v0, v40
    v_dot2_f32_bf16 v40, v236, v0, v40
    v_dot2_f32_bf16 v40, v237, v0, v40
    v_dot2_f32_bf16 v40, v238, v0, v40
    v_dot2_f32_bf16 v40, v239, v0, v40
    v_dot2_f32_bf16 v40, v240, v0, v40
    v_dot2_f32_bf16 v40, v241, v0, v40
    v_dot2_f32_bf16 v40, v242, v0, v40
    v_dot2_f32_bf16 v40, v243, v0, v40
    v_dot2_f32_bf16 v40, v244, v0, v40
    v_dot2_f32_bf16 v40, v245, v0, v40
    v_dot2_f32_bf16 v40, v246, v0, v40
    v_dot2_f32_bf16 v40, v247, v0, v40
    v_dot2_f32_bf16 v40, v248, v0, v40
    v_dot2_f32_bf16 v40, v249, v0, v40
    v_dot2_f32_bf16 v40, v250, v0, v40
    v_dot2_f32_bf16 v40, v251, v0, v40
    v_dot2_f32_bf16 v40, v252, v0, v40
    v_dot2_f32_bf16 v40, v253, v0, v40
    v_dot2_f32_bf16 v40, v254, v0, v40
    v_dot2_f32_bf16 v40, v255, v0, v40
    s_nop 2
    v_cvt_pk_bf16_f32 v42, v40, v40
    v_and_b32 v42, 0xffff0000, v42
    v_sub_f32 v43, v40, v42
    v_cvt_pk_bf16_f32 v16, v42, v43
    v_and_b32 v42, 0xffff0000, v16
    v_sub_f32 v43, v43, v42
    v_cvt_pk_bf16_f32 v17, v43, 0
cf2_65:
    s_waitcnt vmcnt(4)
    s_barrier
    s_mov_b32 m0, s85
    s_add_u32 s85, s85, 4096
    buffer_load_dwordx4 v2, s[4:7], s84 offen offset:0 sc1 lds
    buffer_load_dwordx4 v2, s[4:7], s84 offen offset:1024 sc1 lds
    buffer_load_dwordx4 v2, s[4:7], s84 offen offset:2048 sc1 lds
    buffer_load_dwordx4 v2, s[4:7], s84 offen offset:3072 sc1 lds
    s_add_u32 s84, s84, 4096
    s_waitcnt vmcnt(4)
    s_barrier
    v_lshlrev_b32 v5, 3, v1
    v_add_u32 v5, 131072, v5
    ds_read2st64_b64 v[80:83], v5 offset0:0 offset1:1
    ds_read2st64_b64 v[84:87], v5 offset0:2 offset1:3
    s_waitcnt vmcnt(0)
    s_barrier
    ds_read_b128 v[24:27], v6 offset:0
    ds_read_b128 v[28:31], v6 offset:2048
    ds_read_b128 v[32:35], v6 offset:4096
    ds_read_b128 v[36:39], v6 offset:6144
    ds_read_b128 v[100:103], v6 offset:8192
    ds_read_b128 v[104:107], v6 offset:10240
    ds_read_b128 v[108:111], v6 offset:12288
    ds_read_b128 v[112:115], v6 offset:14336
    s_waitcnt lgkmcnt(7)
    v_mfma_f32_16x16x32_bf16 v[40:43], v[192:195], v[24:27], 0
    ds_read_b128 v[24:27], v6 offset:16384
    s_waitcnt lgkmcnt(7)
    v_mfma_f32_16x16x32_bf16 v[64:67], v[196:199], v[28:31], 0
    ds_read_b128 v[28:31], v6 offset:18432
    s_waitcnt lgkmcnt(7)
    v_mfma_f32_16x16x32_bf16 v[40:43], v[200:203], v[32:35], v[40:43]
    ds_read_b128 v[32:35], v6 offset:20480
    s_waitcnt lgkmcnt(7)
    v_mfma_f32_16x16x32_bf16 v[64:67], v[204:207], v[36:39], v[64:67]
    ds_read_b128 v[36:39], v6 offset:22528
    s_waitcnt lgkmcnt(7)
    v_mfma_f32_16x16x32_bf16 v[40:43], v[208:211], v[100:103], v[40:43]
    ds_read_b128 v[100:103], v6 offset:24576
    s_waitcnt lgkmcnt(7)
    v_mfma_f32_16x16x32_bf16 v[64:67], v[212:215], v[104:107], v[64:67]
    ds_read_b128 v[104:107], v6 offset:26624
    s_waitcnt lgkmcnt(7)
    v_mfma_f32_16x16x32_bf16 v[40:43], v[216:219], v[108:111], v[40:43]
    ds_read_b128 v[108:111], v6 offset:28672
    s_waitcnt lgkmcnt(7)
    v_mfma_f32_16x16x32_bf16 v[64:67], v[220:223], v[112:115], v[64:67]
    ds_read_b128 v[112:115], v6 offset:30720
    s_waitcnt lgkmcnt(7)
    v_mfma_f32_16x16x32_bf16 v[40:43], v[224:227], v[24:27], v[40:43]
    s_waitcnt lgkmcnt(6)
    v_mfma_f32_16x16x32_bf16 v[64:67], v[228:231], v[28:31], v[64:67]
    s_waitcnt lgkmcnt(5)
    v_mfma_f32_16x16x32_bf16 v[40:43], v[232:235], v[32:35], v[40:43]
    s_waitcnt lgkmcnt(4)
    v_mfma_f32_16x16x32_bf16 v[64:67], v[236:239], v[36:39], v[64:67]
    s_waitcnt lgkmcnt(3)
    v_mfma_f32_16x16x32_bf16 v[40:43], v[240:243], v[100:103], v[40:43]
    s_waitcnt lgkmcnt(2)
    v_mfma_f32_16x16x32_bf16 v[64:67], v[244:247], v[104:107], v[64:67]
    s_waitcnt lgkmcnt(1)
    v_mfma_f32_16x16x32_bf16 v[40:43], v[248:251], v[108:111], v[40:43]
    s_waitcnt lgkmcnt(0)
    v_mfma_f32_16x16x32_bf16 v[64:67], v[252:255], v[112:115], v[64:67]
    v_pk_add_f32 v[80:81], v[80:81], v[84:85]
    v_pk_add_f32 v[82:83], v[82:83], v[86:87]
    v_pk_add_f32 v[10:11], v[80:81], v[82:83]
    v_mul_f32 v10, 0x3b000000, v10
    v_mul_f32 v11, 0x3b000000, v11
    v_fma_f32 v11, -v10, v10, v11
    v_max_f32 v11, 0, v11
    v_cvt_pk_bf16_f32 v11, v11, v11
    v_and_b32 v11, 0xffff0000, v11
    v_add_f32 v11, 0x3727c5ac, v11
    v_cvt_pk_bf16_f32 v11, v11, v11
    v_and_b32 v11, 0xffff0000, v11
    v_sqrt_f32 v11, v11
    s_nop 0
    v_cvt_pk_bf16_f32 v11, v11, v11
    v_and_b32 v11, 0xffff0000, v11
    v_rcp_f32 v11, v11
    v_cvt_pk_bf16_f32 v10, v10, v10
    v_and_b32 v10, 0xffff0000, v10
    v_and_b32 v7, 15, v1
    s_lshl_b32 s24, s35, 4
    v_add_u32 v7, s24, v7
    v_lshlrev_b32 v7, 2, v7
    ds_bpermute_b32 v8, v7, v10
    ds_bpermute_b32 v56, v7, v11
    v_and_b32 v60, 15, v1
    v_lshlrev_b32 v60, 4, v60
    v_bfe_u32 v7, v1, 4, 1
    v_lshl_add_u32 v60, v7, 9, v60
    v_lshrrev_b32 v7, 5, v1
    v_lshl_add_u32 v60, v7, 3, v60
    s_lshl_b32 s71, s16, 11
    s_lshr_b32 s25, s35, 1
    s_lshl_b32 s25, s25, 10
    s_add_u32 s71, s71, s25
    s_and_b32 s25, s35, 1
    s_lshl_b32 s25, s25, 8
    s_add_u32 s71, s71, s25
    s_add_u32 s71, s71, 0x880000
    s_add_u32 s71, s71, s23
    s_waitcnt lgkmcnt(0)
    v_mov_b32 v57, v56
    v_mov_b32 v58, v56
    v_mov_b32 v59, v56
    v_cvt_pk_bf16_f32 v48, -v8, -v8
    v_cvt_pk_bf16_f32 v49, -v8, -v8
    v_mov_b32 v50, 0
    v_mov_b32 v51, 0
    s_nop 1
    v_mfma_f32_16x16x32_bf16 v[40:43], v[16:19], v[48:51], v[40:43]
    s_nop 7
    v_pk_add_f32 v[40:41], v[40:41], v[64:65]
    v_pk_add_f32 v[42:43], v[42:43], v[66:67]
    v_mul_f32 v40, v40, v56
    v_mul_f32 v41, v41, v57
    v_mul_f32 v42, v42, v58
    v_mul_f32 v43, v43, v59
    v_cvt_pk_bf16_f32 v44, v40, v41
    v_cvt_pk_bf16_f32 v45, v42, v43
    buffer_store_dwordx2 v[44:45], v60, s[4:7], s71 offen sc1
    v_mov_b32 v8, v10
    v_mov_b32 v9, v11
    s_cmp_eq_u32 s19, 1
    s_cselect_b64 s[26:27], -1, 0
    v_permlane32_swap_b32 v10, v8
    v_permlane32_swap_b32 v11, v9
    s_nop 1
    v_cndmask_b32_e64 v11, v11, v9, s[26:27]
    s_branch b1e_58
b13v_57:
    s_lshl_b32 s65, s38, 4
    s_add_u32 s65, s65, s32
    s_mov_b32 s63, 0
    buffer_load_dwordx2 v[8:9], v98, s[4:7], 0 offen sc1
cw_66:
    s_add_u32 s63, s63, 1
    s_cmp_gt_u32 s63, 200000
    s_cbranch_scc1 L_end
    s_sleep 1
    buffer_load_dwordx2 v[92:93], v98, s[4:7], 0 offen sc1
    s_waitcnt vmcnt(1)
    v_subrev_u32 v8, s65, v8
    v_xor_b32 v9, s33, v9
    v_lshrrev_b32 v8, 12, v8
    v_or_b32 v7, v8, v9
    v_cmp_ne_u32 vcc, 0, v7
    s_cbranch_vccz co_67
    s_sleep 1
    buffer_load_dwordx2 v[8:9], v98, s[4:7], 0 offen sc1
    s_waitcnt vmcnt(1)
    v_subrev_u32 v92, s65, v92
    v_xor_b32 v93, s33, v93
    v_lshrrev_b32 v92, 12, v92
    v_or_b32 v7, v92, v93
    v_cmp_ne_u32 vcc, 0, v7
    s_cbranch_vccnz cw_66
co_67:
    s_lshl_b32 s85, s19, 15
    s_lshl_b32 s26, s20, 14
    s_add_u32 s85, s85, s26
    s_add_u32 s84, s73, s81
    s_add_u32 s84, s84, s85
    s_mov_b32 m0, s85
    s_add_u32 s85, s85, 4096
    buffer_load_dwordx4 v2, s[4:7], s84 offen offset:0 sc1 lds
    buffer_load_dwordx4 v2, s[4:7], s84 offen offset:1024 sc1 lds
    buffer_load_dwordx4 v2, s[4:7], s84 offen offset:2048 sc1 lds
    buffer_load_dwordx4 v2, s[4:7], s84 offen offset:3072 sc1 lds
    s_add_u32 s84, s84, 4096
    s_mov_b32 m0, s85
    s_add_u32 s85, s85, 4096
    buffer_load_dwordx4 v2, s[4:7], s84 offen offset:0 sc1 lds
    buffer_load_dwordx4 v2, s[4:7], s84 offen offset:1024 sc1 lds
    buffer_load_dwordx4 v2, s[4:7], s84 offen offset:2048 sc1 lds
    buffer_load_dwordx4 v2, s[4:7], s84 offen offset:3072 sc1 lds
    s_add_u32 s84, s84, 4096
    s_waitcnt vmcnt(4)
    s_barrier
    s_mov_b32 m0, s85
    s_add_u32 s85, s85, 4096
    buffer_load_dwordx4 v2, s[4:7], s84 offen offset:0 sc1 lds
    buffer_load_dwordx4 v2, s[4:7], s84 offen offset:1024 sc1 lds
    buffer_load_dwordx4 v2, s[4:7], s84 offen offset:2048 sc1 lds
    buffer_load_dwordx4 v2, s[4:7], s84 offen offset:3072 sc1 lds
    s_add_u32 s84, s84, 4096
    v_lshrrev_b32 v5, 5, v1
    v_lshlrev_b32 v5, 9, v5
    v_bfe_u32 v7, v1, 4, 1
    v_lshl_add_u32 v5, v7, 7, v5
    v_bfe_u32 v7, v1, 2, 2
    v_lshl_add_u32 v5, v7, 5, v5
    v_and_b32 v7, 3, v1
    v_lshl_add_u32 v5, v7, 3, v5
    v_add_u32 v5, 135168, v5
    ds_read_b64_tr_b16 v[192:193], v5 offset:0
    ds_read_b64_tr_b16 v[194:195], v5 offset:256
    ds_read_b64_tr_b16 v[196:197], v5 offset:1024
    ds_read_b64_tr_b16 v[198:199], v5 offset:1280
    ds_read_b64_tr_b16 v[200:201], v5 offset:2048
    ds_read_b64_tr_b16 v[202:203], v5 offset:2304
    ds_read_b64_tr_b16 v[204:205], v5 offset:3072
    ds_read_b64_tr_b16 v[206:207], v5 offset:3328
    ds_read_b64_tr_b16 v[208:209], v5 offset:4096
    ds_read_b64_tr_b16 v[210:211], v5 offset:4352
    ds_read_b64_tr_b16 v[212:213], v5 offset:5120
    ds_read_b64_tr_b16 v[214:215], v5 offset:5376
    ds_read_b64_tr_b16 v[216:217], v5 offset:6144
    ds_read_b64_tr_b16 v[218:219], v5 offset:6400
    ds_read_b64_tr_b16 v[220:221], v5 offset:7168
    ds_read_b64_tr_b16 v[222:223], v5 offset:7424
    ds_read_b64_tr_b16 v[224:225], v5 offset:8192
    ds_read_b64_tr_b16 v[226:227], v5 offset:8448
    ds_read_b64_tr_b16 v[228:229], v5 offset:9216
    ds_read_b64_tr_b16 v[230:231], v5 offset:9472
    ds_read_b64_tr_b16 v[232:233], v5 offset:10240
    ds_read_b64_tr_b16 v[234:235], v5 offset:10496
    ds_read_b64_tr_b16 v[236:237], v5 offset:11264
    ds_read_b64_tr_b16 v[238:239], v5 offset:11520
    ds_read_b64_tr_b16 v[240:241], v5 offset:12288
    ds_read_b64_tr_b16 v[242:243], v5 offset:12544
    ds_read_b64_tr_b16 v[244:245], v5 offset:13312
    ds_read_b64_tr_b16 v[246:247], v5 offset:13568
    ds_read_b64_tr_b16 v[248:249], v5 offset:14336
    ds_read_b64_tr_b16 v[250:251], v5 offset:14592
    ds_read_b64_tr_b16 v[252:253], v5 offset:15360
    ds_read_b64_tr_b16 v[254:255], v5 offset:15616
    s_cmp_lg_u32 s23, 0
    s_cbranch_scc1 cf2_68
    s_waitcnt lgkmcnt(0)
    v_mov_b32 v40, 0
    s_nop 1
    v_dot2_f32_bf16 v40, v192, v0, v40
    v_dot2_f32_bf16 v40, v193, v0, v40
    v_dot2_f32_bf16 v40, v194, v0, v40
    v_dot2_f32_bf16 v40, v195, v0, v40
    v_dot2_f32_bf16 v40, v196, v0, v40
    v_dot2_f32_bf16 v40, v197, v0, v40
    v_dot2_f32_bf16 v40, v198, v0, v40
    v_dot2_f32_bf16 v40, v199, v0, v40
    v_dot2_f32_bf16 v40, v200, v0, v40
    v_dot2_f32_bf16 v40, v201, v0, v40
    v_dot2_f32_bf16 v40, v202, v0, v40
    v_dot2_f32_bf16 v40, v203, v0, v40
    v_dot2_f32_bf16 v40, v204, v0, v40
    v_dot2_f32_bf16 v40, v205, v0, v40
    v_dot2_f32_bf16 v40, v206, v0, v40
    v_dot2_f32_bf16 v40, v207, v0, v40
    v_dot2_f32_bf16 v40, v208, v0, v40
    v_dot2_f32_bf16 v40, v209, v0, v40
    v_dot2_f32_bf16 v40, v210, v0, v40
    v_dot2_f32_bf16 v40, v211, v0, v40
    v_dot2_f32_bf16 v40, v212, v0, v40
    v_dot2_f32_bf16 v40, v213, v0, v40
    v_dot2_f32_bf16 v40, v214, v0, v40
    v_dot2_f32_bf16 v40, v215, v0, v40
    v_dot2_f32_bf16 v40, v216, v0, v40
    v_dot2_f32_bf16 v40, v217, v0, v40
    v_dot2_f32_bf16 v40, v218, v0, v40
    v_dot2_f32_bf16 v40, v219, v0, v40
    v_dot2_f32_bf16 v40, v220, v0, v40
    v_dot2_f32_bf16 v40, v221, v0, v40
    v_dot2_f32_bf16 v40, v222, v0, v40
    v_dot2_f32_bf16 v40, v223, v0, v40
    v_dot2_f32_bf16 v40, v224, v0, v40
    v_dot2_f32_bf16 v40, v225, v0, v40
    v_dot2_f32_bf16 v40, v226, v0, v40
    v_dot2_f32_bf16 v40, v227, v0, v40
    v_dot2_f32_bf16 v40, v228, v0, v40
    v_dot2_f32_bf16 v40, v229, v0, v40
    v_dot2_f32_bf16 v40, v230, v0, v40
    v_dot2_f32_bf16 v40, v231, v0, v40
    v_dot2_f32_bf16 v40, v232, v0, v40
    v_dot2_f32_bf16 v40, v233, v0, v40
    v_dot2_f32_bf16 v40, v234, v0, v40
    v_dot2_f32_bf16 v40, v235, v0, v40
    v_dot2_f32_bf16 v40, v236, v0, v40
    v_dot2_f32_bf16 v40, v237, v0, v40
    v_dot2_f32_bf16 v40, v238, v0, v40
    v_dot2_f32_bf16 v40, v239, v0, v40
    v_dot2_f32_bf16 v40, v240, v0, v40
    v_dot2_f32_bf16 v40, v241, v0, v40
    v_dot2_f32_bf16 v40, v242, v0, v40
    v_dot2_f32_bf16 v40, v243, v0, v40
    v_dot2_f32_bf16 v40, v244, v0, v40
    v_dot2_f32_bf16 v40, v245, v0, v40
    v_dot2_f32_bf16 v40, v246, v0, v40
    v_dot2_f32_bf16 v40, v247, v0, v40
    v_dot2_f32_bf16 v40, v248, v0, v40
    v_dot2_f32_bf16 v40, v249, v0, v40
    v_dot2_f32_bf16 v40, v250, v0, v40
    v_dot2_f32_bf16 v40, v251, v0, v40
    v_dot2_f32_bf16 v40, v252, v0, v40
    v_dot2_f32_bf16 v40, v253, v0, v40
    v_dot2_f32_bf16 v40, v254, v0, v40
    v_dot2_f32_bf16 v40, v255, v0, v40
    s_nop 2
    v_cvt_pk_bf16_f32 v42, v40, v40
    v_and_b32 v42, 0xffff0000, v42
    v_sub_f32 v43, v40, v42
    v_cvt_pk_bf16_f32 v16, v42, v43
    v_and_b32 v42, 0xffff0000, v16
    v_sub_f32 v43, v43, v42
    v_cvt_pk_bf16_f32 v17, v43, 0
cf2_68:
    s_waitcnt vmcnt(4)
    s_barrier
    s_mov_b32 m0, s85
    s_add_u32 s85, s85, 4096
    buffer_load_dwordx4 v2, s[4:7], s84 offen offset:0 sc1 lds
    buffer_load_dwordx4 v2, s[4:7], s84 offen offset:1024 sc1 lds
    buffer_load_dwordx4 v2, s[4:7], s84 offen offset:2048 sc1 lds
    buffer_load_dwordx4 v2, s[4:7], s84 offen offset:3072 sc1 lds
    s_add_u32 s84, s84, 4096
    s_waitcnt vmcnt(4)
    s_barrier
    v_lshlrev_b32 v5, 3, v1
    v_add_u32 v5, 131072, v5
    ds_read2st64_b64 v[80:83], v5 offset0:0 offset1:1
    ds_read2st64_b64 v[84:87], v5 offset0:2 offset1:3
    s_waitcnt vmcnt(0)
    s_barrier
    ds_read_b128 v[24:27], v6 offset:0
    ds_read_b128 v[28:31], v6 offset:2048
    ds_read_b128 v[32:35], v6 offset:4096
    ds_read_b128 v[36:39], v6 offset:6144
    ds_read_b128 v[100:103], v6 offset:8192
    ds_read_b128 v[104:107], v6 offset:10240
    ds_read_b128 v[108:111], v6 offset:12288
    ds_read_b128 v[112:115], v6 offset:14336
    s_waitcnt lgkmcnt(7)
    v_mfma_f32_16x16x32_bf16 v[40:43], v[24:27], v[192:195], 0
    ds_read_b128 v[24:27], v6 offset:16384
    s_waitcnt lgkmcnt(7)
    v_mfma_f32_16x16x32_bf16 v[64:67], v[28:31], v[196:199], 0
    ds_read_b128 v[28:31], v6 offset:18432
    s_waitcnt lgkmcnt(7)
    v_mfma_f32_16x16x32_bf16 v[40:43], v[32:35], v[200:203], v[40:43]
    ds_read_b128 v[32:35], v6 offset:20480
    s_waitcnt lgkmcnt(7)
    v_mfma_f32_16x16x32_bf16 v[64:67], v[36:39], v[204:207], v[64:67]
    ds_read_b128 v[36:39], v6 offset:22528
    s_waitcnt lgkmcnt(7)
    v_mfma_f32_16x16x32_bf16 v[40:43], v[100:103], v[208:211], v[40:43]
    ds_read_b128 v[100:103], v6 offset:24576
    s_waitcnt lgkmcnt(7)
    v_mfma_f32_16x16x32_bf16 v[64:67], v[104:107], v[212:215], v[64:67]
    ds_read_b128 v[104:107], v6 offset:26624
    s_waitcnt lgkmcnt(7)
    v_mfma_f32_16x16x32_bf16 v[40:43], v[108:111], v[216:219], v[40:43]
    ds_read_b128 v[108:111], v6 offset:28672
    s_waitcnt lgkmcnt(7)
    v_mfma_f32_16x16x32_bf16 v[64:67], v[112:115], v[220:223], v[64:67]
    ds_read_b128 v[112:115], v6 offset:30720
    s_waitcnt lgkmcnt(7)
    v_mfma_f32_16x16x32_bf16 v[40:43], v[24:27], v[224:227], v[40:43]
    s_waitcnt lgkmcnt(6)
    v_mfma_f32_16x16x32_bf16 v[64:67], v[28:31], v[228:231], v[64:67]
    s_waitcnt lgkmcnt(5)
    v_mfma_f32_16x16x32_bf16 v[40:43], v[32:35], v[232:235], v[40:43]
    s_waitcnt lgkmcnt(4)
    v_mfma_f32_16x16x32_bf16 v[64:67], v[36:39], v[236:239], v[64:67]
    s_waitcnt lgkmcnt(3)
    v_mfma_f32_16x16x32_bf16 v[40:43], v[100:103], v[240:243], v[40:43]
    s_waitcnt lgkmcnt(2)
    v_mfma_f32_16x16x32_bf16 v[64:67], v[104:107], v[244:247], v[64:67]
    s_waitcnt lgkmcnt(1)
    v_mfma_f32_16x16x32_bf16 v[40:43], v[108:111], v[248:251], v[40:43]
    s_waitcnt lgkmcnt(0)
    v_mfma_f32_16x16x32_bf16 v[64:67], v[112:115], v[252:255], v[64:67]
    v_pk_add_f32 v[80:81], v[80:81], v[84:85]
    v_pk_add_f32 v[82:83], v[82:83], v[86:87]
    v_pk_add_f32 v[10:11], v[80:81], v[82:83]
    v_mul_f32 v10, 0x3b000000, v10
    v_mul_f32 v11, 0x3b000000, v11
    v_fma_f32 v11, -v10, v10, v11
    v_max_f32 v11, 0, v11
    v_cvt_pk_bf16_f32 v11, v11, v11
    v_and_b32 v11, 0xffff0000, v11
    v_add_f32 v11, 0x3727c5ac, v11
    v_cvt_pk_bf16_f32 v11, v11, v11
    v_and_b32 v11, 0xffff0000, v11
    v_sqrt_f32 v11, v11
    s_nop 0
    v_cvt_pk_bf16_f32 v11, v11, v11
    v_and_b32 v11, 0xffff0000, v11
    v_rcp_f32 v11, v11
    v_cvt_pk_bf16_f32 v10, v10, v10
    v_and_b32 v10, 0xffff0000, v10
    v_and_b32 v7, 15, v1
    s_lshl_b32 s24, s35, 4
    v_add_u32 v7, s24, v7
    v_lshlrev_b32 v7, 2, v7
    ds_bpermute_b32 v8, v7, v10
    v_lshrrev_b32 v7, 4, v1
    v_lshlrev_b32 v7, 2, v7
    v_add_u32 v7, s24, v7
    v_lshlrev_b32 v7, 2, v7
    ds_bpermute_b32 v56, v7, v11 offset:0
    ds_bpermute_b32 v57, v7, v11 offset:4
    ds_bpermute_b32 v58, v7, v11 offset:8
    ds_bpermute_b32 v59, v7, v11 offset:12
    v_and_b32 v60, 15, v1
    v_lshlrev_b32 v60, 4, v60
    v_bfe_u32 v7, v1, 4, 1
    v_lshl_add_u32 v60, v7, 8, v60
    v_lshrrev_b32 v7, 5, v1
    v_lshl_add_u32 v60, v7, 3, v60
    s_lshl_b32 s71, s16, 2
    s_add_u32 s71, s71, s35
    s_lshl_b32 s71, s71, 9
    s_add_u32 s71, s71, 0x890000
    s_add_u32 s71, s71, s23
    s_waitcnt lgkmcnt(0)
    v_cvt_pk_bf16_f32 v48, -v8, -v8
    v_cvt_pk_bf16_f32 v49, -v8, -v8
    v_mov_b32 v50, 0
    v_mov_b32 v51, 0
    s_nop 1
    v_mfma_f32_16x16x32_bf16 v[40:43], v[48:51], v[16:19], v[40:43]
    s_nop 7
    v_pk_add_f32 v[40:41], v[40:41], v[64:65]
    v_pk_add_f32 v[42:43], v[42:43], v[66:67]
    v_mul_f32 v40, v40, v56
    v_mul_f32 v41, v41, v57
    v_mul_f32 v42, v42, v58
    v_mul_f32 v43, v43, v59
    v_cvt_pk_bf16_f32 v44, v40, v41
    v_cvt_pk_bf16_f32 v45, v42, v43
    buffer_store_dwordx2 v[44:45], v60, s[4:7], s71 offen sc1
    v_mov_b32 v8, v10
    v_mov_b32 v9, v11
    s_cmp_eq_u32 s19, 1
    s_cselect_b64 s[26:27], -1, 0
    v_permlane32_swap_b32 v10, v8
    v_permlane32_swap_b32 v11, v9
    s_nop 1
    v_cndmask_b32_e64 v11, v11, v9, s[26:27]
b1e_58:
    s_xor_b32 s73, s73, 0x200000
    s_xor_b32 s74, s74, 0xf80000
    s_mov_b32 s24, 0x00110000
    s_mov_b32 s25, 0x00110000
    v_cndmask_b32_e64 v7, 0, v0, s[24:25]
    v_mov_b32 v112, v7
    v_mov_b32 v113, v7
    v_mov_b32 v114, v7
    v_mov_b32 v115, v7
    v_mov_b32 v116, v7
    v_mov_b32 v117, v7
    v_mov_b32 v118, v7
    v_mov_b32 v119, v7
    v_mov_b32 v120, v7
    v_mov_b32 v121, v7
    v_mov_b32 v122, v7
    v_mov_b32 v123, v7
    v_mov_b32 v124, v7
    v_mov_b32 v125, v7
    v_mov_b32 v126, v7
    v_mov_b32 v127, v7
    s_waitcnt lgkmcnt(0)
    s_barrier
    s_cmp_lg_u32 s18, 3
    s_cbranch_scc1 role_69
    s_waitcnt vmcnt(0)
    s_lshl_b32 s24, s39, 4
    s_add_u32 s24, s24, s32
    s_add_u32 s24, s24, s91
    v_mov_b32 v6, s24
    v_mov_b32 v7, s33
    s_mov_b64 exec, 1
    s_cmp_eq_u32 s62, 1
    s_cbranch_scc1 fs_70
    buffer_store_dwordx2 v[6:7], v97, s[4:7], 0 offen sc1
    s_branch fs_71
fs_70:
    buffer_store_dwordx2 v[6:7], v97, s[4:7], 0 offen
fs_71:
    s_mov_b64 exec, -1
role_69:
    s_lshl_b32 s24, s18, 12
    s_add_u32 s24, s24, 65536
    v_add_u32 v5, s24, v2
    s_cmp_eq_u32 s21, 1
    s_cbranch_scc1 rr_72
    ds_read_b128 v[40:43], v5 offset:0
    ds_read_b128 v[44:47], v5 offset:1024
    ds_read_b128 v[48:51], v5 offset:2048
    ds_read_b128 v[52:55], v5 offset:3072
    s_waitcnt lgkmcnt(0)
    v_pk_add_f32 v[40:41], v[40:41], v[48:49]
    v_pk_add_f32 v[42:43], v[42:43], v[50:51]
    v_pk_add_f32 v[44:45], v[44:45], v[52:53]
    v_pk_add_f32 v[46:47], v[46:47], v[54:55]
    s_branch rr_73
rr_72:
    s_xor_b32 s24, s19, 1
    s_lshl_b32 s24, s24, 11
    v_add_u32 v5, s24, v5
    ds_read_b128 v[56:59], v5
    ds_read_b128 v[60:63], v5 offset:1024
    s_waitcnt lgkmcnt(0)
    v_pk_add_f32 v[40:41], v[48:49], v[56:57]
    v_pk_add_f32 v[42:43], v[50:51], v[58:59]
    v_pk_add_f32 v[44:45], v[52:53], v[60:61]
    v_pk_add_f32 v[46:47], v[54:55], v[62:63]
rr_73:
    v_mul_f32 v40, v40, v11
    v_mul_f32 v41, v41, v11
    v_mul_f32 v42, v42, v11
    v_mul_f32 v43, v43, v11
    v_mul_f32 v44, v44, v11
    v_mul_f32 v45, v45, v11
    v_mul_f32 v46, v46, v11
    v_mul_f32 v47, v47, v11
    v_cvt_pk_bf16_f32 v24, v40, v41
    v_cvt_pk_bf16_f32 v25, v42, v43
    v_cvt_pk_bf16_f32 v26, v44, v45
    v_cvt_pk_bf16_f32 v27, v46, v47
    v_lshlrev_b32 v40, 16, v24
    v_and_b32 v41, 0xffff0000, v24
    v_lshlrev_b32 v42, 16, v25
    v_and_b32 v43, 0xffff0000, v25
    v_lshlrev_b32 v44, 16, v26
    v_and_b32 v45, 0xffff0000, v26
    v_lshlrev_b32 v46, 16, v27
    v_and_b32 v47, 0xffff0000, v27
    v_mul_f32 v40, 0x3eb8aa3b, v40
    v_mul_f32 v41, 0x3eb8aa3b, v41
    v_mul_f32 v42, 0x3eb8aa3b, v42
    v_mul_f32 v43, 0x3eb8aa3b, v43
    v_mul_f32 v44, 0x3eb8aa3b, v44
    v_mul_f32 v45, 0x3eb8aa3b, v45
    v_mul_f32 v46, 0x3eb8aa3b, v46
    v_mul_f32 v47, 0x3eb8aa3b, v47
    v_cvt_pk_bf16_f32 v100, v40, v41
    v_cvt_pk_bf16_f32 v101, v42, v43
    v_cvt_pk_bf16_f32 v102, v44, v45
    v_cvt_pk_bf16_f32 v103, v46, v47
    s_cmp_lg_u32 s18, 0
    s_cbranch_scc1 role_74
    s_lshl_b32 s65, s39, 4
    s_add_u32 s65, s65, s32
    v_and_b32 v5, 31, v1
    v_lshlrev_b32 v5, 3, v5
    s_lshl_b32 s66, s75, 8
    s_add_u32 s66, s66, 0xb04000
    s_mov_b32 s63, 0
pl_75:
    s_add_u32 s63, s63, 1
    s_cmp_gt_u32 s63, 200000
    s_cbranch_scc1 L_end
    buffer_load_dwordx2 v[8:9], v5, s[4:7], s66 offen sc1
    s_waitcnt vmcnt(0)
    v_subrev_u32 v8, s65, v8
    v_xor_b32 v9, s33, v9
    v_lshrrev_b32 v8, 12, v8
    v_or_b32 v7, v8, v9
    v_cmp_ne_u32 vcc, 0, v7
    s_cbranch_vccnz pl_75
    s_lshr_b32 s24, s2, 3
    s_cmp_lg_u32 s24, 0
    s_cbranch_scc1 ld_77
    s_lshl_b32 s24, s39, 4
    s_add_u32 s24, s24, s32
    v_mov_b32 v6, s24
    v_mov_b32 v7, s33
    s_lshl_b32 s24, s75, 7
    s_add_u32 s24, s24, 0xb05000
    v_mov_b32 v5, 0
    s_mov_b64 exec, 1
    buffer_store_dwordx2 v[6:7], v5, s[4:7], s24 offen sc1
    s_mov_b64 exec, -1
ld_77:
role_74:
    s_waitcnt lgkmcnt(0)
    s_barrier
    s_lshl_b32 s67, s18, 10
    s_add_u32 s24, s75, 0
    s_and_b32 s24, s24, 7
    s_lshl_b32 s24, s24, 13
    s_add_u32 s24, s24, s67
    s_add_u32 s24, s24, s23
    s_add_u32 s24, s24, 0x880000
    s_add_u32 m0, s67, 0
    s_add_u32 s25, s24, 0x10000
    buffer_load_dwordx4 v2, s[4:7], s24 offen sc1 lds
    s_add_u32 m0, s67, 65536
    s_nop 0
    buffer_load_dwordx4 v2, s[4:7], s25 offen sc1 lds
    s_waitcnt vmcnt(0)
    s_barrier
    ds_read_b128 v[104:107], v2
    s_waitcnt lgkmcnt(0)
    v_mfma_f32_32x32x16_bf16 v[40:55], v[104:107], v[100:103], 0
    s_nop 11
    v_max3_f32 v10, v40, v41, v42
    v_max3_f32 v9, v43, v44, v45
    v_max3_f32 v10, v10, v46, v47
    v_max3_f32 v9, v9, v48, v49
    v_max3_f32 v10, v10, v50, v51
    v_max3_f32 v9, v9, v52, v53
    v_max3_f32 v10, v10, v54, v55
    v_max_f32 v10, v10, v9
    v_mov_b32 v9, v10
    s_nop 1
    v_permlane32_swap_b32 v10, v9
    s_nop 1
    v_max_f32 v10, v10, v9
    v_sub_f32 v10, 0, v10
    s_mov_b32 s37, 0
at_run_78:
    v_mov_b32 v24, v10
    v_mov_b32 v25, v10
    v_mov_b32 v26, v10
    v_mov_b32 v27, v10
    v_mov_b32 v28, v10
    v_mov_b32 v29, v10
    v_mov_b32 v30, v10
    v_mov_b32 v31, v10
    v_mov_b32 v32, v10
    v_mov_b32 v33, v10
    v_mov_b32 v34, v10
    v_mov_b32 v35, v10
    v_mov_b32 v36, v10
    v_mov_b32 v37, v10
    v_mov_b32 v38, v10
    v_mov_b32 v39, v10
    s_nop 1
    v_and_b32 v6, 15, v1
    v_lshlrev_b32 v6, 4, v6
    v_lshrrev_b32 v7, 5, v1
    v_lshl_add_u32 v6, v7, 8, v6
    v_add_u32 v6, 65536, v6
    ds_read_b128 v[104:107], v2 offset:0
    ds_read_b128 v[108:111], v2 offset:1024
    s_mov_b64 exec, s[30:31]
    ds_read_b128 v[112:115], v6 offset:0
    ds_read_b128 v[116:119], v6 offset:512
    s_mov_b64 exec, -1
    s_lshl_b32 s70, s18, 12
    s_add_u32 s70, s70, 131072
    s_setprio 1
    s_cmp_lg_u32 s21, 1
    s_cbranch_scc1 role_81
    s_setprio 2
role_81:
    s_waitcnt lgkmcnt(3)
    v_mfma_f32_32x32x16_bf16 v[40:55], v[104:107], v[100:103], v[24:39]
    v_lshrrev_b32 v11, 5, v1
    v_lshlrev_b32 v11, 8, v11
    v_bfe_u32 v7, v1, 2, 2
    v_lshl_add_u32 v11, v7, 6, v11
    v_bfe_u32 v7, v1, 4, 1
    v_lshl_add_u32 v11, v7, 5, v11
    v_and_b32 v7, 3, v1
    v_lshl_add_u32 v11, v7, 3, v11
    v_add_u32 v11, s70, v11
    s_nop 1
    s_waitcnt lgkmcnt(2)
    v_mfma_f32_32x32x16_bf16 v[56:71], v[108:111], v[100:103], v[24:39]
    ds_read_b128 v[104:107], v2 offset:2048
    v_exp_f32 v40, v40
    v_exp_f32 v41, v41
    v_exp_f32 v42, v42
    v_exp_f32 v43, v43
    v_cvt_pk_bf16_f32 v72, v40, v41
    v_exp_f32 v44, v44
    v_exp_f32 v45, v45
    v_cvt_pk_bf16_f32 v73, v42, v43
    v_exp_f32 v46, v46
    v_exp_f32 v47, v47
    v_cvt_pk_bf16_f32 v74, v44, v45
    v_exp_f32 v48, v48
    v_exp_f32 v49, v49
    v_cvt_pk_bf16_f32 v75, v46, v47
    v_exp_f32 v50, v50
    v_exp_f32 v51, v51
    s_waitcnt lgkmcnt(1)
    v_mfma_f32_32x32x16_bf16 v[80:95], v[112:115], v[72:75], 0
    v_cvt_pk_bf16_f32 v76, v48, v49
    v_exp_f32 v52, v52
    v_exp_f32 v53, v53
    v_cvt_pk_bf16_f32 v77, v50, v51
    v_exp_f32 v54, v54
    v_exp_f32 v55, v55
    v_cvt_pk_bf16_f32 v78, v52, v53
    s_nop 0
    v_cvt_pk_bf16_f32 v79, v54, v55
    s_nop 1
    v_mfma_f32_32x32x16_bf16 v[80:95], v[116:119], v[76:79], v[80:95]
    s_mov_b64 exec, s[30:31]
    ds_read_b128 v[120:123], v6 offset:1024
    ds_read_b128 v[124:127], v6 offset:1536
    s_mov_b64 exec, -1
    s_waitcnt lgkmcnt(2)
    v_mfma_f32_32x32x16_bf16 v[40:55], v[104:107], v[100:103], v[24:39]
    ds_read_b128 v[108:111], v2 offset:3072
    v_exp_f32 v56, v56
    v_exp_f32 v57, v57
    v_exp_f32 v58, v58
    v_exp_f32 v59, v59
    v_cvt_pk_bf16_f32 v72, v56, v57
    v_exp_f32 v60, v60
    v_exp_f32 v61, v61
    v_cvt_pk_bf16_f32 v73, v58, v59
    v_exp_f32 v62, v62
    v_exp_f32 v63, v63
    v_cvt_pk_bf16_f32 v74, v60, v61
    v_exp_f32 v64, v64
    v_exp_f32 v65, v65
    v_cvt_pk_bf16_f32 v75, v62, v63
    v_exp_f32 v66, v66
    v_exp_f32 v67, v67
    s_waitcnt lgkmcnt(1)
    v_mfma_f32_32x32x16_bf16 v[80:95], v[120:123], v[72:75], v[80:95]
    v_cvt_pk_bf16_f32 v76, v64, v65
    v_exp_f32 v68, v68
    v_exp_f32 v69, v69
    v_cvt_pk_bf16_f32 v77, v66, v67
    v_exp_f32 v70, v70
    v_exp_f32 v71, v71
    v_cvt_pk_bf16_f32 v78, v68, v69
    s_nop 0
    v_cvt_pk_bf16_f32 v79, v70, v71
    s_nop 1
    v_mfma_f32_32x32x16_bf16 v[80:95], v[124:127], v[76:79], v[80:95]
    s_mov_b64 exec, s[30:31]
    ds_read_b128 v[112:115], v6 offset:2048
    ds_read_b128 v[116:119], v6 offset:2560
    s_mov_b64 exec, -1
    s_cmp_lg_u32 s37, 0
    s_cbranch_scc1 fp_82
    v_and_b32 v7, 7, v1
    v_lshlrev_b32 v7, 7, v7
    s_mov_b32 s66, 0xb05000
    buffer_load_dwordx2 v[8:9], v7, s[4:7], s66 offen sc1
fp_82:
    s_waitcnt lgkmcnt(2)
    v_mfma_f32_32x32x16_bf16 v[56:71], v[108:111], v[100:103], v[24:39]
    ds_read_b128 v[104:107], v2 offset:4096
    v_exp_f32 v40, v40
    v_exp_f32 v41, v41
    v_exp_f32 v42, v42
    v_exp_f32 v43, v43
    v_cvt_pk_bf16_f32 v72, v40, v41
    v_exp_f32 v44, v44
    v_exp_f32 v45, v45
    v_cvt_pk_bf16_f32 v73, v42, v43
    v_exp_f32 v46, v46
    v_exp_f32 v47, v47
    v_cvt_pk_bf16_f32 v74, v44, v45
    v_exp_f32 v48, v48
    v_exp_f32 v49, v49
    v_cvt_pk_bf16_f32 v75, v46, v47
    v_exp_f32 v50, v50
    v_exp_f32 v51, v51
    s_waitcnt lgkmcnt(1)
    v_mfma_f32_32x32x16_bf16 v[80:95], v[112:115], v[72:75], v[80:95]
    v_cvt_pk_bf16_f32 v76, v48, v49
    v_exp_f32 v52, v52
    v_exp_f32 v53, v53
    v_cvt_pk_bf16_f32 v77, v50, v51
    v_exp_f32 v54, v54
    v_exp_f32 v55, v55
    v_cvt_pk_bf16_f32 v78, v52, v53
    s_nop 0
    v_cvt_pk_bf16_f32 v79, v54, v55
    s_nop 1
    v_mfma_f32_32x32x16_bf16 v[80:95], v[116:119], v[76:79], v[80:95]
    s_mov_b64 exec, s[30:31]
    ds_read_b128 v[120:123], v6 offset:3072
    ds_read_b128 v[124:127], v6 offset:3584
    s_mov_b64 exec, -1
    s_waitcnt lgkmcnt(2)
    v_mfma_f32_32x32x16_bf16 v[40:55], v[104:107], v[100:103], v[24:39]
    ds_read_b128 v[108:111], v2 offset:5120
    v_exp_f32 v56, v56
    v_exp_f32 v57, v57
    v_exp_f32 v58, v58
    v_exp_f32 v59, v59
    v_cvt_pk_bf16_f32 v72, v56, v57
    v_exp_f32 v60, v60
    v_exp_f32 v61, v61
    v_cvt_pk_bf16_f32 v73, v58, v59
    v_exp_f32 v62, v62
    v_exp_f32 v63, v63
    v_cvt_pk_bf16_f32 v74, v60, v61
    v_exp_f32 v64, v64
    v_exp_f32 v65, v65
    v_cvt_pk_bf16_f32 v75, v62, v63
    v_exp_f32 v66, v66
    v_exp_f32 v67, v67
    s_waitcnt lgkmcnt(1)
    v_mfma_f32_32x32x16_bf16 v[80:95], v[120:123], v[72:75], v[80:95]
    v_cvt_pk_bf16_f32 v76, v64, v65
    v_exp_f32 v68, v68
    v_exp_f32 v69, v69
    v_cvt_pk_bf16_f32 v77, v66, v67
    v_exp_f32 v70, v70
    v_exp_f32 v71, v71
    v_cvt_pk_bf16_f32 v78, v68, v69
    s_nop 0
    v_cvt_pk_bf16_f32 v79, v70, v71
    s_nop 1
    v_mfma_f32_32x32x16_bf16 v[80:95], v[124:127], v[76:79], v[80:95]
    s_mov_b64 exec, s[30:31]
    ds_read_b128 v[112:115], v6 offset:4096
    ds_read_b128 v[116:119], v6 offset:4608
    s_mov_b64 exec, -1
    s_cmp_lg_u32 s37, 0
    s_cbranch_scc1 fp_83
    s_lshl_b32 s65, s39, 4
    s_add_u32 s65, s65, s32
    s_lshl_b32 s64, 2, s75
    s_waitcnt vmcnt(0)
    s_mov_b32 exec_lo, s64
    s_mov_b32 exec_hi, 0
    v_subrev_u32 v8, s65, v8
    v_xor_b32 v9, s33, v9
    v_lshrrev_b32 v8, 12, v8
    v_or_b32 v5, v8, v9
    v_cmp_ne_u32 vcc, 0, v5
    s_mov_b64 exec, -1
    s_cbranch_vccz xr_84
    v_and_b32 v7, 7, v1
    v_lshlrev_b32 v7, 7, v7
    s_mov_b32 s63, 0
pl_85:
    s_add_u32 s63, s63, 1
    s_cmp_gt_u32 s63, 200000
    s_cbranch_scc1 L_end
    buffer_load_dwordx2 v[8:9], v7, s[4:7], s66 offen sc1
    s_waitcnt vmcnt(0)
    s_mov_b32 exec_lo, s64
    s_mov_b32 exec_hi, 0
    v_subrev_u32 v8, s65, v8
    v_xor_b32 v9, s33, v9
    v_lshrrev_b32 v8, 12, v8
    v_or_b32 v5, v8, v9
    v_cmp_ne_u32 vcc, 0, v5
    s_mov_b64 exec, -1
    s_cbranch_vccz po_86
    s_sleep 1
    s_branch pl_85
po_86:
xr_84:
    s_lshl_b32 s67, s18, 10
    s_add_u32 s24, s75, 1
    s_and_b32 s24, s24, 7
    s_lshl_b32 s24, s24, 13
    s_add_u32 s24, s24, s67
    s_add_u32 s24, s24, s23
    s_add_u32 s24, s24, 0x880000
    s_add_u32 m0, s67, 8192
    s_add_u32 s25, s24, 0x10000
    buffer_load_dwordx4 v2, s[4:7], s24 offen sc1 lds
    s_add_u32 m0, s67, 73728
    s_nop 0
    buffer_load_dwordx4 v2, s[4:7], s25 offen sc1 lds
fp_83:
    s_cmp_lg_u32 s21, 1
    s_cbranch_scc1 role_87
    s_setprio 0
role_87:
    s_waitcnt lgkmcnt(2)
    v_mfma_f32_32x32x16_bf16 v[56:71], v[108:111], v[100:103], v[24:39]
    ds_read_b128 v[104:107], v2 offset:6144
    v_exp_f32 v40, v40
    v_exp_f32 v41, v41
    v_exp_f32 v42, v42
    v_exp_f32 v43, v43
    v_cvt_pk_bf16_f32 v72, v40, v41
    v_exp_f32 v44, v44
    v_exp_f32 v45, v45
    v_cvt_pk_bf16_f32 v73, v42, v43
    v_exp_f32 v46, v46
    v_exp_f32 v47, v47
    v_cvt_pk_bf16_f32 v74, v44, v45
    v_exp_f32 v48, v48
    v_exp_f32 v49, v49
    v_cvt_pk_bf16_f32 v75, v46, v47
    v_exp_f32 v50, v50
    v_exp_f32 v51, v51
    s_waitcnt lgkmcnt(1)
    v_mfma_f32_32x32x16_bf16 v[80:95], v[112:115], v[72:75], v[80:95]
    v_cvt_pk_bf16_f32 v76, v48, v49
    v_exp_f32 v52, v52
    v_exp_f32 v53, v53
    v_cvt_pk_bf16_f32 v77, v50, v51
    v_exp_f32 v54, v54
    v_exp_f32 v55, v55
    v_cvt_pk_bf16_f32 v78, v52, v53
    s_nop 0
    v_cvt_pk_bf16_f32 v79, v54, v55
    s_nop 1
    v_mfma_f32_32x32x16_bf16 v[80:95], v[116:119], v[76:79], v[80:95]
    s_mov_b64 exec, s[30:31]
    ds_read_b128 v[120:123], v6 offset:5120
    ds_read_b128 v[124:127], v6 offset:5632
    s_mov_b64 exec, -1
    s_waitcnt lgkmcnt(2)
    v_mfma_f32_32x32x16_bf16 v[40:55], v[104:107], v[100:103], v[24:39]
    ds_read_b128 v[108:111], v2 offset:7168
    v_exp_f32 v56, v56
    v_exp_f32 v57, v57
    v_exp_f32 v58, v58
    v_exp_f32 v59, v59
    v_cvt_pk_bf16_f32 v72, v56, v57
    v_exp_f32 v60, v60
    v_exp_f32 v61, v61
    v_cvt_pk_bf16_f32 v73, v58, v59
    v_exp_f32 v62, v62
    v_exp_f32 v63, v63
    v_cvt_pk_bf16_f32 v74, v60, v61
    v_exp_f32 v64, v64
    v_exp_f32 v65, v65
    v_cvt_pk_bf16_f32 v75, v62, v63
    v_exp_f32 v66, v66
    v_exp_f32 v67, v67
    s_waitcnt lgkmcnt(1)
    v_mfma_f32_32x32x16_bf16 v[80:95], v[120:123], v[72:75], v[80:95]
    v_cvt_pk_bf16_f32 v76, v64, v65
    v_exp_f32 v68, v68
    v_exp_f32 v69, v69
    v_cvt_pk_bf16_f32 v77, v66, v67
    v_exp_f32 v70, v70
    v_exp_f32 v71, v71
    v_cvt_pk_bf16_f32 v78, v68, v69
    s_nop 0
    v_cvt_pk_bf16_f32 v79, v70, v71
    s_nop 1
    v_mfma_f32_32x32x16_bf16 v[80:95], v[124:127], v[76:79], v[80:95]
    s_mov_b64 exec, s[30:31]
    ds_read_b128 v[112:115], v6 offset:6144
    ds_read_b128 v[116:119], v6 offset:6656
    s_mov_b64 exec, -1
    s_waitcnt lgkmcnt(2)
    v_mfma_f32_32x32x16_bf16 v[56:71], v[108:111], v[100:103], v[24:39]
    v_exp_f32 v40, v40
    v_exp_f32 v41, v41
    v_exp_f32 v42, v42
    v_exp_f32 v43, v43
    v_cvt_pk_bf16_f32 v72, v40, v41
    v_exp_f32 v44, v44
    v_exp_f32 v45, v45
    v_cvt_pk_bf16_f32 v73, v42, v43
    v_exp_f32 v46, v46
    v_exp_f32 v47, v47
    v_cvt_pk_bf16_f32 v74, v44, v45
    v_exp_f32 v48, v48
    v_exp_f32 v49, v49
    v_cvt_pk_bf16_f32 v75, v46, v47
    v_exp_f32 v50, v50
    v_exp_f32 v51, v51
    s_waitcnt lgkmcnt(0)
    v_mfma_f32_32x32x16_bf16 v[80:95], v[112:115], v[72:75], v[80:95]
    v_cvt_pk_bf16_f32 v76, v48, v49
    v_exp_f32 v52, v52
    v_exp_f32 v53, v53
    v_cvt_pk_bf16_f32 v77, v50, v51
    v_exp_f32 v54, v54
    v_exp_f32 v55, v55
    v_cvt_pk_bf16_f32 v78, v52, v53
    s_nop 0
    v_cvt_pk_bf16_f32 v79, v54, v55
    s_nop 1
    v_mfma_f32_32x32x16_bf16 v[80:95], v[116:119], v[76:79], v[80:95]
    s_mov_b64 exec, s[30:31]
    ds_read_b128 v[120:123], v6 offset:7168
    ds_read_b128 v[124:127], v6 offset:7680
    s_mov_b64 exec, -1
    s_cmp_lg_u32 s37, 0
    s_cbranch_scc1 fp_88
    s_waitcnt vmcnt(0)
    s_barrier
fp_88:
    ds_read_b128 v[104:107], v2 offset:8192
    s_cmp_lg_u32 s21, 1
    s_cbranch_scc1 role_89
    s_setprio 2
role_89:
    s_waitcnt lgkmcnt(0)
    v_mfma_f32_32x32x16_bf16 v[40:55], v[104:107], v[100:103], v[24:39]
    ds_read_b128 v[108:111], v2 offset:9216
    v_exp_f32 v56, v56
    v_exp_f32 v57, v57
    v_exp_f32 v58, v58
    v_exp_f32 v59, v59
    v_cvt_pk_bf16_f32 v72, v56, v57
    v_exp_f32 v60, v60
    v_exp_f32 v61, v61
    v_cvt_pk_bf16_f32 v73, v58, v59
    v_exp_f32 v62, v62
    v_exp_f32 v63, v63
    v_cvt_pk_bf16_f32 v74, v60, v61
    v_exp_f32 v64, v64
    v_exp_f32 v65, v65
    v_cvt_pk_bf16_f32 v75, v62, v63
    v_exp_f32 v66, v66
    v_exp_f32 v67, v67
    v_mfma_f32_32x32x16_bf16 v[80:95], v[120:123], v[72:75], v[80:95]
    v_cvt_pk_bf16_f32 v76, v64, v65
    v_exp_f32 v68, v68
    v_exp_f32 v69, v69
    v_cvt_pk_bf16_f32 v77, v66, v67
    v_exp_f32 v70, v70
    v_exp_f32 v71, v71
    v_cvt_pk_bf16_f32 v78, v68, v69
    s_nop 0
    v_cvt_pk_bf16_f32 v79, v70, v71
    s_nop 1
    v_mfma_f32_32x32x16_bf16 v[80:95], v[124:127], v[76:79], v[80:95]
    s_mov_b64 exec, s[30:31]
    ds_read_b128 v[112:115], v6 offset:8192
    ds_read_b128 v[116:119], v6 offset:8704
    s_mov_b64 exec, -1
    s_waitcnt lgkmcnt(2)
    v_mfma_f32_32x32x16_bf16 v[56:71], v[108:111], v[100:103], v[24:39]
    ds_read_b128 v[104:107], v2 offset:10240
    v_exp_f32 v40, v40
    v_exp_f32 v41, v41
    v_exp_f32 v42, v42
    v_exp_f32 v43, v43
    v_cvt_pk_bf16_f32 v72, v40, v41
    v_exp_f32 v44, v44
    v_exp_f32 v45, v45
    v_cvt_pk_bf16_f32 v73, v42, v43
    v_exp_f32 v46, v46
    v_exp_f32 v47, v47
    v_cvt_pk_bf16_f32 v74, v44, v45
    v_exp_f32 v48, v48
    v_exp_f32 v49, v49
    v_cvt_pk_bf16_f32 v75, v46, v47
    v_exp_f32 v50, v50
    v_exp_f32 v51, v51
    s_waitcnt lgkmcnt(1)
    v_mfma_f32_32x32x16_bf16 v[80:95], v[112:115], v[72:75], v[80:95]
    v_cvt_pk_bf16_f32 v76, v48, v49
    v_exp_f32 v52, v52
    v_exp_f32 v53, v53
    v_cvt_pk_bf16_f32 v77, v50, v51
    v_exp_f32 v54, v54
    v_exp_f32 v55, v55
    v_cvt_pk_bf16_f32 v78, v52, v53
    s_nop 0
    v_cvt_pk_bf16_f32 v79, v54, v55
    s_nop 1
    v_mfma_f32_32x32x16_bf16 v[80:95], v[116:119], v[76:79], v[80:95]
    s_mov_b64 exec, s[30:31]
    ds_read_b128 v[120:123], v6 offset:9216
    ds_read_b128 v[124:127], v6 offset:9728
    s_mov_b64 exec, -1
    s_cmp_lg_u32 s37, 0
    s_cbranch_scc1 fp_90
    v_and_b32 v7, 7, v1
    v_lshlrev_b32 v7, 7, v7
    s_mov_b32 s66, 0xb05000
    buffer_load_dwordx2 v[8:9], v7, s[4:7], s66 offen sc1
fp_90:
    s_waitcnt lgkmcnt(2)
    v_mfma_f32_32x32x16_bf16 v[40:55], v[104:107], v[100:103], v[24:39]
    ds_read_b128 v[108:111], v2 offset:11264
    v_exp_f32 v56, v56
    v_exp_f32 v57, v57
    v_exp_f32 v58, v58
    v_exp_f32 v59, v59
    v_cvt_pk_bf16_f32 v72, v56, v57
    v_exp_f32 v60, v60
    v_exp_f32 v61, v61
    v_cvt_pk_bf16_f32 v73, v58, v59
    v_exp_f32 v62, v62
    v_exp_f32 v63, v63
    v_cvt_pk_bf16_f32 v74, v60, v61
    v_exp_f32 v64, v64
    v_exp_f32 v65, v65
    v_cvt_pk_bf16_f32 v75, v62, v63
    v_exp_f32 v66, v66
    v_exp_f32 v67, v67
    s_waitcnt lgkmcnt(1)
    v_mfma_f32_32x32x16_bf16 v[80:95], v[120:123], v[72:75], v[80:95]
    v_cvt_pk_bf16_f32 v76, v64, v65
    v_exp_f32 v68, v68
    v_exp_f32 v69, v69
    v_cvt_pk_bf16_f32 v77, v66, v67
    v_exp_f32 v70, v70
    v_exp_f32 v71, v71
    v_cvt_pk_bf16_f32 v78, v68, v69
    s_nop 0
    v_cvt_pk_bf16_f32 v79, v70, v71
    s_nop 1
    v_mfma_f32_32x32x16_bf16 v[80:95], v[124:127], v[76:79], v[80:95]
    s_mov_b64 exec, s[30:31]
    ds_read_b128 v[112:115], v6 offset:10240
    ds_read_b128 v[116:119], v6 offset:10752
    s_mov_b64 exec, -1
    s_waitcnt lgkmcnt(2)
    v_mfma_f32_32x32x16_bf16 v[56:71], v[108:111], v[100:103], v[24:39]
    ds_read_b128 v[104:107], v2 offset:12288
    v_exp_f32 v40, v40
    v_exp_f32 v41, v41
    v_exp_f32 v42, v42
    v_exp_f32 v43, v43
    v_cvt_pk_bf16_f32 v72, v40, v41
    v_exp_f32 v44, v44
    v_exp_f32 v45, v45
    v_cvt_pk_bf16_f32 v73, v42, v43
    v_exp_f32 v46, v46
    v_exp_f32 v47, v47
    v_cvt_pk_bf16_f32 v74, v44, v45
    v_exp_f32 v48, v48
    v_exp_f32 v49, v49
    v_cvt_pk_bf16_f32 v75, v46, v47
    v_exp_f32 v50, v50
    v_exp_f32 v51, v51
    s_waitcnt lgkmcnt(1)
    v_mfma_f32_32x32x16_bf16 v[80:95], v[112:115], v[72:75], v[80:95]
    v_cvt_pk_bf16_f32 v76, v48, v49
    v_exp_f32 v52, v52
    v_exp_f32 v53, v53
    v_cvt_pk_bf16_f32 v77, v50, v51
    v_exp_f32 v54, v54
    v_exp_f32 v55, v55
    v_cvt_pk_bf16_f32 v78, v52, v53
    s_nop 0
    v_cvt_pk_bf16_f32 v79, v54, v55
    s_nop 1
    v_mfma_f32_32x32x16_bf16 v[80:95], v[116:119], v[76:79], v[80:95]
    s_mov_b64 exec, s[30:31]
    ds_read_b128 v[120:123], v6 offset:11264
    ds_read_b128 v[124:127], v6 offset:11776
    s_mov_b64 exec, -1
    s_cmp_lg_u32 s37, 0
    s_cbranch_scc1 fp_91
    s_lshl_b32 s65, s39, 4
    s_add_u32 s65, s65, s32
    s_lshl_b32 s64, 12, s75
    s_waitcnt vmcnt(0)
    s_mov_b32 exec_lo, s64
    s_mov_b32 exec_hi, 0
    v_subrev_u32 v8, s65, v8
    v_xor_b32 v9, s33, v9
    v_lshrrev_b32 v8, 12, v8
    v_or_b32 v5, v8, v9
    v_cmp_ne_u32 vcc, 0, v5
    s_mov_b64 exec, -1
    s_cbranch_vccz xr_92
    v_and_b32 v7, 7, v1
    v_lshlrev_b32 v7, 7, v7
    s_mov_b32 s63, 0
pl_93:
    s_add_u32 s63, s63, 1
    s_cmp_gt_u32 s63, 200000
    s_cbranch_scc1 L_end
    buffer_load_dwordx2 v[8:9], v7, s[4:7], s66 offen sc1
    s_waitcnt vmcnt(0)
    s_mov_b32 exec_lo, s64
    s_mov_b32 exec_hi, 0
    v_subrev_u32 v8, s65, v8
    v_xor_b32 v9, s33, v9
    v_lshrrev_b32 v8, 12, v8
    v_or_b32 v5, v8, v9
    v_cmp_ne_u32 vcc, 0, v5
    s_mov_b64 exec, -1
    s_cbranch_vccz po_94
    s_sleep 1
    s_branch pl_93
po_94:
xr_92:
    s_lshl_b32 s67, s18, 10
    s_add_u32 s24, s75, 2
    s_and_b32 s24, s24, 7
    s_lshl_b32 s24, s24, 13
    s_add_u32 s24, s24, s67
    s_add_u32 s24, s24, s23
    s_add_u32 s24, s24, 0x880000
    s_add_u32 m0, s67, 16384
    s_add_u32 s25, s24, 0x10000
    buffer_load_dwordx4 v2, s[4:7], s24 offen sc1 lds
    s_add_u32 m0, s67, 81920
    s_nop 0
    buffer_load_dwordx4 v2, s[4:7], s25 offen sc1 lds
    s_add_u32 s24, s75, 3
    s_and_b32 s24, s24, 7
    s_lshl_b32 s24, s24, 13
    s_add_u32 s24, s24, s67
    s_add_u32 s24, s24, s23
    s_add_u32 s24, s24, 0x880000
    s_add_u32 m0, s67, 24576
    s_add_u32 s25, s24, 0x10000
    buffer_load_dwordx4 v2, s[4:7], s24 offen sc1 lds
    s_add_u32 m0, s67, 90112
    s_nop 0
    buffer_load_dwordx4 v2, s[4:7], s25 offen sc1 lds
fp_91:
    s_waitcnt lgkmcnt(2)
    v_mfma_f32_32x32x16_bf16 v[40:55], v[104:107], v[100:103], v[24:39]
    ds_read_b128 v[108:111], v2 offset:13312
    v_exp_f32 v56, v56
    v_exp_f32 v57, v57
    v_exp_f32 v58, v58
    v_exp_f32 v59, v59
    v_cvt_pk_bf16_f32 v72, v56, v57
    v_exp_f32 v60, v60
    v_exp_f32 v61, v61
    v_cvt_pk_bf16_f32 v73, v58, v59
    v_exp_f32 v62, v62
    v_exp_f32 v63, v63
    v_cvt_pk_bf16_f32 v74, v60, v61
    v_exp_f32 v64, v64
    v_exp_f32 v65, v65
    v_cvt_pk_bf16_f32 v75, v62, v63
    v_exp_f32 v66, v66
    v_exp_f32 v67, v67
    s_waitcnt lgkmcnt(1)
    v_mfma_f32_32x32x16_bf16 v[80:95], v[120:123], v[72:75], v[80:95]
    v_cvt_pk_bf16_f32 v76, v64, v65
    v_exp_f32 v68, v68
    v_exp_f32 v69, v69
    v_cvt_pk_bf16_f32 v77, v66, v67
    v_exp_f32 v70, v70
    v_exp_f32 v71, v71
    v_cvt_pk_bf16_f32 v78, v68, v69
    s_nop 0
    v_cvt_pk_bf16_f32 v79, v70, v71
    s_nop 1
    v_mfma_f32_32x32x16_bf16 v[80:95], v[124:127], v[76:79], v[80:95]
    s_mov_b64 exec, s[30:31]
    ds_read_b128 v[112:115], v6 offset:12288
    ds_read_b128 v[116:119], v6 offset:12800
    s_mov_b64 exec, -1
    s_cmp_lg_u32 s21, 1
    s_cbranch_scc1 role_95
    s_setprio 0
role_95:
    s_waitcnt lgkmcnt(2)
    v_mfma_f32_32x32x16_bf16 v[56:71], v[108:111], v[100:103], v[24:39]
    ds_read_b128 v[104:107], v2 offset:14336
    v_exp_f32 v40, v40
    v_exp_f32 v41, v41
    v_exp_f32 v42, v42
    v_exp_f32 v43, v43
    v_cvt_pk_bf16_f32 v72, v40, v41
    v_exp_f32 v44, v44
    v_exp_f32 v45, v45
    v_cvt_pk_bf16_f32 v73, v42, v43
    v_exp_f32 v46, v46
    v_exp_f32 v47, v47
    v_cvt_pk_bf16_f32 v74, v44, v45
    v_exp_f32 v48, v48
    v_exp_f32 v49, v49
    v_cvt_pk_bf16_f32 v75, v46, v47
    v_exp_f32 v50, v50
    v_exp_f32 v51, v51
    s_waitcnt lgkmcnt(1)
    v_mfma_f32_32x32x16_bf16 v[80:95], v[112:115], v[72:75], v[80:95]
    v_cvt_pk_bf16_f32 v76, v48, v49
    v_exp_f32 v52, v52
    v_exp_f32 v53, v53
    v_cvt_pk_bf16_f32 v77, v50, v51
    v_exp_f32 v54, v54
    v_exp_f32 v55, v55
    v_cvt_pk_bf16_f32 v78, v52, v53
    s_nop 0
    v_cvt_pk_bf16_f32 v79, v54, v55
    s_nop 1
    v_mfma_f32_32x32x16_bf16 v[80:95], v[116:119], v[76:79], v[80:95]
    s_mov_b64 exec, s[30:31]
    ds_read_b128 v[120:123], v6 offset:13312
    ds_read_b128 v[124:127], v6 offset:13824
    s_mov_b64 exec, -1
    s_waitcnt lgkmcnt(2)
    v_mfma_f32_32x32x16_bf16 v[40:55], v[104:107], v[100:103], v[24:39]
    ds_read_b128 v[108:111], v2 offset:15360
    v_exp_f32 v56, v56
    v_exp_f32 v57, v57
    v_exp_f32 v58, v58
    v_exp_f32 v59, v59
    v_cvt_pk_bf16_f32 v72, v56, v57
    v_exp_f32 v60, v60
    v_exp_f32 v61, v61
    v_cvt_pk_bf16_f32 v73, v58, v59
    v_exp_f32 v62, v62
    v_exp_f32 v63, v63
    v_cvt_pk_bf16_f32 v74, v60, v61
    v_exp_f32 v64, v64
    v_exp_f32 v65, v65
    v_cvt_pk_bf16_f32 v75, v62, v63
    v_exp_f32 v66, v66
    v_exp_f32 v67, v67
    s_waitcnt lgkmcnt(1)
    v_mfma_f32_32x32x16_bf16 v[80:95], v[120:123], v[72:75], v[80:95]
    v_cvt_pk_bf16_f32 v76, v64, v65
    v_exp_f32 v68, v68
    v_exp_f32 v69, v69
    v_cvt_pk_bf16_f32 v77, v66, v67
    v_exp_f32 v70, v70
    v_exp_f32 v71, v71
    v_cvt_pk_bf16_f32 v78, v68, v69
    s_nop 0
    v_cvt_pk_bf16_f32 v79, v70, v71
    s_nop 1
    v_mfma_f32_32x32x16_bf16 v[80:95], v[124:127], v[76:79], v[80:95]
    s_mov_b64 exec, s[30:31]
    ds_read_b128 v[112:115], v6 offset:14336
    ds_read_b128 v[116:119], v6 offset:14848
    s_mov_b64 exec, -1
    s_waitcnt lgkmcnt(2)
    v_mfma_f32_32x32x16_bf16 v[56:71], v[108:111], v[100:103], v[24:39]
    v_exp_f32 v40, v40
    v_exp_f32 v41, v41
    v_exp_f32 v42, v42
    v_exp_f32 v43, v43
    v_cvt_pk_bf16_f32 v72, v40, v41
    v_exp_f32 v44, v44
    v_exp_f32 v45, v45
    v_cvt_pk_bf16_f32 v73, v42, v43
    v_exp_f32 v46, v46
    v_exp_f32 v47, v47
    v_cvt_pk_bf16_f32 v74, v44, v45
    v_exp_f32 v48, v48
    v_exp_f32 v49, v49
    v_cvt_pk_bf16_f32 v75, v46, v47
    v_exp_f32 v50, v50
    v_exp_f32 v51, v51
    s_waitcnt lgkmcnt(0)
    v_mfma_f32_32x32x16_bf16 v[80:95], v[112:115], v[72:75], v[80:95]
    v_cvt_pk_bf16_f32 v76, v48, v49
    v_exp_f32 v52, v52
    v_exp_f32 v53, v53
    v_cvt_pk_bf16_f32 v77, v50, v51
    v_exp_f32 v54, v54
    v_exp_f32 v55, v55
    v_cvt_pk_bf16_f32 v78, v52, v53
    s_nop 0
    v_cvt_pk_bf16_f32 v79, v54, v55
    s_nop 1
    v_mfma_f32_32x32x16_bf16 v[80:95], v[116:119], v[76:79], v[80:95]
    s_mov_b64 exec, s[30:31]
    ds_read_b128 v[120:123], v6 offset:15360
    ds_read_b128 v[124:127], v6 offset:15872
    s_mov_b64 exec, -1
    s_cmp_lg_u32 s37, 0
    s_cbranch_scc1 fp_96
    s_waitcnt vmcnt(0)
    s_barrier
fp_96:
    ds_read_b128 v[104:107], v2 offset:16384
    s_cmp_lg_u32 s21, 1
    s_cbranch_scc1 role_97
    s_setprio 2
role_97:
    s_waitcnt lgkmcnt(0)
    v_mfma_f32_32x32x16_bf16 v[40:55], v[104:107], v[100:103], v[24:39]
    ds_read_b128 v[108:111], v2 offset:17408
    v_exp_f32 v56, v56
    v_exp_f32 v57, v57
    v_exp_f32 v58, v58
    v_exp_f32 v59, v59
    v_cvt_pk_bf16_f32 v72, v56, v57
    v_exp_f32 v60, v60
    v_exp_f32 v61, v61
    v_cvt_pk_bf16_f32 v73, v58, v59
    v_exp_f32 v62, v62
    v_exp_f32 v63, v63
    v_cvt_pk_bf16_f32 v74, v60, v61
    v_exp_f32 v64, v64
    v_exp_f32 v65, v65
    v_cvt_pk_bf16_f32 v75, v62, v63
    v_exp_f32 v66, v66
    v_exp_f32 v67, v67
    v_mfma_f32_32x32x16_bf16 v[80:95], v[120:123], v[72:75], v[80:95]
    v_cvt_pk_bf16_f32 v76, v64, v65
    v_exp_f32 v68, v68
    v_exp_f32 v69, v69
    v_cvt_pk_bf16_f32 v77, v66, v67
    v_exp_f32 v70, v70
    v_exp_f32 v71, v71
    v_cvt_pk_bf16_f32 v78, v68, v69
    s_nop 0
    v_cvt_pk_bf16_f32 v79, v70, v71
    s_nop 1
    v_mfma_f32_32x32x16_bf16 v[80:95], v[124:127], v[76:79], v[80:95]
    s_mov_b64 exec, s[30:31]
    ds_read_b128 v[112:115], v6 offset:16384
    ds_read_b128 v[116:119], v6 offset:16896
    s_mov_b64 exec, -1
    s_waitcnt lgkmcnt(2)
    v_mfma_f32_32x32x16_bf16 v[56:71], v[108:111], v[100:103], v[24:39]
    ds_read_b128 v[104:107], v2 offset:18432
    v_exp_f32 v40, v40
    v_exp_f32 v41, v41
    v_exp_f32 v42, v42
    v_exp_f32 v43, v43
    v_cvt_pk_bf16_f32 v72, v40, v41
    v_exp_f32 v44, v44
    v_exp_f32 v45, v45
    v_cvt_pk_bf16_f32 v73, v42, v43
    v_exp_f32 v46, v46
    v_exp_f32 v47, v47
    v_cvt_pk_bf16_f32 v74, v44, v45
    v_exp_f32 v48, v48
    v_exp_f32 v49, v49
    v_cvt_pk_bf16_f32 v75, v46, v47
    v_exp_f32 v50, v50
    v_exp_f32 v51, v51
    s_waitcnt lgkmcnt(1)
    v_mfma_f32_32x32x16_bf16 v[80:95], v[112:115], v[72:75], v[80:95]
    v_cvt_pk_bf16_f32 v76, v48, v49
    v_exp_f32 v52, v52
    v_exp_f32 v53, v53
    v_cvt_pk_bf16_f32 v77, v50, v51
    v_exp_f32 v54, v54
    v_exp_f32 v55, v55
    v_cvt_pk_bf16_f32 v78, v52, v53
    s_nop 0
    v_cvt_pk_bf16_f32 v79, v54, v55
    s_nop 1
    v_mfma_f32_32x32x16_bf16 v[80:95], v[116:119], v[76:79], v[80:95]
    s_mov_b64 exec, s[30:31]
    ds_read_b128 v[120:123], v6 offset:17408
    ds_read_b128 v[124:127], v6 offset:17920
    s_mov_b64 exec, -1
    s_waitcnt lgkmcnt(2)
    v_mfma_f32_32x32x16_bf16 v[40:55], v[104:107], v[100:103], v[24:39]
    ds_read_b128 v[108:111], v2 offset:19456
    v_exp_f32 v56, v56
    v_exp_f32 v57, v57
    v_exp_f32 v58, v58
    v_exp_f32 v59, v59
    v_cvt_pk_bf16_f32 v72, v56, v57
    v_exp_f32 v60, v60
    v_exp_f32 v61, v61
    v_cvt_pk_bf16_f32 v73, v58, v59
    v_exp_f32 v62, v62
    v_exp_f32 v63, v63
    v_cvt_pk_bf16_f32 v74, v60, v61
    v_exp_f32 v64, v64
    v_exp_f32 v65, v65
    v_cvt_pk_bf16_f32 v75, v62, v63
    v_exp_f32 v66, v66
    v_exp_f32 v67, v67
    s_waitcnt lgkmcnt(1)
    v_mfma_f32_32x32x16_bf16 v[80:95], v[120:123], v[72:75], v[80:95]
    v_cvt_pk_bf16_f32 v76, v64, v65
    v_exp_f32 v68, v68
    v_exp_f32 v69, v69
    v_cvt_pk_bf16_f32 v77, v66, v67
    v_exp_f32 v70, v70
    v_exp_f32 v71, v71
    v_cvt_pk_bf16_f32 v78, v68, v69
    s_nop 0
    v_cvt_pk_bf16_f32 v79, v70, v71
    s_nop 1
    v_mfma_f32_32x32x16_bf16 v[80:95], v[124:127], v[76:79], v[80:95]
    s_mov_b64 exec, s[30:31]
    ds_read_b128 v[112:115], v6 offset:18432
    ds_read_b128 v[116:119], v6 offset:18944
    s_mov_b64 exec, -1
    s_waitcnt lgkmcnt(2)
    v_mfma_f32_32x32x16_bf16 v[56:71], v[108:111], v[100:103], v[24:39]
    ds_read_b128 v[104:107], v2 offset:20480
    v_exp_f32 v40, v40
    v_exp_f32 v41, v41
    v_exp_f32 v42, v42
    v_exp_f32 v43, v43
    v_cvt_pk_bf16_f32 v72, v40, v41
    v_exp_f32 v44, v44
    v_exp_f32 v45, v45
    v_cvt_pk_bf16_f32 v73, v42, v43
    v_exp_f32 v46, v46
    v_exp_f32 v47, v47
    v_cvt_pk_bf16_f32 v74, v44, v45
    v_exp_f32 v48, v48
    v_exp_f32 v49, v49
    v_cvt_pk_bf16_f32 v75, v46, v47
    v_exp_f32 v50, v50
    v_exp_f32 v51, v51
    s_waitcnt lgkmcnt(1)
    v_mfma_f32_32x32x16_bf16 v[80:95], v[112:115], v[72:75], v[80:95]
    v_cvt_pk_bf16_f32 v76, v48, v49
    v_exp_f32 v52, v52
    v_exp_f32 v53, v53
    v_cvt_pk_bf16_f32 v77, v50, v51
    v_exp_f32 v54, v54
    v_exp_f32 v55, v55
    v_cvt_pk_bf16_f32 v78, v52, v53
    s_nop 0
    v_cvt_pk_bf16_f32 v79, v54, v55
    s_nop 1
    v_mfma_f32_32x32x16_bf16 v[80:95], v[116:119], v[76:79], v[80:95]
    s_mov_b64 exec, s[30:31]
    ds_read_b128 v[120:123], v6 offset:19456
    ds_read_b128 v[124:127], v6 offset:19968
    s_mov_b64 exec, -1
    s_waitcnt lgkmcnt(2)
    v_mfma_f32_32x32x16_bf16 v[40:55], v[104:107], v[100:103], v[24:39]
    ds_read_b128 v[108:111], v2 offset:21504
    v_exp_f32 v56, v56
    v_exp_f32 v57, v57
    v_exp_f32 v58, v58
    v_exp_f32 v59, v59
    v_cvt_pk_bf16_f32 v72, v56, v57
    v_exp_f32 v60, v60
    v_exp_f32 v61, v61
    v_cvt_pk_bf16_f32 v73, v58, v59
    v_exp_f32 v62, v62
    v_exp_f32 v63, v63
    v_cvt_pk_bf16_f32 v74, v60, v61
    v_exp_f32 v64, v64
    v_exp_f32 v65, v65
    v_cvt_pk_bf16_f32 v75, v62, v63
    v_exp_f32 v66, v66
    v_exp_f32 v67, v67
    s_waitcnt lgkmcnt(1)
    v_mfma_f32_32x32x16_bf16 v[80:95], v[120:123], v[72:75], v[80:95]
    v_cvt_pk_bf16_f32 v76, v64, v65
    v_exp_f32 v68, v68
    v_exp_f32 v69, v69
    v_cvt_pk_bf16_f32 v77, v66, v67
    v_exp_f32 v70, v70
    v_exp_f32 v71, v71
    v_cvt_pk_bf16_f32 v78, v68, v69
    s_nop 0
    v_cvt_pk_bf16_f32 v79, v70, v71
    s_nop 1
    v_mfma_f32_32x32x16_bf16 v[80:95], v[124:127], v[76:79], v[80:95]
    s_mov_b64 exec, s[30:31]
    ds_read_b128 v[112:115], v6 offset:20480
    ds_read_b128 v[116:119], v6 offset:20992
    s_mov_b64 exec, -1
    s_cmp_lg_u32 s37, 0
    s_cbranch_scc1 fp_98
    v_and_b32 v7, 7, v1
    v_lshlrev_b32 v7, 7, v7
    s_mov_b32 s66, 0xb05000
    buffer_load_dwordx2 v[8:9], v7, s[4:7], s66 offen sc1
fp_98:
    s_waitcnt lgkmcnt(2)
    v_mfma_f32_32x32x16_bf16 v[56:71], v[108:111], v[100:103], v[24:39]
    ds_read_b128 v[104:107], v2 offset:22528
    v_exp_f32 v40, v40
    v_exp_f32 v41, v41
    v_exp_f32 v42, v42
    v_exp_f32 v43, v43
    v_cvt_pk_bf16_f32 v72, v40, v41
    v_exp_f32 v44, v44
    v_exp_f32 v45, v45
    v_cvt_pk_bf16_f32 v73, v42, v43
    v_exp_f32 v46, v46
    v_exp_f32 v47, v47
    v_cvt_pk_bf16_f32 v74, v44, v45
    v_exp_f32 v48, v48
    v_exp_f32 v49, v49
    v_cvt_pk_bf16_f32 v75, v46, v47
    v_exp_f32 v50, v50
    v_exp_f32 v51, v51
    s_waitcnt lgkmcnt(1)
    v_mfma_f32_32x32x16_bf16 v[80:95], v[112:115], v[72:75], v[80:95]
    v_cvt_pk_bf16_f32 v76, v48, v49
    v_exp_f32 v52, v52
    v_exp_f32 v53, v53
    v_cvt_pk_bf16_f32 v77, v50, v51
    v_exp_f32 v54, v54
    v_exp_f32 v55, v55
    v_cvt_pk_bf16_f32 v78, v52, v53
    s_nop 0
    v_cvt_pk_bf16_f32 v79, v54, v55
    s_nop 1
    v_mfma_f32_32x32x16_bf16 v[80:95], v[116:119], v[76:79], v[80:95]
    s_mov_b64 exec, s[30:31]
    ds_read_b128 v[120:123], v6 offset:21504
    ds_read_b128 v[124:127], v6 offset:22016
    s_mov_b64 exec, -1
    s_waitcnt lgkmcnt(2)
    v_mfma_f32_32x32x16_bf16 v[40:55], v[104:107], v[100:103], v[24:39]
    ds_read_b128 v[108:111], v2 offset:23552
    v_exp_f32 v56, v56
    v_exp_f32 v57, v57
    v_exp_f32 v58, v58
    v_exp_f32 v59, v59
    v_cvt_pk_bf16_f32 v72, v56, v57
    v_exp_f32 v60, v60
    v_exp_f32 v61, v61
    v_cvt_pk_bf16_f32 v73, v58, v59
    v_exp_f32 v62, v62
    v_exp_f32 v63, v63
    v_cvt_pk_bf16_f32 v74, v60, v61
    v_exp_f32 v64, v64
    v_exp_f32 v65, v65
    v_cvt_pk_bf16_f32 v75, v62, v63
    v_exp_f32 v66, v66
    v_exp_f32 v67, v67
    s_waitcnt lgkmcnt(1)
    v_mfma_f32_32x32x16_bf16 v[80:95], v[120:123], v[72:75], v[80:95]
    v_cvt_pk_bf16_f32 v76, v64, v65
    v_exp_f32 v68, v68
    v_exp_f32 v69, v69
    v_cvt_pk_bf16_f32 v77, v66, v67
    v_exp_f32 v70, v70
    v_exp_f32 v71, v71
    v_cvt_pk_bf16_f32 v78, v68, v69
    s_nop 0
    v_cvt_pk_bf16_f32 v79, v70, v71
    s_nop 1
    v_mfma_f32_32x32x16_bf16 v[80:95], v[124:127], v[76:79], v[80:95]
    s_mov_b64 exec, s[30:31]
    ds_read_b128 v[112:115], v6 offset:22528
    ds_read_b128 v[116:119], v6 offset:23040
    s_mov_b64 exec, -1
    s_cmp_lg_u32 s37, 0
    s_cbranch_scc1 fp_99
    s_lshl_b32 s65, s39, 4
    s_add_u32 s65, s65, s32
    s_lshl_b32 s64, 240, s75
    s_waitcnt vmcnt(0)
    s_mov_b32 exec_lo, s64
    s_mov_b32 exec_hi, 0
    v_subrev_u32 v8, s65, v8
    v_xor_b32 v9, s33, v9
    v_lshrrev_b32 v8, 12, v8
    v_or_b32 v5, v8, v9
    v_cmp_ne_u32 vcc, 0, v5
    s_mov_b64 exec, -1
    s_cbranch_vccz xr_100
    v_and_b32 v7, 7, v1
    v_lshlrev_b32 v7, 7, v7
    s_mov_b32 s63, 0
pl_101:
    s_add_u32 s63, s63, 1
    s_cmp_gt_u32 s63, 200000
    s_cbranch_scc1 L_end
    buffer_load_dwordx2 v[8:9], v7, s[4:7], s66 offen sc1
    s_waitcnt vmcnt(0)
    s_mov_b32 exec_lo, s64
    s_mov_b32 exec_hi, 0
    v_subrev_u32 v8, s65, v8
    v_xor_b32 v9, s33, v9
    v_lshrrev_b32 v8, 12, v8
    v_or_b32 v5, v8, v9
    v_cmp_ne_u32 vcc, 0, v5
    s_mov_b64 exec, -1
    s_cbranch_vccz po_102
    s_sleep 1
    s_branch pl_101
po_102:
xr_100:
    s_lshl_b32 s67, s18, 10
    s_add_u32 s24, s75, 4
    s_and_b32 s24, s24, 7
    s_lshl_b32 s24, s24, 13
    s_add_u32 s24, s24, s67
    s_add_u32 s24, s24, s23
    s_add_u32 s24, s24, 0x880000
    s_add_u32 m0, s67, 32768
    s_add_u32 s25, s24, 0x10000
    buffer_load_dwordx4 v2, s[4:7], s24 offen sc1 lds
    s_add_u32 m0, s67, 98304
    s_nop 0
    buffer_load_dwordx4 v2, s[4:7], s25 offen sc1 lds
    s_add_u32 s24, s75, 5
    s_and_b32 s24, s24, 7
    s_lshl_b32 s24, s24, 13
    s_add_u32 s24, s24, s67
    s_add_u32 s24, s24, s23
    s_add_u32 s24, s24, 0x880000
    s_add_u32 m0, s67, 40960
    s_add_u32 s25, s24, 0x10000
    buffer_load_dwordx4 v2, s[4:7], s24 offen sc1 lds
    s_add_u32 m0, s67, 106496
    s_nop 0
    buffer_load_dwordx4 v2, s[4:7], s25 offen sc1 lds
    s_add_u32 s24, s75, 6
    s_and_b32 s24, s24, 7
    s_lshl_b32 s24, s24, 13
    s_add_u32 s24, s24, s67
    s_add_u32 s24, s24, s23
    s_add_u32 s24, s24, 0x880000
    s_add_u32 m0, s67, 49152
    s_add_u32 s25, s24, 0x10000
    buffer_load_dwordx4 v2, s[4:7], s24 offen sc1 lds
    s_add_u32 m0, s67, 114688
    s_nop 0
    buffer_load_dwordx4 v2, s[4:7], s25 offen sc1 lds
    s_add_u32 s24, s75, 7
    s_and_b32 s24, s24, 7
    s_lshl_b32 s24, s24, 13
    s_add_u32 s24, s24, s67
    s_add_u32 s24, s24, s23
    s_add_u32 s24, s24, 0x880000
    s_add_u32 m0, s67, 57344
    s_add_u32 s25, s24, 0x10000
    buffer_load_dwordx4 v2, s[4:7], s24 offen sc1 lds
    s_add_u32 m0, s67, 122880
    s_nop 0
    buffer_load_dwordx4 v2, s[4:7], s25 offen sc1 lds
fp_99:
    s_waitcnt lgkmcnt(2)
    v_mfma_f32_32x32x16_bf16 v[56:71], v[108:111], v[100:103], v[24:39]
    ds_read_b128 v[104:107], v2 offset:24576
    v_exp_f32 v40, v40
    v_exp_f32 v41, v41
    v_exp_f32 v42, v42
    v_exp_f32 v43, v43
    v_cvt_pk_bf16_f32 v72, v40, v41
    v_exp_f32 v44, v44
    v_exp_f32 v45, v45
    v_cvt_pk_bf16_f32 v73, v42, v43
    v_exp_f32 v46, v46
    v_exp_f32 v47, v47
    v_cvt_pk_bf16_f32 v74, v44, v45
    v_exp_f32 v48, v48
    v_exp_f32 v49, v49
    v_cvt_pk_bf16_f32 v75, v46, v47
    v_exp_f32 v50, v50
    v_exp_f32 v51, v51
    s_waitcnt lgkmcnt(1)
    v_mfma_f32_32x32x16_bf16 v[80:95], v[112:115], v[72:75], v[80:95]
    v_cvt_pk_bf16_f32 v76, v48, v49
    v_exp_f32 v52, v52
    v_exp_f32 v53, v53
    v_cvt_pk_bf16_f32 v77, v50, v51
    v_exp_f32 v54, v54
    v_exp_f32 v55, v55
    v_cvt_pk_bf16_f32 v78, v52, v53
    s_nop 0
    v_cvt_pk_bf16_f32 v79, v54, v55
    s_nop 1
    v_mfma_f32_32x32x16_bf16 v[80:95], v[116:119], v[76:79], v[80:95]
    s_mov_b64 exec, s[30:31]
    ds_read_b128 v[120:123], v6 offset:23552
    ds_read_b128 v[124:127], v6 offset:24064
    s_mov_b64 exec, -1
    s_cmp_lg_u32 s21, 1
    s_cbranch_scc1 role_103
    s_setprio 0
role_103:
    s_waitcnt lgkmcnt(2)
    v_mfma_f32_32x32x16_bf16 v[40:55], v[104:107], v[100:103], v[24:39]
    ds_read_b128 v[108:111], v2 offset:25600
    v_exp_f32 v56, v56
    v_exp_f32 v57, v57
    v_exp_f32 v58, v58
    v_exp_f32 v59, v59
    v_cvt_pk_bf16_f32 v72, v56, v57
    v_exp_f32 v60, v60
    v_exp_f32 v61, v61
    v_cvt_pk_bf16_f32 v73, v58, v59
    v_exp_f32 v62, v62
    v_exp_f32 v63, v63
    v_cvt_pk_bf16_f32 v74, v60, v61
    v_exp_f32 v64, v64
    v_exp_f32 v65, v65
    v_cvt_pk_bf16_f32 v75, v62, v63
    v_exp_f32 v66, v66
    v_exp_f32 v67, v67
    s_waitcnt lgkmcnt(1)
    v_mfma_f32_32x32x16_bf16 v[80:95], v[120:123], v[72:75], v[80:95]
    v_cvt_pk_bf16_f32 v76, v64, v65
    v_exp_f32 v68, v68
    v_exp_f32 v69, v69
    v_cvt_pk_bf16_f32 v77, v66, v67
    v_exp_f32 v70, v70
    v_exp_f32 v71, v71
    v_cvt_pk_bf16_f32 v78, v68, v69
    s_nop 0
    v_cvt_pk_bf16_f32 v79, v70, v71
    s_nop 1
    v_mfma_f32_32x32x16_bf16 v[80:95], v[124:127], v[76:79], v[80:95]
    s_mov_b64 exec, s[30:31]
    ds_read_b128 v[112:115], v6 offset:24576
    ds_read_b128 v[116:119], v6 offset:25088
    s_mov_b64 exec, -1
    s_waitcnt lgkmcnt(2)
    v_mfma_f32_32x32x16_bf16 v[56:71], v[108:111], v[100:103], v[24:39]
    ds_read_b128 v[104:107], v2 offset:26624
    v_exp_f32 v40, v40
    v_exp_f32 v41, v41
    v_exp_f32 v42, v42
    v_exp_f32 v43, v43
    v_cvt_pk_bf16_f32 v72, v40, v41
    v_exp_f32 v44, v44
    v_exp_f32 v45, v45
    v_cvt_pk_bf16_f32 v73, v42, v43
    v_exp_f32 v46, v46
    v_exp_f32 v47, v47
    v_cvt_pk_bf16_f32 v74, v44, v45
    v_exp_f32 v48, v48
    v_exp_f32 v49, v49
    v_cvt_pk_bf16_f32 v75, v46, v47
    v_exp_f32 v50, v50
    v_exp_f32 v51, v51
    s_waitcnt lgkmcnt(1)
    v_mfma_f32_32x32x16_bf16 v[80:95], v[112:115], v[72:75], v[80:95]
    v_cvt_pk_bf16_f32 v76, v48, v49
    v_exp_f32 v52, v52
    v_exp_f32 v53, v53
    v_cvt_pk_bf16_f32 v77, v50, v51
    v_exp_f32 v54, v54
    v_exp_f32 v55, v55
    v_cvt_pk_bf16_f32 v78, v52, v53
    s_nop 0
    v_cvt_pk_bf16_f32 v79, v54, v55
    s_nop 1
    v_mfma_f32_32x32x16_bf16 v[80:95], v[116:119], v[76:79], v[80:95]
    s_mov_b64 exec, s[30:31]
    ds_read_b128 v[120:123], v6 offset:25600
    ds_read_b128 v[124:127], v6 offset:26112
    s_mov_b64 exec, -1
    s_waitcnt lgkmcnt(2)
    v_mfma_f32_32x32x16_bf16 v[40:55], v[104:107], v[100:103], v[24:39]
    ds_read_b128 v[108:111], v2 offset:27648
    v_exp_f32 v56, v56
    v_exp_f32 v57, v57
    v_exp_f32 v58, v58
    v_exp_f32 v59, v59
    v_cvt_pk_bf16_f32 v72, v56, v57
    v_exp_f32 v60, v60
    v_exp_f32 v61, v61
    v_cvt_pk_bf16_f32 v73, v58, v59
    v_exp_f32 v62, v62
    v_exp_f32 v63, v63
    v_cvt_pk_bf16_f32 v74, v60, v61
    v_exp_f32 v64, v64
    v_exp_f32 v65, v65
    v_cvt_pk_bf16_f32 v75, v62, v63
    v_exp_f32 v66, v66
    v_exp_f32 v67, v67
    s_waitcnt lgkmcnt(1)
    v_mfma_f32_32x32x16_bf16 v[80:95], v[120:123], v[72:75], v[80:95]
    v_cvt_pk_bf16_f32 v76, v64, v65
    v_exp_f32 v68, v68
    v_exp_f32 v69, v69
    v_cvt_pk_bf16_f32 v77, v66, v67
    v_exp_f32 v70, v70
    v_exp_f32 v71, v71
    v_cvt_pk_bf16_f32 v78, v68, v69
    s_nop 0
    v_cvt_pk_bf16_f32 v79, v70, v71
    s_nop 1
    v_mfma_f32_32x32x16_bf16 v[80:95], v[124:127], v[76:79], v[80:95]
    s_mov_b64 exec, s[30:31]
    ds_read_b128 v[112:115], v6 offset:26624
    ds_read_b128 v[116:119], v6 offset:27136
    s_mov_b64 exec, -1
    s_waitcnt lgkmcnt(2)
    v_mfma_f32_32x32x16_bf16 v[56:71], v[108:111], v[100:103], v[24:39]
    ds_read_b128 v[104:107], v2 offset:28672
    v_exp_f32 v40, v40
    v_exp_f32 v41, v41
    v_exp_f32 v42, v42
    v_exp_f32 v43, v43
    v_cvt_pk_bf16_f32 v72, v40, v41
    v_exp_f32 v44, v44
    v_exp_f32 v45, v45
    v_cvt_pk_bf16_f32 v73, v42, v43
    v_exp_f32 v46, v46
    v_exp_f32 v47, v47
    v_cvt_pk_bf16_f32 v74, v44, v45
    v_exp_f32 v48, v48
    v_exp_f32 v49, v49
    v_cvt_pk_bf16_f32 v75, v46, v47
    v_exp_f32 v50, v50
    v_exp_f32 v51, v51
    s_waitcnt lgkmcnt(1)
    v_mfma_f32_32x32x16_bf16 v[80:95], v[112:115], v[72:75], v[80:95]
    v_cvt_pk_bf16_f32 v76, v48, v49
    v_exp_f32 v52, v52
    v_exp_f32 v53, v53
    v_cvt_pk_bf16_f32 v77, v50, v51
    v_exp_f32 v54, v54
    v_exp_f32 v55, v55
    v_cvt_pk_bf16_f32 v78, v52, v53
    s_nop 0
    v_cvt_pk_bf16_f32 v79, v54, v55
    s_nop 1
    v_mfma_f32_32x32x16_bf16 v[80:95], v[116:119], v[76:79], v[80:95]
    s_mov_b64 exec, s[30:31]
    ds_read_b128 v[120:123], v6 offset:27648
    ds_read_b128 v[124:127], v6 offset:28160
    s_mov_b64 exec, -1
    s_waitcnt lgkmcnt(2)
    v_mfma_f32_32x32x16_bf16 v[40:55], v[104:107], v[100:103], v[24:39]
    ds_read_b128 v[108:111], v2 offset:29696
    v_exp_f32 v56, v56
    v_exp_f32 v57, v57
    v_exp_f32 v58, v58
    v_exp_f32 v59, v59
    v_cvt_pk_bf16_f32 v72, v56, v57
    v_exp_f32 v60, v60
    v_exp_f32 v61, v61
    v_cvt_pk_bf16_f32 v73, v58, v59
    v_exp_f32 v62, v62
    v_exp_f32 v63, v63
    v_cvt_pk_bf16_f32 v74, v60, v61
    v_exp_f32 v64, v64
    v_exp_f32 v65, v65
    v_cvt_pk_bf16_f32 v75, v62, v63
    v_exp_f32 v66, v66
    v_exp_f32 v67, v67
    s_waitcnt lgkmcnt(1)
    v_mfma_f32_32x32x16_bf16 v[80:95], v[120:123], v[72:75], v[80:95]
    v_cvt_pk_bf16_f32 v76, v64, v65
    v_exp_f32 v68, v68
    v_exp_f32 v69, v69
    v_cvt_pk_bf16_f32 v77, v66, v67
    v_exp_f32 v70, v70
    v_exp_f32 v71, v71
    v_cvt_pk_bf16_f32 v78, v68, v69
    s_nop 0
    v_cvt_pk_bf16_f32 v79, v70, v71
    s_nop 1
    v_mfma_f32_32x32x16_bf16 v[80:95], v[124:127], v[76:79], v[80:95]
    s_mov_b64 exec, s[30:31]
    ds_read_b128 v[112:115], v6 offset:28672
    ds_read_b128 v[116:119], v6 offset:29184
    s_mov_b64 exec, -1
    s_cmp_lg_u32 s37, 0
    s_cbranch_scc1 fp_104
    s_waitcnt vmcnt(0)
    s_barrier
fp_104:
    s_cmp_lg_u32 s21, 1
    s_cbranch_scc1 role_105
    s_setprio 2
role_105:
    s_waitcnt lgkmcnt(2)
    v_mfma_f32_32x32x16_bf16 v[56:71], v[108:111], v[100:103], v[24:39]
    ds_read_b128 v[104:107], v2 offset:30720
    v_exp_f32 v40, v40
    v_exp_f32 v41, v41
    v_exp_f32 v42, v42
    v_exp_f32 v43, v43
    v_cvt_pk_bf16_f32 v72, v40, v41
    v_exp_f32 v44, v44
    v_exp_f32 v45, v45
    v_cvt_pk_bf16_f32 v73, v42, v43
    v_exp_f32 v46, v46
    v_exp_f32 v47, v47
    v_cvt_pk_bf16_f32 v74, v44, v45
    v_exp_f32 v48, v48
    v_exp_f32 v49, v49
    v_cvt_pk_bf16_f32 v75, v46, v47
    v_exp_f32 v50, v50
    v_exp_f32 v51, v51
    s_waitcnt lgkmcnt(1)
    v_mfma_f32_32x32x16_bf16 v[80:95], v[112:115], v[72:75], v[80:95]
    v_cvt_pk_bf16_f32 v76, v48, v49
    v_exp_f32 v52, v52
    v_exp_f32 v53, v53
    v_cvt_pk_bf16_f32 v77, v50, v51
    v_exp_f32 v54, v54
    v_exp_f32 v55, v55
    v_cvt_pk_bf16_f32 v78, v52, v53
    s_nop 0
    v_cvt_pk_bf16_f32 v79, v54, v55
    s_nop 1
    v_mfma_f32_32x32x16_bf16 v[80:95], v[116:119], v[76:79], v[80:95]
    s_mov_b64 exec, s[30:31]
    ds_read_b128 v[120:123], v6 offset:29696
    ds_read_b128 v[124:127], v6 offset:30208
    s_mov_b64 exec, -1
    s_cmp_lg_u32 s23, 0
    s_cbranch_scc1 wm_106
    s_lshr_b32 s26, s2, 3
    s_lshl_b32 s26, s26, 3
    s_add_u32 s26, s26, s18
    v_lshlrev_b32 v7, 7, v1
    s_lshr_b32 s25, s26, 6
    s_mov_b32 s64, s44
    s_mov_b32 s65, s45
    s_mov_b32 s66, 0x80000
    s_mov_b32 s67, 0x00020000
    s_cmp_eq_u32 s25, 1
    s_cselect_b32 s64, s48, s64
    s_cselect_b32 s65, s49, s65
    s_cmp_eq_u32 s25, 2
    s_cselect_b32 s64, s54, s64
    s_cselect_b32 s65, s55, s65
    s_cmp_eq_u32 s25, 3
    s_cselect_b32 s64, s50, s64
    s_cselect_b32 s65, s51, s65
    s_cselect_b32 s66, 0x4000, s66
    s_cmp_ge_u32 s26, 224
    s_cselect_b32 s64, s52, s64
    s_cselect_b32 s65, s53, s65
    s_cselect_b32 s25, 31, 63
    s_and_b32 s24, s26, s25
    s_lshl_b32 s24, s24, 13
    buffer_load_dword v8, v7, s[64:67], s24 offen
wm_106:
    s_mov_b32 s12, s54
    s_cmp_eq_u32 s21, 1
    s_cselect_b32 s12, s42, s12
    s_mov_b32 s13, s55
    s_cmp_eq_u32 s21, 1
    s_cselect_b32 s13, s43, s13
    s_mov_b32 s14, 0x80000
    s_cmp_eq_u32 s21, 1
    s_cselect_b32 s14, 0x180000, s14
    s_mov_b32 s15, 0x00020000
    s_mov_b32 s69, 1024
    s_cmp_eq_u32 s21, 1
    s_cselect_b32 s69, 3072, s69
    s_mov_b32 s68, 0
    v_lshrrev_b32 v10, 2, v1
    v_mul_lo_u32 v10, v10, s69
    v_and_b32 v7, 3, v1
    v_lshl_add_u32 v10, v7, 4, v10
    s_lshl_b32 s69, s69, 4
    s_lshl_b32 s24, s19, 4
    s_mul_i32 s24, s24, s69
    s_add_u32 s68, s68, s24
    s_add_u32 s68, s68, s80
    s_cmp_lg_u32 s23, 0
    s_cselect_b32 s24, 0x7fff0000, 0
    s_cmp_eq_u32 s21, 0
    s_cselect_b32 s24, 0, s24
    s_add_u32 s68, s68, s24
    s_waitcnt lgkmcnt(2)
    v_mfma_f32_32x32x16_bf16 v[40:55], v[104:107], v[100:103], v[24:39]
    ds_read_b128 v[108:111], v2 offset:31744
    v_exp_f32 v56, v56
    v_exp_f32 v57, v57
    v_exp_f32 v58, v58
    v_exp_f32 v59, v59
    v_cvt_pk_bf16_f32 v72, v56, v57
    v_exp_f32 v60, v60
    v_exp_f32 v61, v61
    v_cvt_pk_bf16_f32 v73, v58, v59
    v_exp_f32 v62, v62
    v_exp_f32 v63, v63
    v_cvt_pk_bf16_f32 v74, v60, v61
    v_exp_f32 v64, v64
    v_exp_f32 v65, v65
    v_cvt_pk_bf16_f32 v75, v62, v63
    v_exp_f32 v66, v66
    v_exp_f32 v67, v67
    s_waitcnt lgkmcnt(1)
    v_mfma_f32_32x32x16_bf16 v[80:95], v[120:123], v[72:75], v[80:95]
    s_add_u32 m0, s70, 0
    s_nop 0
    buffer_load_dwordx4 v10, s[12:15], s68 offen lds
    s_add_u32 s68, s68, s69
    v_cvt_pk_bf16_f32 v76, v64, v65
    v_exp_f32 v68, v68
    v_exp_f32 v69, v69
    v_cvt_pk_bf16_f32 v77, v66, v67
    v_exp_f32 v70, v70
    v_exp_f32 v71, v71
    v_cvt_pk_bf16_f32 v78, v68, v69
    s_nop 0
    v_cvt_pk_bf16_f32 v79, v70, v71
    s_nop 1
    v_mfma_f32_32x32x16_bf16 v[80:95], v[124:127], v[76:79], v[80:95]
    s_mov_b64 exec, s[30:31]
    ds_read_b128 v[112:115], v6 offset:30720
    ds_read_b128 v[116:119], v6 offset:31232
    s_mov_b64 exec, -1
    s_waitcnt lgkmcnt(2)
    v_mfma_f32_32x32x16_bf16 v[56:71], v[108:111], v[100:103], v[24:39]
    ds_read_b128 v[104:107], v2 offset:32768
    v_exp_f32 v40, v40
    v_exp_f32 v41, v41
    v_exp_f32 v42, v42
    v_exp_f32 v43, v43
    v_cvt_pk_bf16_f32 v72, v40, v41
    v_exp_f32 v44, v44
    v_exp_f32 v45, v45
    v_cvt_pk_bf16_f32 v73, v42, v43
    v_exp_f32 v46, v46
    v_exp_f32 v47, v47
    v_cvt_pk_bf16_f32 v74, v44, v45
    v_exp_f32 v48, v48
    v_exp_f32 v49, v49
    v_cvt_pk_bf16_f32 v75, v46, v47
    v_exp_f32 v50, v50
    v_exp_f32 v51, v51
    s_waitcnt lgkmcnt(1)
    v_mfma_f32_32x32x16_bf16 v[80:95], v[112:115], v[72:75], v[80:95]
    s_add_u32 m0, s70, 1024
    s_nop 0
    buffer_load_dwordx4 v10, s[12:15], s68 offen lds
    s_add_u32 s68, s68, s69
    v_cvt_pk_bf16_f32 v76, v48, v49
    v_exp_f32 v52, v52
    v_exp_f32 v53, v53
    v_cvt_pk_bf16_f32 v77, v50, v51
    v_exp_f32 v54, v54
    v_exp_f32 v55, v55
    v_cvt_pk_bf16_f32 v78, v52, v53
    s_nop 0
    v_cvt_pk_bf16_f32 v79, v54, v55
    s_nop 1
    v_mfma_f32_32x32x16_bf16 v[80:95], v[116:119], v[76:79], v[80:95]
    s_mov_b64 exec, s[30:31]
    ds_read_b128 v[120:123], v6 offset:31744
    ds_read_b128 v[124:127], v6 offset:32256
    s_mov_b64 exec, -1
    s_waitcnt lgkmcnt(2)
    v_mfma_f32_32x32x16_bf16 v[40:55], v[104:107], v[100:103], v[24:39]
    ds_read_b128 v[108:111], v2 offset:33792
    v_exp_f32 v56, v56
    v_exp_f32 v57, v57
    v_exp_f32 v58, v58
    v_exp_f32 v59, v59
    v_cvt_pk_bf16_f32 v72, v56, v57
    v_exp_f32 v60, v60
    v_exp_f32 v61, v61
    v_cvt_pk_bf16_f32 v73, v58, v59
    v_exp_f32 v62, v62
    v_exp_f32 v63, v63
    v_cvt_pk_bf16_f32 v74, v60, v61
    v_exp_f32 v64, v64
    v_exp_f32 v65, v65
    v_cvt_pk_bf16_f32 v75, v62, v63
    v_exp_f32 v66, v66
    v_exp_f32 v67, v67
    s_waitcnt lgkmcnt(1)
    v_mfma_f32_32x32x16_bf16 v[80:95], v[120:123], v[72:75], v[80:95]
    s_add_u32 m0, s70, 2048
    s_nop 0
    buffer_load_dwordx4 v10, s[12:15], s68 offen lds
    s_add_u32 s68, s68, s69
    v_cvt_pk_bf16_f32 v76, v64, v65
    v_exp_f32 v68, v68
    v_exp_f32 v69, v69
    v_cvt_pk_bf16_f32 v77, v66, v67
    v_exp_f32 v70, v70
    v_exp_f32 v71, v71
    v_cvt_pk_bf16_f32 v78, v68, v69
    s_waitcnt vmcnt(2)
    v_cvt_pk_bf16_f32 v79, v70, v71
    ds_read_b64_tr_b16 v[128:129], v11 offset:0
    ds_read_b64_tr_b16 v[130:131], v11 offset:512
    v_mfma_f32_32x32x16_bf16 v[80:95], v[124:127], v[76:79], v[80:95]
    s_mov_b64 exec, s[30:31]
    ds_read_b128 v[112:115], v6 offset:32768
    ds_read_b128 v[116:119], v6 offset:33280
    s_mov_b64 exec, -1
    s_waitcnt lgkmcnt(4)
    v_mfma_f32_32x32x16_bf16 v[56:71], v[108:111], v[100:103], v[24:39]
    ds_read_b128 v[104:107], v2 offset:34816
    v_exp_f32 v40, v40
    v_exp_f32 v41, v41
    v_exp_f32 v42, v42
    v_exp_f32 v43, v43
    v_cvt_pk_bf16_f32 v72, v40, v41
    v_exp_f32 v44, v44
    v_exp_f32 v45, v45
    v_cvt_pk_bf16_f32 v73, v42, v43
    v_exp_f32 v46, v46
    v_exp_f32 v47, v47
    v_cvt_pk_bf16_f32 v74, v44, v45
    v_exp_f32 v48, v48
    v_exp_f32 v49, v49
    v_cvt_pk_bf16_f32 v75, v46, v47
    v_exp_f32 v50, v50
    v_exp_f32 v51, v51
    s_waitcnt lgkmcnt(1)
    v_mfma_f32_32x32x16_bf16 v[80:95], v[112:115], v[72:75], v[80:95]
    s_add_u32 m0, s70, 3072
    s_nop 0
    buffer_load_dwordx4 v10, s[12:15], s68 offen lds
    s_add_u32 s68, s68, s69
    v_cvt_pk_bf16_f32 v76, v48, v49
    v_exp_f32 v52, v52
    v_exp_f32 v53, v53
    v_cvt_pk_bf16_f32 v77, v50, v51
    v_exp_f32 v54, v54
    v_exp_f32 v55, v55
    v_cvt_pk_bf16_f32 v78, v52, v53
    s_waitcnt vmcnt(2)
    v_cvt_pk_bf16_f32 v79, v54, v55
    ds_read_b64_tr_b16 v[132:133], v11 offset:1024
    ds_read_b64_tr_b16 v[134:135], v11 offset:1536
    v_mfma_f32_32x32x16_bf16 v[80:95], v[116:119], v[76:79], v[80:95]
    s_mov_b64 exec, s[30:31]
    ds_read_b128 v[120:123], v6 offset:33792
    ds_read_b128 v[124:127], v6 offset:34304
    s_mov_b64 exec, -1
    s_waitcnt lgkmcnt(4)
    v_mfma_f32_32x32x16_bf16 v[40:55], v[104:107], v[100:103], v[24:39]
    ds_read_b128 v[108:111], v2 offset:35840
    v_exp_f32 v56, v56
    v_exp_f32 v57, v57
    v_exp_f32 v58, v58
    v_exp_f32 v59, v59
    v_cvt_pk_bf16_f32 v72, v56, v57
    v_exp_f32 v60, v60
    v_exp_f32 v61, v61
    v_cvt_pk_bf16_f32 v73, v58, v59
    v_exp_f32 v62, v62
    v_exp_f32 v63, v63
    v_cvt_pk_bf16_f32 v74, v60, v61
    v_exp_f32 v64, v64
    v_exp_f32 v65, v65
    v_cvt_pk_bf16_f32 v75, v62, v63
    v_exp_f32 v66, v66
    v_exp_f32 v67, v67
    s_waitcnt lgkmcnt(1)
    v_mfma_f32_32x32x16_bf16 v[80:95], v[120:123], v[72:75], v[80:95]
    s_add_u32 m0, s70, 0
    s_nop 0
    buffer_load_dwordx4 v10, s[12:15], s68 offen lds
    s_add_u32 s68, s68, s69
    v_cvt_pk_bf16_f32 v76, v64, v65
    v_exp_f32 v68, v68
    v_exp_f32 v69, v69
    v_cvt_pk_bf16_f32 v77, v66, v67
    v_exp_f32 v70, v70
    v_exp_f32 v71, v71
    v_cvt_pk_bf16_f32 v78, v68, v69
    s_waitcnt vmcnt(2)
    v_cvt_pk_bf16_f32 v79, v70, v71
    ds_read_b64_tr_b16 v[136:137], v11 offset:2048
    ds_read_b64_tr_b16 v[138:139], v11 offset:2560
    v_mfma_f32_32x32x16_bf16 v[80:95], v[124:127], v[76:79], v[80:95]
    s_mov_b64 exec, s[30:31]
    ds_read_b128 v[112:115], v6 offset:34816
    ds_read_b128 v[116:119], v6 offset:35328
    s_mov_b64 exec, -1
    s_waitcnt lgkmcnt(4)
    v_mfma_f32_32x32x16_bf16 v[56:71], v[108:111], v[100:103], v[24:39]
    ds_read_b128 v[104:107], v2 offset:36864
    v_exp_f32 v40, v40
    v_exp_f32 v41, v41
    v_exp_f32 v42, v42
    v_exp_f32 v43, v43
    v_cvt_pk_bf16_f32 v72, v40, v41
    v_exp_f32 v44, v44
    v_exp_f32 v45, v45
    v_cvt_pk_bf16_f32 v73, v42, v43
    v_exp_f32 v46, v46
    v_exp_f32 v47, v47
    v_cvt_pk_bf16_f32 v74, v44, v45
    v_exp_f32 v48, v48
    v_exp_f32 v49, v49
    v_cvt_pk_bf16_f32 v75, v46, v47
    v_exp_f32 v50, v50
    v_exp_f32 v51, v51
    s_waitcnt lgkmcnt(1)
    v_mfma_f32_32x32x16_bf16 v[80:95], v[112:115], v[72:75], v[80:95]
    s_add_u32 m0, s70, 1024
    s_nop 0
    buffer_load_dwordx4 v10, s[12:15], s68 offen lds
    s_add_u32 s68, s68, s69
    v_cvt_pk_bf16_f32 v76, v48, v49
    v_exp_f32 v52, v52
    v_exp_f32 v53, v53
    v_cvt_pk_bf16_f32 v77, v50, v51
    v_exp_f32 v54, v54
    v_exp_f32 v55, v55
    v_cvt_pk_bf16_f32 v78, v52, v53
    s_waitcnt vmcnt(2)
    v_cvt_pk_bf16_f32 v79, v54, v55
    ds_read_b64_tr_b16 v[140:141], v11 offset:3072
    ds_read_b64_tr_b16 v[142:143], v11 offset:3584
    v_mfma_f32_32x32x16_bf16 v[80:95], v[116:119], v[76:79], v[80:95]
    s_mov_b64 exec, s[30:31]
    ds_read_b128 v[120:123], v6 offset:35840
    ds_read_b128 v[124:127], v6 offset:36352
    s_mov_b64 exec, -1
    s_waitcnt lgkmcnt(4)
    v_mfma_f32_32x32x16_bf16 v[40:55], v[104:107], v[100:103], v[24:39]
    ds_read_b128 v[108:111], v2 offset:37888
    v_exp_f32 v56, v56
    v_exp_f32 v57, v57
    v_exp_f32 v58, v58
    v_exp_f32 v59, v59
    v_cvt_pk_bf16_f32 v72, v56, v57
    v_exp_f32 v60, v60
    v_exp_f32 v61, v61
    v_cvt_pk_bf16_f32 v73, v58, v59
    v_exp_f32 v62, v62
    v_exp_f32 v63, v63
    v_cvt_pk_bf16_f32 v74, v60, v61
    v_exp_f32 v64, v64
    v_exp_f32 v65, v65
    v_cvt_pk_bf16_f32 v75, v62, v63
    v_exp_f32 v66, v66
    v_exp_f32 v67, v67
    s_waitcnt lgkmcnt(1)
    v_mfma_f32_32x32x16_bf16 v[80:95], v[120:123], v[72:75], v[80:95]
    s_add_u32 m0, s70, 2048
    s_nop 0
    buffer_load_dwordx4 v10, s[12:15], s68 offen lds
    s_add_u32 s68, s68, s69
    v_cvt_pk_bf16_f32 v76, v64, v65
    v_exp_f32 v68, v68
    v_exp_f32 v69, v69
    v_cvt_pk_bf16_f32 v77, v66, v67
    v_exp_f32 v70, v70
    v_exp_f32 v71, v71
    v_cvt_pk_bf16_f32 v78, v68, v69
    s_waitcnt vmcnt(2)
    v_cvt_pk_bf16_f32 v79, v70, v71
    ds_read_b64_tr_b16 v[144:145], v11 offset:0
    ds_read_b64_tr_b16 v[146:147], v11 offset:512
    v_mfma_f32_32x32x16_bf16 v[80:95], v[124:127], v[76:79], v[80:95]
    s_mov_b64 exec, s[30:31]
    ds_read_b128 v[112:115], v6 offset:36864
    ds_read_b128 v[116:119], v6 offset:37376
    s_mov_b64 exec, -1
    s_waitcnt lgkmcnt(4)
    v_mfma_f32_32x32x16_bf16 v[56:71], v[108:111], v[100:103], v[24:39]
    ds_read_b128 v[104:107], v2 offset:38912
    v_exp_f32 v40, v40
    v_exp_f32 v41, v41
    v_exp_f32 v42, v42
    v_exp_f32 v43, v43
    v_cvt_pk_bf16_f32 v72, v40, v41
    v_exp_f32 v44, v44
    v_exp_f32 v45, v45
    v_cvt_pk_bf16_f32 v73, v42, v43
    v_exp_f32 v46, v46
    v_exp_f32 v47, v47
    v_cvt_pk_bf16_f32 v74, v44, v45
    v_exp_f32 v48, v48
    v_exp_f32 v49, v49
    v_cvt_pk_bf16_f32 v75, v46, v47
    v_exp_f32 v50, v50
    v_exp_f32 v51, v51
    s_waitcnt lgkmcnt(1)
    v_mfma_f32_32x32x16_bf16 v[80:95], v[112:115], v[72:75], v[80:95]
    s_add_u32 m0, s70, 3072
    s_nop 0
    buffer_load_dwordx4 v10, s[12:15], s68 offen lds
    s_add_u32 s68, s68, s69
    v_cvt_pk_bf16_f32 v76, v48, v49
    v_exp_f32 v52, v52
    v_exp_f32 v53, v53
    v_cvt_pk_bf16_f32 v77, v50, v51
    v_exp_f32 v54, v54
    v_exp_f32 v55, v55
    v_cvt_pk_bf16_f32 v78, v52, v53
    s_waitcnt vmcnt(2)
    v_cvt_pk_bf16_f32 v79, v54, v55
    ds_read_b64_tr_b16 v[148:149], v11 offset:1024
    ds_read_b64_tr_b16 v[150:151], v11 offset:1536
    v_mfma_f32_32x32x16_bf16 v[80:95], v[116:119], v[76:79], v[80:95]
    s_mov_b64 exec, s[30:31]
    ds_read_b128 v[120:123], v6 offset:37888
    ds_read_b128 v[124:127], v6 offset:38400
    s_mov_b64 exec, -1
    s_waitcnt lgkmcnt(4)
    v_mfma_f32_32x32x16_bf16 v[40:55], v[104:107], v[100:103], v[24:39]
    ds_read_b128 v[108:111], v2 offset:39936
    v_exp_f32 v56, v56
    v_exp_f32 v57, v57
    v_exp_f32 v58, v58
    v_exp_f32 v59, v59
    v_cvt_pk_bf16_f32 v72, v56, v57
    v_exp_f32 v60, v60
    v_exp_f32 v61, v61
    v_cvt_pk_bf16_f32 v73, v58, v59
    v_exp_f32 v62, v62
    v_exp_f32 v63, v63
    v_cvt_pk_bf16_f32 v74, v60, v61
    v_exp_f32 v64, v64
    v_exp_f32 v65, v65
    v_cvt_pk_bf16_f32 v75, v62, v63
    v_exp_f32 v66, v66
    v_exp_f32 v67, v67
    s_waitcnt lgkmcnt(1)
    v_mfma_f32_32x32x16_bf16 v[80:95], v[120:123], v[72:75], v[80:95]
    s_add_u32 m0, s70, 0
    s_nop 0
    buffer_load_dwordx4 v10, s[12:15], s68 offen lds
    s_add_u32 s68, s68, s69
    v_cvt_pk_bf16_f32 v76, v64, v65
    v_exp_f32 v68, v68
    v_exp_f32 v69, v69
    v_cvt_pk_bf16_f32 v77, v66, v67
    v_exp_f32 v70, v70
    v_exp_f32 v71, v71
    v_cvt_pk_bf16_f32 v78, v68, v69
    s_waitcnt vmcnt(2)
    v_cvt_pk_bf16_f32 v79, v70, v71
    ds_read_b64_tr_b16 v[152:153], v11 offset:2048
    ds_read_b64_tr_b16 v[154:155], v11 offset:2560
    v_mfma_f32_32x32x16_bf16 v[80:95], v[124:127], v[76:79], v[80:95]
    s_mov_b64 exec, s[30:31]
    ds_read_b128 v[112:115], v6 offset:38912
    ds_read_b128 v[116:119], v6 offset:39424
    s_mov_b64 exec, -1
    s_waitcnt lgkmcnt(4)
    v_mfma_f32_32x32x16_bf16 v[56:71], v[108:111], v[100:103], v[24:39]
    ds_read_b128 v[104:107], v2 offset:40960
    v_exp_f32 v40, v40
    v_exp_f32 v41, v41
    v_exp_f32 v42, v42
    v_exp_f32 v43, v43
    v_cvt_pk_bf16_f32 v72, v40, v41
    v_exp_f32 v44, v44
    v_exp_f32 v45, v45
    v_cvt_pk_bf16_f32 v73, v42, v43
    v_exp_f32 v46, v46
    v_exp_f32 v47, v47
    v_cvt_pk_bf16_f32 v74, v44, v45
    v_exp_f32 v48, v48
    v_exp_f32 v49, v49
    v_cvt_pk_bf16_f32 v75, v46, v47
    v_exp_f32 v50, v50
    v_exp_f32 v51, v51
    s_waitcnt lgkmcnt(1)
    v_mfma_f32_32x32x16_bf16 v[80:95], v[112:115], v[72:75], v[80:95]
    s_add_u32 m0, s70, 1024
    s_nop 0
    buffer_load_dwordx4 v10, s[12:15], s68 offen lds
    s_add_u32 s68, s68, s69
    v_cvt_pk_bf16_f32 v76, v48, v49
    v_exp_f32 v52, v52
    v_exp_f32 v53, v53
    v_cvt_pk_bf16_f32 v77, v50, v51
    v_exp_f32 v54, v54
    v_exp_f32 v55, v55
    v_cvt_pk_bf16_f32 v78, v52, v53
    s_waitcnt vmcnt(2)
    v_cvt_pk_bf16_f32 v79, v54, v55
    ds_read_b64_tr_b16 v[156:157], v11 offset:3072
    ds_read_b64_tr_b16 v[158:159], v11 offset:3584
    v_mfma_f32_32x32x16_bf16 v[80:95], v[116:119], v[76:79], v[80:95]
    s_mov_b64 exec, s[30:31]
    ds_read_b128 v[120:123], v6 offset:39936
    ds_read_b128 v[124:127], v6 offset:40448
    s_mov_b64 exec, -1
    s_waitcnt lgkmcnt(4)
    v_mfma_f32_32x32x16_bf16 v[40:55], v[104:107], v[100:103], v[24:39]
    ds_read_b128 v[108:111], v2 offset:41984
    v_exp_f32 v56, v56
    v_exp_f32 v57, v57
    v_exp_f32 v58, v58
    v_exp_f32 v59, v59
    v_cvt_pk_bf16_f32 v72, v56, v57
    v_exp_f32 v60, v60
    v_exp_f32 v61, v61
    v_cvt_pk_bf16_f32 v73, v58, v59
    v_exp_f32 v62, v62
    v_exp_f32 v63, v63
    v_cvt_pk_bf16_f32 v74, v60, v61
    v_exp_f32 v64, v64
    v_exp_f32 v65, v65
    v_cvt_pk_bf16_f32 v75, v62, v63
    v_exp_f32 v66, v66
    v_exp_f32 v67, v67
    s_waitcnt lgkmcnt(1)
    v_mfma_f32_32x32x16_bf16 v[80:95], v[120:123], v[72:75], v[80:95]
    s_add_u32 m0, s70, 2048
    s_nop 0
    buffer_load_dwordx4 v10, s[12:15], s68 offen lds
    s_add_u32 s68, s68, s69
    v_cvt_pk_bf16_f32 v76, v64, v65
    v_exp_f32 v68, v68
    v_exp_f32 v69, v69
    v_cvt_pk_bf16_f32 v77, v66, v67
    v_exp_f32 v70, v70
    v_exp_f32 v71, v71
    v_cvt_pk_bf16_f32 v78, v68, v69
    s_waitcnt vmcnt(2)
    v_cvt_pk_bf16_f32 v79, v70, v71
    ds_read_b64_tr_b16 v[160:161], v11 offset:0
    ds_read_b64_tr_b16 v[162:163], v11 offset:512
    v_mfma_f32_32x32x16_bf16 v[80:95], v[124:127], v[76:79], v[80:95]
    s_mov_b64 exec, s[30:31]
    ds_read_b128 v[112:115], v6 offset:40960
    ds_read_b128 v[116:119], v6 offset:41472
    s_mov_b64 exec, -1
    s_waitcnt lgkmcnt(4)
    v_mfma_f32_32x32x16_bf16 v[56:71], v[108:111], v[100:103], v[24:39]
    ds_read_b128 v[104:107], v2 offset:43008
    v_exp_f32 v40, v40
    v_exp_f32 v41, v41
    v_exp_f32 v42, v42
    v_exp_f32 v43, v43
    v_cvt_pk_bf16_f32 v72, v40, v41
    v_exp_f32 v44, v44
    v_exp_f32 v45, v45
    v_cvt_pk_bf16_f32 v73, v42, v43
    v_exp_f32 v46, v46
    v_exp_f32 v47, v47
    v_cvt_pk_bf16_f32 v74, v44, v45
    v_exp_f32 v48, v48
    v_exp_f32 v49, v49
    v_cvt_pk_bf16_f32 v75, v46, v47
    v_exp_f32 v50, v50
    v_exp_f32 v51, v51
    s_waitcnt lgkmcnt(1)
    v_mfma_f32_32x32x16_bf16 v[80:95], v[112:115], v[72:75], v[80:95]
    s_add_u32 m0, s70, 3072
    s_nop 0
    buffer_load_dwordx4 v10, s[12:15], s68 offen lds
    s_add_u32 s68, s68, s69
    v_cvt_pk_bf16_f32 v76, v48, v49
    v_exp_f32 v52, v52
    v_exp_f32 v53, v53
    v_cvt_pk_bf16_f32 v77, v50, v51
    v_exp_f32 v54, v54
    v_exp_f32 v55, v55
    v_cvt_pk_bf16_f32 v78, v52, v53
    s_waitcnt vmcnt(2)
    v_cvt_pk_bf16_f32 v79, v54, v55
    ds_read_b64_tr_b16 v[164:165], v11 offset:1024
    ds_read_b64_tr_b16 v[166:167], v11 offset:1536
    v_mfma_f32_32x32x16_bf16 v[80:95], v[116:119], v[76:79], v[80:95]
    s_mov_b64 exec, s[30:31]
    ds_read_b128 v[120:123], v6 offset:41984
    ds_read_b128 v[124:127], v6 offset:42496
    s_mov_b64 exec, -1
    s_waitcnt lgkmcnt(4)
    v_mfma_f32_32x32x16_bf16 v[40:55], v[104:107], v[100:103], v[24:39]
    ds_read_b128 v[108:111], v2 offset:44032
    v_exp_f32 v56, v56
    v_exp_f32 v57, v57
    v_exp_f32 v58, v58
    v_exp_f32 v59, v59
    v_cvt_pk_bf16_f32 v72, v56, v57
    v_exp_f32 v60, v60
    v_exp_f32 v61, v61
    v_cvt_pk_bf16_f32 v73, v58, v59
    v_exp_f32 v62, v62
    v_exp_f32 v63, v63
    v_cvt_pk_bf16_f32 v74, v60, v61
    v_exp_f32 v64, v64
    v_exp_f32 v65, v65
    v_cvt_pk_bf16_f32 v75, v62, v63
    v_exp_f32 v66, v66
    v_exp_f32 v67, v67
    s_waitcnt lgkmcnt(1)
    v_mfma_f32_32x32x16_bf16 v[80:95], v[120:123], v[72:75], v[80:95]
    s_add_u32 m0, s70, 0
    s_nop 0
    buffer_load_dwordx4 v10, s[12:15], s68 offen lds
    s_add_u32 s68, s68, s69
    v_cvt_pk_bf16_f32 v76, v64, v65
    v_exp_f32 v68, v68
    v_exp_f32 v69, v69
    v_cvt_pk_bf16_f32 v77, v66, v67
    v_exp_f32 v70, v70
    v_exp_f32 v71, v71
    v_cvt_pk_bf16_f32 v78, v68, v69
    s_waitcnt vmcnt(2)
    v_cvt_pk_bf16_f32 v79, v70, v71
    ds_read_b64_tr_b16 v[168:169], v11 offset:2048
    ds_read_b64_tr_b16 v[170:171], v11 offset:2560
    v_mfma_f32_32x32x16_bf16 v[80:95], v[124:127], v[76:79], v[80:95]
    s_mov_b64 exec, s[30:31]
    ds_read_b128 v[112:115], v6 offset:43008
    ds_read_b128 v[116:119], v6 offset:43520
    s_mov_b64 exec, -1
    s_waitcnt lgkmcnt(4)
    v_mfma_f32_32x32x16_bf16 v[56:71], v[108:111], v[100:103], v[24:39]
    ds_read_b128 v[104:107], v2 offset:45056
    v_exp_f32 v40, v40
    v_exp_f32 v41, v41
    v_exp_f32 v42, v42
    v_exp_f32 v43, v43
    v_cvt_pk_bf16_f32 v72, v40, v41
    v_exp_f32 v44, v44
    v_exp_f32 v45, v45
    v_cvt_pk_bf16_f32 v73, v42, v43
    v_exp_f32 v46, v46
    v_exp_f32 v47, v47
    v_cvt_pk_bf16_f32 v74, v44, v45
    v_exp_f32 v48, v48
    v_exp_f32 v49, v49
    v_cvt_pk_bf16_f32 v75, v46, v47
    v_exp_f32 v50, v50
    v_exp_f32 v51, v51
    s_waitcnt lgkmcnt(1)
    v_mfma_f32_32x32x16_bf16 v[80:95], v[112:115], v[72:75], v[80:95]
    s_add_u32 m0, s70, 1024
    s_nop 0
    buffer_load_dwordx4 v10, s[12:15], s68 offen lds
    s_add_u32 s68, s68, s69
    v_cvt_pk_bf16_f32 v76, v48, v49
    v_exp_f32 v52, v52
    v_exp_f32 v53, v53
    v_cvt_pk_bf16_f32 v77, v50, v51
    v_exp_f32 v54, v54
    v_exp_f32 v55, v55
    v_cvt_pk_bf16_f32 v78, v52, v53
    s_waitcnt vmcnt(2)
    v_cvt_pk_bf16_f32 v79, v54, v55
    ds_read_b64_tr_b16 v[172:173], v11 offset:3072
    ds_read_b64_tr_b16 v[174:175], v11 offset:3584
    v_mfma_f32_32x32x16_bf16 v[80:95], v[116:119], v[76:79], v[80:95]
    s_mov_b64 exec, s[30:31]
    ds_read_b128 v[120:123], v6 offset:44032
    ds_read_b128 v[124:127], v6 offset:44544
    s_mov_b64 exec, -1
    s_waitcnt lgkmcnt(4)
    v_mfma_f32_32x32x16_bf16 v[40:55], v[104:107], v[100:103], v[24:39]
    ds_read_b128 v[108:111], v2 offset:46080
    v_exp_f32 v56, v56
    v_exp_f32 v57, v57
    v_exp_f32 v58, v58
    v_exp_f32 v59, v59
    v_cvt_pk_bf16_f32 v72, v56, v57
    v_exp_f32 v60, v60
    v_exp_f32 v61, v61
    v_cvt_pk_bf16_f32 v73, v58, v59
    v_exp_f32 v62, v62
    v_exp_f32 v63, v63
    v_cvt_pk_bf16_f32 v74, v60, v61
    v_exp_f32 v64, v64
    v_exp_f32 v65, v65
    v_cvt_pk_bf16_f32 v75, v62, v63
    v_exp_f32 v66, v66
    v_exp_f32 v67, v67
    s_waitcnt lgkmcnt(1)
    v_mfma_f32_32x32x16_bf16 v[80:95], v[120:123], v[72:75], v[80:95]
    s_add_u32 m0, s70, 2048
    s_nop 0
    buffer_load_dwordx4 v10, s[12:15], s68 offen lds
    s_add_u32 s68, s68, s69
    v_cvt_pk_bf16_f32 v76, v64, v65
    v_exp_f32 v68, v68
    v_exp_f32 v69, v69
    v_cvt_pk_bf16_f32 v77, v66, v67
    v_exp_f32 v70, v70
    v_exp_f32 v71, v71
    v_cvt_pk_bf16_f32 v78, v68, v69
    s_waitcnt vmcnt(2)
    v_cvt_pk_bf16_f32 v79, v70, v71
    ds_read_b64_tr_b16 v[176:177], v11 offset:0
    ds_read_b64_tr_b16 v[178:179], v11 offset:512
    v_mfma_f32_32x32x16_bf16 v[80:95], v[124:127], v[76:79], v[80:95]
    s_mov_b64 exec, s[30:31]
    ds_read_b128 v[112:115], v6 offset:45056
    ds_read_b128 v[116:119], v6 offset:45568
    s_mov_b64 exec, -1
    s_waitcnt lgkmcnt(4)
    v_mfma_f32_32x32x16_bf16 v[56:71], v[108:111], v[100:103], v[24:39]
    ds_read_b128 v[104:107], v2 offset:47104
    v_exp_f32 v40, v40
    v_exp_f32 v41, v41
    v_exp_f32 v42, v42
    v_exp_f32 v43, v43
    v_cvt_pk_bf16_f32 v72, v40, v41
    v_exp_f32 v44, v44
    v_exp_f32 v45, v45
    v_cvt_pk_bf16_f32 v73, v42, v43
    v_exp_f32 v46, v46
    v_exp_f32 v47, v47
    v_cvt_pk_bf16_f32 v74, v44, v45
    v_exp_f32 v48, v48
    v_exp_f32 v49, v49
    v_cvt_pk_bf16_f32 v75, v46, v47
    v_exp_f32 v50, v50
    v_exp_f32 v51, v51
    s_waitcnt lgkmcnt(1)
    v_mfma_f32_32x32x16_bf16 v[80:95], v[112:115], v[72:75], v[80:95]
    s_add_u32 m0, s70, 3072
    s_nop 0
    buffer_load_dwordx4 v10, s[12:15], s68 offen lds
    s_add_u32 s68, s68, s69
    v_cvt_pk_bf16_f32 v76, v48, v49
    v_exp_f32 v52, v52
    v_exp_f32 v53, v53
    v_cvt_pk_bf16_f32 v77, v50, v51
    v_exp_f32 v54, v54
    v_exp_f32 v55, v55
    v_cvt_pk_bf16_f32 v78, v52, v53
    s_waitcnt vmcnt(2)
    v_cvt_pk_bf16_f32 v79, v54, v55
    ds_read_b64_tr_b16 v[180:181], v11 offset:1024
    ds_read_b64_tr_b16 v[182:183], v11 offset:1536
    v_mfma_f32_32x32x16_bf16 v[80:95], v[116:119], v[76:79], v[80:95]
    s_mov_b64 exec, s[30:31]
    ds_read_b128 v[120:123], v6 offset:46080
    ds_read_b128 v[124:127], v6 offset:46592
    s_mov_b64 exec, -1
    s_mov_b32 s12, s42
    s_mov_b32 s13, s43
    s_mov_b32 s14, 0x180000
    s_mov_b32 s15, 0x00020000
    s_mov_b32 s69, 3072
    s_mov_b32 s68, 1024
    s_cmp_eq_u32 s21, 1
    s_cselect_b32 s68, 2048, s68
    v_lshrrev_b32 v10, 2, v1
    v_mul_lo_u32 v10, v10, s69
    v_and_b32 v7, 3, v1
    v_lshl_add_u32 v10, v7, 4, v10
    s_lshl_b32 s69, s69, 4
    s_lshl_b32 s24, s19, 4
    s_mul_i32 s24, s24, s69
    s_add_u32 s68, s68, s24
    s_add_u32 s68, s68, s80
    s_cmp_lg_u32 s23, 0
    s_cselect_b32 s24, 0x7fff0000, 0
    s_add_u32 s68, s68, s24
    s_waitcnt lgkmcnt(4)
    v_mfma_f32_32x32x16_bf16 v[40:55], v[104:107], v[100:103], v[24:39]
    ds_read_b128 v[108:111], v2 offset:48128
    v_exp_f32 v56, v56
    v_exp_f32 v57, v57
    v_exp_f32 v58, v58
    v_exp_f32 v59, v59
    v_cvt_pk_bf16_f32 v72, v56, v57
    v_exp_f32 v60, v60
    v_exp_f32 v61, v61
    v_cvt_pk_bf16_f32 v73, v58, v59
    v_exp_f32 v62, v62
    v_exp_f32 v63, v63
    v_cvt_pk_bf16_f32 v74, v60, v61
    v_exp_f32 v64, v64
    v_exp_f32 v65, v65
    v_cvt_pk_bf16_f32 v75, v62, v63
    v_exp_f32 v66, v66
    v_exp_f32 v67, v67
    s_waitcnt lgkmcnt(1)
    v_mfma_f32_32x32x16_bf16 v[80:95], v[120:123], v[72:75], v[80:95]
    s_add_u32 m0, s70, 0
    s_nop 0
    buffer_load_dwordx4 v10, s[12:15], s68 offen lds
    s_add_u32 s68, s68, s69
    v_cvt_pk_bf16_f32 v76, v64, v65
    v_exp_f32 v68, v68
    v_exp_f32 v69, v69
    v_cvt_pk_bf16_f32 v77, v66, v67
    v_exp_f32 v70, v70
    v_exp_f32 v71, v71
    v_cvt_pk_bf16_f32 v78, v68, v69
    s_waitcnt vmcnt(2)
    v_cvt_pk_bf16_f32 v79, v70, v71
    ds_read_b64_tr_b16 v[184:185], v11 offset:2048
    ds_read_b64_tr_b16 v[186:187], v11 offset:2560
    v_mfma_f32_32x32x16_bf16 v[80:95], v[124:127], v[76:79], v[80:95]
    s_mov_b64 exec, s[30:31]
    ds_read_b128 v[112:115], v6 offset:47104
    ds_read_b128 v[116:119], v6 offset:47616
    s_mov_b64 exec, -1
    s_waitcnt lgkmcnt(4)
    v_mfma_f32_32x32x16_bf16 v[56:71], v[108:111], v[100:103], v[24:39]
    ds_read_b128 v[104:107], v2 offset:49152
    v_exp_f32 v40, v40
    v_exp_f32 v41, v41
    v_exp_f32 v42, v42
    v_exp_f32 v43, v43
    v_cvt_pk_bf16_f32 v72, v40, v41
    v_exp_f32 v44, v44
    v_exp_f32 v45, v45
    v_cvt_pk_bf16_f32 v73, v42, v43
    v_exp_f32 v46, v46
    v_exp_f32 v47, v47
    v_cvt_pk_bf16_f32 v74, v44, v45
    v_exp_f32 v48, v48
    v_exp_f32 v49, v49
    v_cvt_pk_bf16_f32 v75, v46, v47
    v_exp_f32 v50, v50
    v_exp_f32 v51, v51
    s_waitcnt lgkmcnt(1)
    v_mfma_f32_32x32x16_bf16 v[80:95], v[112:115], v[72:75], v[80:95]
    s_add_u32 m0, s70, 1024
    s_nop 0
    buffer_load_dwordx4 v10, s[12:15], s68 offen lds
    s_add_u32 s68, s68, s69
    v_cvt_pk_bf16_f32 v76, v48, v49
    v_exp_f32 v52, v52
    v_exp_f32 v53, v53
    v_cvt_pk_bf16_f32 v77, v50, v51
    v_exp_f32 v54, v54
    v_exp_f32 v55, v55
    v_cvt_pk_bf16_f32 v78, v52, v53
    s_waitcnt vmcnt(2)
    v_cvt_pk_bf16_f32 v79, v54, v55
    ds_read_b64_tr_b16 v[188:189], v11 offset:3072
    ds_read_b64_tr_b16 v[190:191], v11 offset:3584
    v_mfma_f32_32x32x16_bf16 v[80:95], v[116:119], v[76:79], v[80:95]
    s_mov_b64 exec, s[30:31]
    ds_read_b128 v[120:123], v6 offset:48128
    ds_read_b128 v[124:127], v6 offset:48640
    s_mov_b64 exec, -1
    s_waitcnt lgkmcnt(4)
    v_mfma_f32_32x32x16_bf16 v[40:55], v[104:107], v[100:103], v[24:39]
    ds_read_b128 v[108:111], v2 offset:50176
    v_exp_f32 v56, v56
    v_exp_f32 v57, v57
    v_exp_f32 v58, v58
    v_exp_f32 v59, v59
    v_cvt_pk_bf16_f32 v72, v56, v57
    v_exp_f32 v60, v60
    v_exp_f32 v61, v61
    v_cvt_pk_bf16_f32 v73, v58, v59
    v_exp_f32 v62, v62
    v_exp_f32 v63, v63
    v_cvt_pk_bf16_f32 v74, v60, v61
    v_exp_f32 v64, v64
    v_exp_f32 v65, v65
    v_cvt_pk_bf16_f32 v75, v62, v63
    v_exp_f32 v66, v66
    v_exp_f32 v67, v67
    s_waitcnt lgkmcnt(1)
    v_mfma_f32_32x32x16_bf16 v[80:95], v[120:123], v[72:75], v[80:95]
    s_add_u32 m0, s70, 2048
    s_nop 0
    buffer_load_dwordx4 v10, s[12:15], s68 offen lds
    s_add_u32 s68, s68, s69
    v_cvt_pk_bf16_f32 v76, v64, v65
    v_exp_f32 v68, v68
    v_exp_f32 v69, v69
    v_cvt_pk_bf16_f32 v77, v66, v67
    v_exp_f32 v70, v70
    v_exp_f32 v71, v71
    v_cvt_pk_bf16_f32 v78, v68, v69
    s_waitcnt vmcnt(2)
    v_cvt_pk_bf16_f32 v79, v70, v71
    ds_read_b64_tr_b16 v[192:193], v11 offset:0
    ds_read_b64_tr_b16 v[194:195], v11 offset:512
    v_mfma_f32_32x32x16_bf16 v[80:95], v[124:127], v[76:79], v[80:95]
    s_mov_b64 exec, s[30:31]
    ds_read_b128 v[112:115], v6 offset:49152
    ds_read_b128 v[116:119], v6 offset:49664
    s_mov_b64 exec, -1
    s_waitcnt lgkmcnt(4)
    v_mfma_f32_32x32x16_bf16 v[56:71], v[108:111], v[100:103], v[24:39]
    ds_read_b128 v[104:107], v2 offset:51200
    v_exp_f32 v40, v40
    v_exp_f32 v41, v41
    v_exp_f32 v42, v42
    v_exp_f32 v43, v43
    v_cvt_pk_bf16_f32 v72, v40, v41
    v_exp_f32 v44, v44
    v_exp_f32 v45, v45
    v_cvt_pk_bf16_f32 v73, v42, v43
    v_exp_f32 v46, v46
    v_exp_f32 v47, v47
    v_cvt_pk_bf16_f32 v74, v44, v45
    v_exp_f32 v48, v48
    v_exp_f32 v49, v49
    v_cvt_pk_bf16_f32 v75, v46, v47
    v_exp_f32 v50, v50
    v_exp_f32 v51, v51
    s_waitcnt lgkmcnt(1)
    v_mfma_f32_32x32x16_bf16 v[80:95], v[112:115], v[72:75], v[80:95]
    s_add_u32 m0, s70, 3072
    s_nop 0
    buffer_load_dwordx4 v10, s[12:15], s68 offen lds
    s_add_u32 s68, s68, s69
    v_cvt_pk_bf16_f32 v76, v48, v49
    v_exp_f32 v52, v52
    v_exp_f32 v53, v53
    v_cvt_pk_bf16_f32 v77, v50, v51
    v_exp_f32 v54, v54
    v_exp_f32 v55, v55
    v_cvt_pk_bf16_f32 v78, v52, v53
    s_waitcnt vmcnt(2)
    v_cvt_pk_bf16_f32 v79, v54, v55
    ds_read_b64_tr_b16 v[196:197], v11 offset:1024
    ds_read_b64_tr_b16 v[198:199], v11 offset:1536
    v_mfma_f32_32x32x16_bf16 v[80:95], v[116:119], v[76:79], v[80:95]
    s_mov_b64 exec, s[30:31]
    ds_read_b128 v[120:123], v6 offset:50176
    ds_read_b128 v[124:127], v6 offset:50688
    s_mov_b64 exec, -1
    s_waitcnt lgkmcnt(4)
    v_mfma_f32_32x32x16_bf16 v[40:55], v[104:107], v[100:103], v[24:39]
    ds_read_b128 v[108:111], v2 offset:52224
    v_exp_f32 v56, v56
    v_exp_f32 v57, v57
    v_exp_f32 v58, v58
    v_exp_f32 v59, v59
    v_cvt_pk_bf16_f32 v72, v56, v57
    v_exp_f32 v60, v60
    v_exp_f32 v61, v61
    v_cvt_pk_bf16_f32 v73, v58, v59
    v_exp_f32 v62, v62
    v_exp_f32 v63, v63
    v_cvt_pk_bf16_f32 v74, v60, v61
    v_exp_f32 v64, v64
    v_exp_f32 v65, v65
    v_cvt_pk_bf16_f32 v75, v62, v63
    v_exp_f32 v66, v66
    v_exp_f32 v67, v67
    s_waitcnt lgkmcnt(1)
    v_mfma_f32_32x32x16_bf16 v[80:95], v[120:123], v[72:75], v[80:95]
    s_add_u32 m0, s70, 0
    s_nop 0
    buffer_load_dwordx4 v10, s[12:15], s68 offen lds
    s_add_u32 s68, s68, s69
    v_cvt_pk_bf16_f32 v76, v64, v65
    v_exp_f32 v68, v68
    v_exp_f32 v69, v69
    v_cvt_pk_bf16_f32 v77, v66, v67
    v_exp_f32 v70, v70
    v_exp_f32 v71, v71
    v_cvt_pk_bf16_f32 v78, v68, v69
    s_waitcnt vmcnt(2)
    v_cvt_pk_bf16_f32 v79, v70, v71
    ds_read_b64_tr_b16 v[200:201], v11 offset:2048
    ds_read_b64_tr_b16 v[202:203], v11 offset:2560
    v_mfma_f32_32x32x16_bf16 v[80:95], v[124:127], v[76:79], v[80:95]
    s_mov_b64 exec, s[30:31]
    ds_read_b128 v[112:115], v6 offset:51200
    ds_read_b128 v[116:119], v6 offset:51712
    s_mov_b64 exec, -1
    s_waitcnt lgkmcnt(4)
    v_mfma_f32_32x32x16_bf16 v[56:71], v[108:111], v[100:103], v[24:39]
    ds_read_b128 v[104:107], v2 offset:53248
    v_exp_f32 v40, v40
    v_exp_f32 v41, v41
    v_exp_f32 v42, v42
    v_exp_f32 v43, v43
    v_cvt_pk_bf16_f32 v72, v40, v41
    v_exp_f32 v44, v44
    v_exp_f32 v45, v45
    v_cvt_pk_bf16_f32 v73, v42, v43
    v_exp_f32 v46, v46
    v_exp_f32 v47, v47
    v_cvt_pk_bf16_f32 v74, v44, v45
    v_exp_f32 v48, v48
    v_exp_f32 v49, v49
    v_cvt_pk_bf16_f32 v75, v46, v47
    v_exp_f32 v50, v50
    v_exp_f32 v51, v51
    s_waitcnt lgkmcnt(1)
    v_mfma_f32_32x32x16_bf16 v[80:95], v[112:115], v[72:75], v[80:95]
    s_add_u32 m0, s70, 1024
    s_nop 0
    buffer_load_dwordx4 v10, s[12:15], s68 offen lds
    s_add_u32 s68, s68, s69
    v_cvt_pk_bf16_f32 v76, v48, v49
    v_exp_f32 v52, v52
    v_exp_f32 v53, v53
    v_cvt_pk_bf16_f32 v77, v50, v51
    v_exp_f32 v54, v54
    v_exp_f32 v55, v55
    v_cvt_pk_bf16_f32 v78, v52, v53
    s_waitcnt vmcnt(2)
    v_cvt_pk_bf16_f32 v79, v54, v55
    ds_read_b64_tr_b16 v[204:205], v11 offset:3072
    ds_read_b64_tr_b16 v[206:207], v11 offset:3584
    v_mfma_f32_32x32x16_bf16 v[80:95], v[116:119], v[76:79], v[80:95]
    s_mov_b64 exec, s[30:31]
    ds_read_b128 v[120:123], v6 offset:52224
    ds_read_b128 v[124:127], v6 offset:52736
    s_mov_b64 exec, -1
    s_waitcnt lgkmcnt(4)
    v_mfma_f32_32x32x16_bf16 v[40:55], v[104:107], v[100:103], v[24:39]
    ds_read_b128 v[108:111], v2 offset:54272
    v_exp_f32 v56, v56
    v_exp_f32 v57, v57
    v_exp_f32 v58, v58
    v_exp_f32 v59, v59
    v_cvt_pk_bf16_f32 v72, v56, v57
    v_exp_f32 v60, v60
    v_exp_f32 v61, v61
    v_cvt_pk_bf16_f32 v73, v58, v59
    v_exp_f32 v62, v62
    v_exp_f32 v63, v63
    v_cvt_pk_bf16_f32 v74, v60, v61
    v_exp_f32 v64, v64
    v_exp_f32 v65, v65
    v_cvt_pk_bf16_f32 v75, v62, v63
    v_exp_f32 v66, v66
    v_exp_f32 v67, v67
    s_waitcnt lgkmcnt(1)
    v_mfma_f32_32x32x16_bf16 v[80:95], v[120:123], v[72:75], v[80:95]
    s_add_u32 m0, s70, 2048
    s_nop 0
    buffer_load_dwordx4 v10, s[12:15], s68 offen lds
    s_add_u32 s68, s68, s69
    v_cvt_pk_bf16_f32 v76, v64, v65
    v_exp_f32 v68, v68
    v_exp_f32 v69, v69
    v_cvt_pk_bf16_f32 v77, v66, v67
    v_exp_f32 v70, v70
    v_exp_f32 v71, v71
    v_cvt_pk_bf16_f32 v78, v68, v69
    s_waitcnt vmcnt(2)
    v_cvt_pk_bf16_f32 v79, v70, v71
    ds_read_b64_tr_b16 v[208:209], v11 offset:0
    ds_read_b64_tr_b16 v[210:211], v11 offset:512
    v_mfma_f32_32x32x16_bf16 v[80:95], v[124:127], v[76:79], v[80:95]
    s_mov_b64 exec, s[30:31]
    ds_read_b128 v[112:115], v6 offset:53248
    ds_read_b128 v[116:119], v6 offset:53760
    s_mov_b64 exec, -1
    s_waitcnt lgkmcnt(4)
    v_mfma_f32_32x32x16_bf16 v[56:71], v[108:111], v[100:103], v[24:39]
    ds_read_b128 v[104:107], v2 offset:55296
    v_exp_f32 v40, v40
    v_exp_f32 v41, v41
    v_exp_f32 v42, v42
    v_exp_f32 v43, v43
    v_cvt_pk_bf16_f32 v72, v40, v41
    v_exp_f32 v44, v44
    v_exp_f32 v45, v45
    v_cvt_pk_bf16_f32 v73, v42, v43
    v_exp_f32 v46, v46
    v_exp_f32 v47, v47
    v_cvt_pk_bf16_f32 v74, v44, v45
    v_exp_f32 v48, v48
    v_exp_f32 v49, v49
    v_cvt_pk_bf16_f32 v75, v46, v47
    v_exp_f32 v50, v50
    v_exp_f32 v51, v51
    s_waitcnt lgkmcnt(1)
    v_mfma_f32_32x32x16_bf16 v[80:95], v[112:115], v[72:75], v[80:95]
    s_add_u32 m0, s70, 3072
    s_nop 0
    buffer_load_dwordx4 v10, s[12:15], s68 offen lds
    s_add_u32 s68, s68, s69
    v_cvt_pk_bf16_f32 v76, v48, v49
    v_exp_f32 v52, v52
    v_exp_f32 v53, v53
    v_cvt_pk_bf16_f32 v77, v50, v51
    v_exp_f32 v54, v54
    v_exp_f32 v55, v55
    v_cvt_pk_bf16_f32 v78, v52, v53
    s_waitcnt vmcnt(2)
    v_cvt_pk_bf16_f32 v79, v54, v55
    ds_read_b64_tr_b16 v[212:213], v11 offset:1024
    ds_read_b64_tr_b16 v[214:215], v11 offset:1536
    v_mfma_f32_32x32x16_bf16 v[80:95], v[116:119], v[76:79], v[80:95]
    s_mov_b64 exec, s[30:31]
    ds_read_b128 v[120:123], v6 offset:54272
    ds_read_b128 v[124:127], v6 offset:54784
    s_mov_b64 exec, -1
    s_cmp_lg_u32 s21, 1
    s_cbranch_scc1 role_107
    s_setprio 0
role_107:
    s_waitcnt lgkmcnt(4)
    v_mfma_f32_32x32x16_bf16 v[40:55], v[104:107], v[100:103], v[24:39]
    ds_read_b128 v[108:111], v2 offset:56320
    v_exp_f32 v56, v56
    v_exp_f32 v57, v57
    v_exp_f32 v58, v58
    v_exp_f32 v59, v59
    v_cvt_pk_bf16_f32 v72, v56, v57
    v_exp_f32 v60, v60
    v_exp_f32 v61, v61
    v_cvt_pk_bf16_f32 v73, v58, v59
    v_exp_f32 v62, v62
    v_exp_f32 v63, v63
    v_cvt_pk_bf16_f32 v74, v60, v61
    v_exp_f32 v64, v64
    v_exp_f32 v65, v65
    v_cvt_pk_bf16_f32 v75, v62, v63
    v_exp_f32 v66, v66
    v_exp_f32 v67, v67
    s_waitcnt lgkmcnt(1)
    v_mfma_f32_32x32x16_bf16 v[80:95], v[120:123], v[72:75], v[80:95]
    s_add_u32 m0, s70, 0
    s_nop 0
    buffer_load_dwordx4 v10, s[12:15], s68 offen lds
    s_add_u32 s68, s68, s69
    v_cvt_pk_bf16_f32 v76, v64, v65
    v_exp_f32 v68, v68
    v_exp_f32 v69, v69
    v_cvt_pk_bf16_f32 v77, v66, v67
    v_exp_f32 v70, v70
    v_exp_f32 v71, v71
    v_cvt_pk_bf16_f32 v78, v68, v69
    s_waitcnt vmcnt(2)
    v_cvt_pk_bf16_f32 v79, v70, v71
    ds_read_b64_tr_b16 v[216:217], v11 offset:2048
    ds_read_b64_tr_b16 v[218:219], v11 offset:2560
    v_mfma_f32_32x32x16_bf16 v[80:95], v[124:127], v[76:79], v[80:95]
    s_mov_b64 exec, s[30:31]
    ds_read_b128 v[112:115], v6 offset:55296
    ds_read_b128 v[116:119], v6 offset:55808
    s_mov_b64 exec, -1
    s_waitcnt lgkmcnt(4)
    v_mfma_f32_32x32x16_bf16 v[56:71], v[108:111], v[100:103], v[24:39]
    ds_read_b128 v[104:107], v2 offset:57344
    v_exp_f32 v40, v40
    v_exp_f32 v41, v41
    v_exp_f32 v42, v42
    v_exp_f32 v43, v43
    v_cvt_pk_bf16_f32 v72, v40, v41
    v_exp_f32 v44, v44
    v_exp_f32 v45, v45
    v_cvt_pk_bf16_f32 v73, v42, v43
    v_exp_f32 v46, v46
    v_exp_f32 v47, v47
    v_cvt_pk_bf16_f32 v74, v44, v45
    v_exp_f32 v48, v48
    v_exp_f32 v49, v49
    v_cvt_pk_bf16_f32 v75, v46, v47
    v_exp_f32 v50, v50
    v_exp_f32 v51, v51
    s_waitcnt lgkmcnt(1)
    v_mfma_f32_32x32x16_bf16 v[80:95], v[112:115], v[72:75], v[80:95]
    s_add_u32 m0, s70, 1024
    s_nop 0
    buffer_load_dwordx4 v10, s[12:15], s68 offen lds
    s_add_u32 s68, s68, s69
    v_cvt_pk_bf16_f32 v76, v48, v49
    v_exp_f32 v52, v52
    v_exp_f32 v53, v53
    v_cvt_pk_bf16_f32 v77, v50, v51
    v_exp_f32 v54, v54
    v_exp_f32 v55, v55
    v_cvt_pk_bf16_f32 v78, v52, v53
    s_waitcnt vmcnt(2)
    v_cvt_pk_bf16_f32 v79, v54, v55
    ds_read_b64_tr_b16 v[220:221], v11 offset:3072
    ds_read_b64_tr_b16 v[222:223], v11 offset:3584
    v_mfma_f32_32x32x16_bf16 v[80:95], v[116:119], v[76:79], v[80:95]
    s_mov_b64 exec, s[30:31]
    ds_read_b128 v[120:123], v6 offset:56320
    ds_read_b128 v[124:127], v6 offset:56832
    s_mov_b64 exec, -1
    s_waitcnt lgkmcnt(4)
    v_mfma_f32_32x32x16_bf16 v[40:55], v[104:107], v[100:103], v[24:39]
    ds_read_b128 v[108:111], v2 offset:58368
    v_exp_f32 v56, v56
    v_exp_f32 v57, v57
    v_exp_f32 v58, v58
    v_exp_f32 v59, v59
    v_cvt_pk_bf16_f32 v72, v56, v57
    v_exp_f32 v60, v60
    v_exp_f32 v61, v61
    v_cvt_pk_bf16_f32 v73, v58, v59
    v_exp_f32 v62, v62
    v_exp_f32 v63, v63
    v_cvt_pk_bf16_f32 v74, v60, v61
    v_exp_f32 v64, v64
    v_exp_f32 v65, v65
    v_cvt_pk_bf16_f32 v75, v62, v63
    v_exp_f32 v66, v66
    v_exp_f32 v67, v67
    s_waitcnt lgkmcnt(1)
    v_mfma_f32_32x32x16_bf16 v[80:95], v[120:123], v[72:75], v[80:95]
    s_add_u32 m0, s70, 2048
    s_nop 0
    buffer_load_dwordx4 v10, s[12:15], s68 offen lds
    s_add_u32 s68, s68, s69
    v_cvt_pk_bf16_f32 v76, v64, v65
    v_exp_f32 v68, v68
    v_exp_f32 v69, v69
    v_cvt_pk_bf16_f32 v77, v66, v67
    v_exp_f32 v70, v70
    v_exp_f32 v71, v71
    v_cvt_pk_bf16_f32 v78, v68, v69
    s_waitcnt vmcnt(2)
    v_cvt_pk_bf16_f32 v79, v70, v71
    ds_read_b64_tr_b16 v[224:225], v11 offset:0
    ds_read_b64_tr_b16 v[226:227], v11 offset:512
    v_mfma_f32_32x32x16_bf16 v[80:95], v[124:127], v[76:79], v[80:95]
    s_mov_b64 exec, s[30:31]
    ds_read_b128 v[112:115], v6 offset:57344
    ds_read_b128 v[116:119], v6 offset:57856
    s_mov_b64 exec, -1
    s_waitcnt lgkmcnt(4)
    v_mfma_f32_32x32x16_bf16 v[56:71], v[108:111], v[100:103], v[24:39]
    ds_read_b128 v[104:107], v2 offset:59392
    v_exp_f32 v40, v40
    v_exp_f32 v41, v41
    v_exp_f32 v42, v42
    v_exp_f32 v43, v43
    v_cvt_pk_bf16_f32 v72, v40, v41
    v_exp_f32 v44, v44
    v_exp_f32 v45, v45
    v_cvt_pk_bf16_f32 v73, v42, v43
    v_exp_f32 v46, v46
    v_exp_f32 v47, v47
    v_cvt_pk_bf16_f32 v74, v44, v45
    v_exp_f32 v48, v48
    v_exp_f32 v49, v49
    v_cvt_pk_bf16_f32 v75, v46, v47
    v_exp_f32 v50, v50
    v_exp_f32 v51, v51
    s_waitcnt lgkmcnt(1)
    v_mfma_f32_32x32x16_bf16 v[80:95], v[112:115], v[72:75], v[80:95]
    s_add_u32 m0, s70, 3072
    s_nop 0
    buffer_load_dwordx4 v10, s[12:15], s68 offen lds
    s_add_u32 s68, s68, s69
    v_cvt_pk_bf16_f32 v76, v48, v49
    v_exp_f32 v52, v52
    v_exp_f32 v53, v53
    v_cvt_pk_bf16_f32 v77, v50, v51
    v_exp_f32 v54, v54
    v_exp_f32 v55, v55
    v_cvt_pk_bf16_f32 v78, v52, v53
    s_waitcnt vmcnt(2)
    v_cvt_pk_bf16_f32 v79, v54, v55
    ds_read_b64_tr_b16 v[228:229], v11 offset:1024
    ds_read_b64_tr_b16 v[230:231], v11 offset:1536
    v_mfma_f32_32x32x16_bf16 v[80:95], v[116:119], v[76:79], v[80:95]
    s_mov_b64 exec, s[30:31]
    ds_read_b128 v[120:123], v6 offset:58368
    ds_read_b128 v[124:127], v6 offset:58880
    s_mov_b64 exec, -1
    s_waitcnt lgkmcnt(4)
    v_mfma_f32_32x32x16_bf16 v[40:55], v[104:107], v[100:103], v[24:39]
    ds_read_b128 v[108:111], v2 offset:60416
    v_exp_f32 v56, v56
    v_exp_f32 v57, v57
    v_exp_f32 v58, v58
    v_exp_f32 v59, v59
    v_cvt_pk_bf16_f32 v72, v56, v57
    v_exp_f32 v60, v60
    v_exp_f32 v61, v61
    v_cvt_pk_bf16_f32 v73, v58, v59
    v_exp_f32 v62, v62
    v_exp_f32 v63, v63
    v_cvt_pk_bf16_f32 v74, v60, v61
    v_exp_f32 v64, v64
    v_exp_f32 v65, v65
    v_cvt_pk_bf16_f32 v75, v62, v63
    v_exp_f32 v66, v66
    v_exp_f32 v67, v67
    s_waitcnt lgkmcnt(1)
    v_mfma_f32_32x32x16_bf16 v[80:95], v[120:123], v[72:75], v[80:95]
    s_add_u32 m0, s70, 0
    s_nop 0
    buffer_load_dwordx4 v10, s[12:15], s68 offen lds
    s_add_u32 s68, s68, s69
    v_cvt_pk_bf16_f32 v76, v64, v65
    v_exp_f32 v68, v68
    v_exp_f32 v69, v69
    v_cvt_pk_bf16_f32 v77, v66, v67
    v_exp_f32 v70, v70
    v_exp_f32 v71, v71
    v_cvt_pk_bf16_f32 v78, v68, v69
    s_waitcnt vmcnt(2)
    v_cvt_pk_bf16_f32 v79, v70, v71
    ds_read_b64_tr_b16 v[232:233], v11 offset:2048
    ds_read_b64_tr_b16 v[234:235], v11 offset:2560
    v_mfma_f32_32x32x16_bf16 v[80:95], v[124:127], v[76:79], v[80:95]
    s_mov_b64 exec, s[30:31]
    ds_read_b128 v[112:115], v6 offset:59392
    ds_read_b128 v[116:119], v6 offset:59904
    s_mov_b64 exec, -1
    s_waitcnt lgkmcnt(4)
    v_mfma_f32_32x32x16_bf16 v[56:71], v[108:111], v[100:103], v[24:39]
    ds_read_b128 v[104:107], v2 offset:61440
    v_exp_f32 v40, v40
    v_exp_f32 v41, v41
    v_exp_f32 v42, v42
    v_exp_f32 v43, v43
    v_cvt_pk_bf16_f32 v72, v40, v41
    v_exp_f32 v44, v44
    v_exp_f32 v45, v45
    v_cvt_pk_bf16_f32 v73, v42, v43
    v_exp_f32 v46, v46
    v_exp_f32 v47, v47
    v_cvt_pk_bf16_f32 v74, v44, v45
    v_exp_f32 v48, v48
    v_exp_f32 v49, v49
    v_cvt_pk_bf16_f32 v75, v46, v47
    v_exp_f32 v50, v50
    v_exp_f32 v51, v51
    s_waitcnt lgkmcnt(1)
    v_mfma_f32_32x32x16_bf16 v[80:95], v[112:115], v[72:75], v[80:95]
    s_add_u32 m0, s70, 1024
    s_nop 0
    buffer_load_dwordx4 v10, s[12:15], s68 offen lds
    s_add_u32 s68, s68, s69
    v_cvt_pk_bf16_f32 v76, v48, v49
    v_exp_f32 v52, v52
    v_exp_f32 v53, v53
    v_cvt_pk_bf16_f32 v77, v50, v51
    v_exp_f32 v54, v54
    v_exp_f32 v55, v55
    v_cvt_pk_bf16_f32 v78, v52, v53
    s_waitcnt vmcnt(2)
    v_cvt_pk_bf16_f32 v79, v54, v55
    ds_read_b64_tr_b16 v[236:237], v11 offset:3072
    ds_read_b64_tr_b16 v[238:239], v11 offset:3584
    v_mfma_f32_32x32x16_bf16 v[80:95], v[116:119], v[76:79], v[80:95]
    s_mov_b64 exec, s[30:31]
    ds_read_b128 v[120:123], v6 offset:60416
    ds_read_b128 v[124:127], v6 offset:60928
    s_mov_b64 exec, -1
    s_waitcnt lgkmcnt(4)
    v_mfma_f32_32x32x16_bf16 v[40:55], v[104:107], v[100:103], v[24:39]
    ds_read_b128 v[108:111], v2 offset:62464
    v_exp_f32 v56, v56
    v_exp_f32 v57, v57
    v_exp_f32 v58, v58
    v_exp_f32 v59, v59
    v_cvt_pk_bf16_f32 v72, v56, v57
    v_exp_f32 v60, v60
    v_exp_f32 v61, v61
    v_cvt_pk_bf16_f32 v73, v58, v59
    v_exp_f32 v62, v62
    v_exp_f32 v63, v63
    v_cvt_pk_bf16_f32 v74, v60, v61
    v_exp_f32 v64, v64
    v_exp_f32 v65, v65
    v_cvt_pk_bf16_f32 v75, v62, v63
    v_exp_f32 v66, v66
    v_exp_f32 v67, v67
    s_waitcnt lgkmcnt(1)
    v_mfma_f32_32x32x16_bf16 v[80:95], v[120:123], v[72:75], v[80:95]
    s_add_u32 m0, s70, 2048
    s_nop 0
    buffer_load_dwordx4 v10, s[12:15], s68 offen lds
    s_add_u32 s68, s68, s69
    v_cvt_pk_bf16_f32 v76, v64, v65
    v_exp_f32 v68, v68
    v_exp_f32 v69, v69
    v_cvt_pk_bf16_f32 v77, v66, v67
    v_exp_f32 v70, v70
    v_exp_f32 v71, v71
    v_cvt_pk_bf16_f32 v78, v68, v69
    s_waitcnt vmcnt(2)
    v_cvt_pk_bf16_f32 v79, v70, v71
    ds_read_b64_tr_b16 v[240:241], v11 offset:0
    ds_read_b64_tr_b16 v[242:243], v11 offset:512
    v_mfma_f32_32x32x16_bf16 v[80:95], v[124:127], v[76:79], v[80:95]
    s_mov_b64 exec, s[30:31]
    ds_read_b128 v[112:115], v6 offset:61440
    ds_read_b128 v[116:119], v6 offset:61952
    s_mov_b64 exec, -1
    s_waitcnt lgkmcnt(4)
    v_mfma_f32_32x32x16_bf16 v[56:71], v[108:111], v[100:103], v[24:39]
    ds_read_b128 v[104:107], v2 offset:63488
    v_exp_f32 v40, v40
    v_exp_f32 v41, v41
    v_exp_f32 v42, v42
    v_exp_f32 v43, v43
    v_cvt_pk_bf16_f32 v72, v40, v41
    v_exp_f32 v44, v44
    v_exp_f32 v45, v45
    v_cvt_pk_bf16_f32 v73, v42, v43
    v_exp_f32 v46, v46
    v_exp_f32 v47, v47
    v_cvt_pk_bf16_f32 v74, v44, v45
    v_exp_f32 v48, v48
    v_exp_f32 v49, v49
    v_cvt_pk_bf16_f32 v75, v46, v47
    v_exp_f32 v50, v50
    v_exp_f32 v51, v51
    s_waitcnt lgkmcnt(1)
    v_mfma_f32_32x32x16_bf16 v[80:95], v[112:115], v[72:75], v[80:95]
    s_add_u32 m0, s70, 3072
    s_nop 0
    buffer_load_dwordx4 v10, s[12:15], s68 offen lds
    s_add_u32 s68, s68, s69
    v_cvt_pk_bf16_f32 v76, v48, v49
    v_exp_f32 v52, v52
    v_exp_f32 v53, v53
    v_cvt_pk_bf16_f32 v77, v50, v51
    v_exp_f32 v54, v54
    v_exp_f32 v55, v55
    v_cvt_pk_bf16_f32 v78, v52, v53
    s_waitcnt vmcnt(2)
    v_cvt_pk_bf16_f32 v79, v54, v55
    ds_read_b64_tr_b16 v[244:245], v11 offset:1024
    ds_read_b64_tr_b16 v[246:247], v11 offset:1536
    v_mfma_f32_32x32x16_bf16 v[80:95], v[116:119], v[76:79], v[80:95]
    s_mov_b64 exec, s[30:31]
    ds_read_b128 v[120:123], v6 offset:62464
    ds_read_b128 v[124:127], v6 offset:62976
    s_mov_b64 exec, -1
    s_waitcnt lgkmcnt(4)
    v_mfma_f32_32x32x16_bf16 v[40:55], v[104:107], v[100:103], v[24:39]
    ds_read_b128 v[108:111], v2 offset:64512
    v_exp_f32 v56, v56
    v_exp_f32 v57, v57
    v_exp_f32 v58, v58
    v_exp_f32 v59, v59
    v_cvt_pk_bf16_f32 v72, v56, v57
    v_exp_f32 v60, v60
    v_exp_f32 v61, v61
    v_cvt_pk_bf16_f32 v73, v58, v59
    v_exp_f32 v62, v62
    v_exp_f32 v63, v63
    v_cvt_pk_bf16_f32 v74, v60, v61
    v_exp_f32 v64, v64
    v_exp_f32 v65, v65
    v_cvt_pk_bf16_f32 v75, v62, v63
    v_exp_f32 v66, v66
    v_exp_f32 v67, v67
    s_waitcnt lgkmcnt(1)
    v_mfma_f32_32x32x16_bf16 v[80:95], v[120:123], v[72:75], v[80:95]
    v_cvt_pk_bf16_f32 v76, v64, v65
    v_exp_f32 v68, v68
    v_exp_f32 v69, v69
    v_cvt_pk_bf16_f32 v77, v66, v67
    v_exp_f32 v70, v70
    v_exp_f32 v71, v71
    v_cvt_pk_bf16_f32 v78, v68, v69
    s_waitcnt vmcnt(1)
    v_cvt_pk_bf16_f32 v79, v70, v71
    ds_read_b64_tr_b16 v[248:249], v11 offset:2048
    ds_read_b64_tr_b16 v[250:251], v11 offset:2560
    v_mfma_f32_32x32x16_bf16 v[80:95], v[124:127], v[76:79], v[80:95]
    s_mov_b64 exec, s[30:31]
    ds_read_b128 v[112:115], v6 offset:63488
    ds_read_b128 v[116:119], v6 offset:64000
    s_mov_b64 exec, -1
    s_waitcnt lgkmcnt(4)
    v_mfma_f32_32x32x16_bf16 v[56:71], v[108:111], v[100:103], v[24:39]
    v_exp_f32 v40, v40
    v_exp_f32 v41, v41
    v_exp_f32 v42, v42
    v_exp_f32 v43, v43
    v_cvt_pk_bf16_f32 v72, v40, v41
    v_exp_f32 v44, v44
    v_exp_f32 v45, v45
    v_cvt_pk_bf16_f32 v73, v42, v43
    v_exp_f32 v46, v46
    v_exp_f32 v47, v47
    v_cvt_pk_bf16_f32 v74, v44, v45
    v_exp_f32 v48, v48
    v_exp_f32 v49, v49
    v_cvt_pk_bf16_f32 v75, v46, v47
    v_exp_f32 v50, v50
    v_exp_f32 v51, v51
    s_waitcnt lgkmcnt(0)
    v_mfma_f32_32x32x16_bf16 v[80:95], v[112:115], v[72:75], v[80:95]
    v_cvt_pk_bf16_f32 v76, v48, v49
    v_exp_f32 v52, v52
    v_exp_f32 v53, v53
    v_cvt_pk_bf16_f32 v77, v50, v51
    v_exp_f32 v54, v54
    v_exp_f32 v55, v55
    v_cvt_pk_bf16_f32 v78, v52, v53
    s_waitcnt vmcnt(0)
    v_cvt_pk_bf16_f32 v79, v54, v55
    ds_read_b64_tr_b16 v[252:253], v11 offset:3072
    ds_read_b64_tr_b16 v[254:255], v11 offset:3584
    v_mfma_f32_32x32x16_bf16 v[80:95], v[116:119], v[76:79], v[80:95]
    s_mov_b64 exec, s[30:31]
    ds_read_b128 v[120:123], v6 offset:64512
    ds_read_b128 v[124:127], v6 offset:65024
    s_mov_b64 exec, -1
    v_exp_f32 v56, v56
    v_exp_f32 v57, v57
    v_exp_f32 v58, v58
    v_exp_f32 v59, v59
    v_cvt_pk_bf16_f32 v72, v56, v57
    v_exp_f32 v60, v60
    v_exp_f32 v61, v61
    v_cvt_pk_bf16_f32 v73, v58, v59
    v_exp_f32 v62, v62
    v_exp_f32 v63, v63
    v_cvt_pk_bf16_f32 v74, v60, v61
    v_exp_f32 v64, v64
    v_exp_f32 v65, v65
    v_cvt_pk_bf16_f32 v75, v62, v63
    v_exp_f32 v66, v66
    v_exp_f32 v67, v67
    s_waitcnt lgkmcnt(0)
    v_mfma_f32_32x32x16_bf16 v[80:95], v[120:123], v[72:75], v[80:95]
    v_cvt_pk_bf16_f32 v76, v64, v65
    v_exp_f32 v68, v68
    v_exp_f32 v69, v69
    v_cvt_pk_bf16_f32 v77, v66, v67
    v_exp_f32 v70, v70
    v_exp_f32 v71, v71
    v_cvt_pk_bf16_f32 v78, v68, v69
    s_nop 0
    v_cvt_pk_bf16_f32 v79, v70, v71
    s_nop 1
    v_mfma_f32_32x32x16_bf16 v[80:95], v[124:127], v[76:79], v[80:95]
    s_setprio 0
    s_nop 15
    s_cmp_eq_u32 s37, 1
    s_cbranch_scc1 at_ok_79
    v_max3_f32 v8, abs(v80), abs(v81), abs(v82)
    v_max3_f32 v9, abs(v83), abs(v84), abs(v85)
    v_max3_f32 v8, abs(v86), abs(v87), v8
    v_max_f32 v8, v8, v9
    v_cmp_nle_f32 vcc, 0x13000000, v88
    s_mov_b64 s[64:65], vcc
    v_cmp_nge_f32 vcc, 0x6c800000, v88
    s_nop 3
    s_or_b64 s[64:65], s[64:65], vcc
    v_cmp_nge_f32 vcc, 0x7e800000, v8
    s_nop 3
    s_or_b64 s[64:65], s[64:65], vcc
    s_cmp_eq_u64 s[64:65], 0
    s_cbranch_scc1 at_ok_79
    s_mov_b32 s37, 1
    v_mov_b32 v10, 0xff800000
    v_mov_b32 v5, v2
    s_mov_b32 s36, 0
at_mx_80:
    ds_read_b128 v[104:107], v5
    s_waitcnt lgkmcnt(0)
    v_mfma_f32_32x32x16_bf16 v[40:55], v[104:107], v[100:103], 0
    s_nop 15
    v_max3_f32 v10, v10, v40, v41
    v_max3_f32 v10, v10, v42, v43
    v_max3_f32 v10, v10, v44, v45
    v_max3_f32 v10, v10, v46, v47
    v_max3_f32 v10, v10, v48, v49
    v_max3_f32 v10, v10, v50, v51
    v_max3_f32 v10, v10, v52, v53
    v_max3_f32 v10, v10, v54, v55
    v_add_u32 v5, 1024, v5
    s_add_u32 s36, s36, 1
    s_cmp_lt_u32 s36, 64
    s_cbranch_scc1 at_mx_80
    v_mov_b32 v9, v10
    s_nop 1
    v_permlane32_swap_b32 v10, v9
    s_nop 1
    v_max_f32 v10, v10, v9
    v_sub_f32 v10, 0, v10
    s_branch at_run_78
at_ok_79:
    v_rcp_f32 v8, v88
    s_nop 0
    v_mul_f32 v80, v80, v8
    v_mul_f32 v81, v81, v8
    v_mul_f32 v82, v82, v8
    v_mul_f32 v83, v83, v8
    v_mul_f32 v84, v84, v8
    v_mul_f32 v85, v85, v8
    v_mul_f32 v86, v86, v8
    v_mul_f32 v87, v87, v8
    v_cvt_pk_bf16_f32 v72, v80, v81
    v_cvt_pk_bf16_f32 v73, v82, v83
    v_cvt_pk_bf16_f32 v74, v84, v85
    v_cvt_pk_bf16_f32 v75, v86, v87
    s_add_u32 s24, s22, s73
    s_cmp_eq_u32 s62, 1
    s_cbranch_scc1 fs_108
    buffer_store_dwordx4 v[72:75], v2, s[4:7], s24 offen sc1
    s_branch fs_109
fs_108:
    buffer_store_dwordx4 v[72:75], v2, s[4:7], s24 offen
fs_109:
    s_add_u32 s38, s38, 1
    s_lshl_b32 s24, s38, 4
    s_add_u32 s24, s24, s32
    s_add_u32 s24, s24, s91
    v_mov_b32 v6, s24
    v_mov_b32 v7, s33
    s_waitcnt vmcnt(0) lgkmcnt(0)
    s_mov_b64 exec, 1
    s_cmp_eq_u32 s62, 1
    s_cbranch_scc1 fs_110
    buffer_store_dwordx2 v[6:7], v96, s[4:7], 0 offen sc1
    s_branch fs_111
fs_110:
    buffer_store_dwordx2 v[6:7], v96, s[4:7], 0 offen
fs_111:
    s_mov_b64 exec, -1
    s_cmp_lg_u32 s21, 0
    s_cbranch_scc1 ie_112
    s_barrier
    ds_read_b128 v[24:27], v4 offset:0
    ds_read_b128 v[28:31], v3 offset:0
    ds_read_b128 v[32:35], v4 offset:1024
    ds_read_b128 v[36:39], v3 offset:1024
    ds_read_b128 v[100:103], v4 offset:2048
    ds_read_b128 v[104:107], v3 offset:2048
    ds_read_b128 v[108:111], v4 offset:3072
    ds_read_b128 v[112:115], v3 offset:3072
    s_waitcnt lgkmcnt(6)
    v_mfma_f32_32x32x16_bf16 v[40:55], v[128:131], v[24:27], 0
    v_mfma_f32_32x32x16_bf16 v[56:71], v[128:131], v[28:31], 0
    s_barrier
    ds_read_b128 v[24:27], v4 offset:4096
    ds_read_b128 v[28:31], v3 offset:4096
    s_waitcnt lgkmcnt(6)
    v_mfma_f32_32x32x16_bf16 v[40:55], v[132:135], v[32:35], v[40:55]
    v_mfma_f32_32x32x16_bf16 v[56:71], v[132:135], v[36:39], v[56:71]
    ds_read_b128 v[32:35], v4 offset:5120
    ds_read_b128 v[36:39], v3 offset:5120
    s_waitcnt lgkmcnt(6)
    v_mfma_f32_32x32x16_bf16 v[40:55], v[136:139], v[100:103], v[40:55]
    v_mfma_f32_32x32x16_bf16 v[56:71], v[136:139], v[104:107], v[56:71]
    ds_read_b128 v[100:103], v4 offset:6144
    ds_read_b128 v[104:107], v3 offset:6144
    s_waitcnt lgkmcnt(6)
    v_mfma_f32_32x32x16_bf16 v[40:55], v[140:143], v[108:111], v[40:55]
    v_mfma_f32_32x32x16_bf16 v[56:71], v[140:143], v[112:115], v[56:71]
    ds_read_b128 v[108:111], v4 offset:7168
    ds_read_b128 v[112:115], v3 offset:7168
    s_waitcnt lgkmcnt(6)
    v_mfma_f32_32x32x16_bf16 v[40:55], v[144:147], v[24:27], v[40:55]
    v_mfma_f32_32x32x16_bf16 v[56:71], v[144:147], v[28:31], v[56:71]
    s_barrier
    ds_read_b128 v[24:27], v4 offset:8192
    ds_read_b128 v[28:31], v3 offset:8192
    s_waitcnt lgkmcnt(6)
    v_mfma_f32_32x32x16_bf16 v[40:55], v[148:151], v[32:35], v[40:55]
    v_mfma_f32_32x32x16_bf16 v[56:71], v[148:151], v[36:39], v[56:71]
    ds_read_b128 v[32:35], v4 offset:9216
    ds_read_b128 v[36:39], v3 offset:9216
    s_waitcnt lgkmcnt(6)
    v_mfma_f32_32x32x16_bf16 v[40:55], v[152:155], v[100:103], v[40:55]
    v_mfma_f32_32x32x16_bf16 v[56:71], v[152:155], v[104:107], v[56:71]
    ds_read_b128 v[100:103], v4 offset:10240
    ds_read_b128 v[104:107], v3 offset:10240
    s_waitcnt lgkmcnt(6)
    v_mfma_f32_32x32x16_bf16 v[40:55], v[156:159], v[108:111], v[40:55]
    v_mfma_f32_32x32x16_bf16 v[56:71], v[156:159], v[112:115], v[56:71]
    ds_read_b128 v[108:111], v4 offset:11264
    ds_read_b128 v[112:115], v3 offset:11264
    s_waitcnt lgkmcnt(6)
    v_mfma_f32_32x32x16_bf16 v[40:55], v[160:163], v[24:27], v[40:55]
    v_mfma_f32_32x32x16_bf16 v[56:71], v[160:163], v[28:31], v[56:71]
    s_barrier
    ds_read_b128 v[24:27], v4 offset:12288
    ds_read_b128 v[28:31], v3 offset:12288
    s_waitcnt lgkmcnt(6)
    v_mfma_f32_32x32x16_bf16 v[40:55], v[164:167], v[32:35], v[40:55]
    v_mfma_f32_32x32x16_bf16 v[56:71], v[164:167], v[36:39], v[56:71]
    ds_read_b128 v[32:35], v4 offset:13312
    ds_read_b128 v[36:39], v3 offset:13312
    s_waitcnt lgkmcnt(6)
    v_mfma_f32_32x32x16_bf16 v[40:55], v[168:171], v[100:103], v[40:55]
    v_mfma_f32_32x32x16_bf16 v[56:71], v[168:171], v[104:107], v[56:71]
    ds_read_b128 v[100:103], v4 offset:14336
    ds_read_b128 v[104:107], v3 offset:14336
    s_waitcnt lgkmcnt(6)
    v_mfma_f32_32x32x16_bf16 v[40:55], v[172:175], v[108:111], v[40:55]
    v_mfma_f32_32x32x16_bf16 v[56:71], v[172:175], v[112:115], v[56:71]
    ds_read_b128 v[108:111], v4 offset:15360
    ds_read_b128 v[112:115], v3 offset:15360
    s_waitcnt lgkmcnt(6)
    v_mfma_f32_32x32x16_bf16 v[40:55], v[176:179], v[24:27], v[40:55]
    v_mfma_f32_32x32x16_bf16 v[56:71], v[176:179], v[28:31], v[56:71]
    s_waitcnt lgkmcnt(4)
    v_mfma_f32_32x32x16_bf16 v[40:55], v[180:183], v[32:35], v[40:55]
    v_mfma_f32_32x32x16_bf16 v[56:71], v[180:183], v[36:39], v[56:71]
    s_waitcnt lgkmcnt(2)
    v_mfma_f32_32x32x16_bf16 v[40:55], v[184:187], v[100:103], v[40:55]
    v_mfma_f32_32x32x16_bf16 v[56:71], v[184:187], v[104:107], v[56:71]
    s_waitcnt lgkmcnt(0)
    v_mfma_f32_32x32x16_bf16 v[40:55], v[188:191], v[108:111], v[40:55]
    v_mfma_f32_32x32x16_bf16 v[56:71], v[188:191], v[112:115], v[56:71]
    s_lshl_b32 s24, s20, 13
    s_mul_i32 s25, s19, 6144
    s_add_u32 s24, s24, s25
    s_add_u32 s24, s24, 65536
    v_add_u32 v5, s24, v2
    v_xor_b32 v6, 4096, v5
    s_nop 6
    ds_write_b128 v5, v[48:51] offset:16384
    ds_write_b128 v5, v[52:55] offset:17408
    ds_write_b128 v6, v[56:59] offset:0
    ds_write_b128 v6, v[60:63] offset:1024
    ds_write_b128 v6, v[64:67] offset:16384
    ds_write_b128 v6, v[68:71] offset:17408
    s_branch ie_113
ie_112:
    s_lshl_b32 s65, s38, 4
    s_add_u32 s65, s65, s32
    s_mov_b32 s63, 0
    buffer_load_dwordx2 v[8:9], v98, s[4:7], 0 offen sc1
cw_114:
    s_add_u32 s63, s63, 1
    s_cmp_gt_u32 s63, 200000
    s_cbranch_scc1 L_end
    s_sleep 1
    buffer_load_dwordx2 v[92:93], v98, s[4:7], 0 offen sc1
    s_waitcnt vmcnt(1)
    v_subrev_u32 v8, s65, v8
    v_xor_b32 v9, s33, v9
    v_lshrrev_b32 v8, 12, v8
    v_or_b32 v7, v8, v9
    v_cmp_ne_u32 vcc, 0, v7
    s_cbranch_vccz co_115
    s_sleep 1
    buffer_load_dwordx2 v[8:9], v98, s[4:7], 0 offen sc1
    s_waitcnt vmcnt(1)
    v_subrev_u32 v92, s65, v92
    v_xor_b32 v93, s33, v93
    v_lshrrev_b32 v92, 12, v92
    v_or_b32 v7, v92, v93
    v_cmp_ne_u32 vcc, 0, v7
    s_cbranch_vccnz cw_114
co_115:
    s_lshl_b32 s85, s19, 15
    s_lshl_b32 s26, s20, 14
    s_add_u32 s85, s85, s26
    s_add_u32 s84, s73, s81
    s_add_u32 s84, s84, s85
    s_mov_b32 m0, s85
    s_add_u32 s85, s85, 4096
    buffer_load_dwordx4 v2, s[4:7], s84 offen offset:0 sc1 lds
    buffer_load_dwordx4 v2, s[4:7], s84 offen offset:1024 sc1 lds
    buffer_load_dwordx4 v2, s[4:7], s84 offen offset:2048 sc1 lds
    buffer_load_dwordx4 v2, s[4:7], s84 offen offset:3072 sc1 lds
    s_add_u32 s84, s84, 4096
    s_mov_b32 m0, s85
    s_add_u32 s85, s85, 4096
    buffer_load_dwordx4 v2, s[4:7], s84 offen offset:0 sc1 lds
    buffer_load_dwordx4 v2, s[4:7], s84 offen offset:1024 sc1 lds
    buffer_load_dwordx4 v2, s[4:7], s84 offen offset:2048 sc1 lds
    buffer_load_dwordx4 v2, s[4:7], s84 offen offset:3072 sc1 lds
    s_add_u32 s84, s84, 4096
    s_waitcnt vmcnt(4)
    s_barrier
    s_mov_b32 m0, s85
    s_add_u32 s85, s85, 4096
    buffer_load_dwordx4 v2, s[4:7], s84 offen offset:0 sc1 lds
    buffer_load_dwordx4 v2, s[4:7], s84 offen offset:1024 sc1 lds
    buffer_load_dwordx4 v2, s[4:7], s84 offen offset:2048 sc1 lds
    buffer_load_dwordx4 v2, s[4:7], s84 offen offset:3072 sc1 lds
    s_add_u32 s84, s84, 4096
    s_waitcnt vmcnt(4)
    s_barrier
    s_mov_b32 m0, s85
    s_add_u32 s85, s85, 4096
    buffer_load_dwordx4 v2, s[4:7], s84 offen offset:0 sc1 lds
    buffer_load_dwordx4 v2, s[4:7], s84 offen offset:1024 sc1 lds
    buffer_load_dwordx4 v2, s[4:7], s84 offen offset:2048 sc1 lds
    buffer_load_dwordx4 v2, s[4:7], s84 offen offset:3072 sc1 lds
    s_add_u32 s84, s84, 4096
    s_waitcnt vmcnt(4)
    s_barrier
    s_waitcnt vmcnt(0)
    s_barrier
ie_113:
    s_xor_b32 s73, s73, 0x200000
    s_waitcnt lgkmcnt(0)
    s_barrier
    s_lshl_b32 s24, s18, 12
    s_add_u32 s24, s24, 65536
    v_add_u32 v5, s24, v2
    s_cmp_eq_u32 s21, 0
    s_cbranch_scc1 rr_116
    ds_read_b128 v[40:43], v5 offset:0
    ds_read_b128 v[44:47], v5 offset:1024
    ds_read_b128 v[48:51], v5 offset:2048
    ds_read_b128 v[52:55], v5 offset:3072
    s_waitcnt lgkmcnt(0)
    v_pk_add_f32 v[40:41], v[40:41], v[48:49]
    v_pk_add_f32 v[42:43], v[42:43], v[50:51]
    v_pk_add_f32 v[44:45], v[44:45], v[52:53]
    v_pk_add_f32 v[46:47], v[46:47], v[54:55]
    s_branch rr_117
rr_116:
    s_xor_b32 s24, s19, 1
    s_lshl_b32 s24, s24, 11
    v_add_u32 v5, s24, v5
    ds_read_b128 v[56:59], v5
    ds_read_b128 v[60:63], v5 offset:1024
    s_waitcnt lgkmcnt(0)
    v_pk_add_f32 v[40:41], v[40:41], v[56:57]
    v_pk_add_f32 v[42:43], v[42:43], v[58:59]
    v_pk_add_f32 v[44:45], v[44:45], v[60:61]
    v_pk_add_f32 v[46:47], v[46:47], v[62:63]
rr_117:
    v_lshlrev_b32 v48, 16, v20
    v_and_b32 v49, 0xffff0000, v20
    v_lshlrev_b32 v50, 16, v21
    v_and_b32 v51, 0xffff0000, v21
    v_lshlrev_b32 v52, 16, v22
    v_and_b32 v53, 0xffff0000, v22
    v_lshlrev_b32 v54, 16, v23
    v_and_b32 v55, 0xffff0000, v23
    v_pk_add_f32 v[40:41], v[40:41], v[48:49]
    v_pk_add_f32 v[42:43], v[42:43], v[50:51]
    v_pk_add_f32 v[44:45], v[44:45], v[52:53]
    v_pk_add_f32 v[46:47], v[46:47], v[54:55]
    v_cvt_pk_bf16_f32 v20, v40, v41
    v_cvt_pk_bf16_f32 v21, v42, v43
    v_cvt_pk_bf16_f32 v22, v44, v45
    v_cvt_pk_bf16_f32 v23, v46, v47
    s_cmp_lg_u32 s23, 0
    s_cbranch_scc1 L_final
    s_mov_b32 s23, 0x140000
    s_add_u32 s24, s22, s73
    s_cmp_eq_u32 s62, 1
    s_cbranch_scc1 fs_118
    buffer_store_dwordx4 v[20:23], v2, s[4:7], s24 offen sc1
    s_branch fs_119
fs_118:
    buffer_store_dwordx4 v[20:23], v2, s[4:7], s24 offen
fs_119:
    v_mov_b32 v6, 0
    v_mov_b32 v7, 0
    s_nop 0
    v_dot2_f32_bf16 v6, v20, v0, v6
    v_dot2_f32_bf16 v7, v20, v20, v7
    v_dot2_f32_bf16 v6, v21, v0, v6
    v_dot2_f32_bf16 v7, v21, v21, v7
    v_dot2_f32_bf16 v6, v22, v0, v6
    v_dot2_f32_bf16 v7, v22, v22, v7
    v_dot2_f32_bf16 v6, v23, v0, v6
    v_dot2_f32_bf16 v7, v23, v23, v7
    s_bfe_u32 s24, s22, 0x5000a
    s_lshl_b32 s24, s24, 9
    s_lshr_b32 s25, s81, 2
    s_add_u32 s24, s24, s25
    s_lshl_b32 s25, s19, 8
    s_add_u32 s24, s24, s25
    s_add_u32 s24, s24, s74
    v_mov_b32 v8, v6
    v_mov_b32 v9, v7
    v_lshlrev_b32 v5, 3, v1
    s_nop 0
    v_permlane32_swap_b32 v6, v8
    v_permlane32_swap_b32 v7, v9
    s_nop 1
    v_pk_add_f32 v[6:7], v[6:7], v[8:9]
    s_mov_b32 exec_hi, 0
    s_cmp_eq_u32 s62, 1
    s_cbranch_scc1 fs_120
    buffer_store_dwordx2 v[6:7], v5, s[4:7], s24 offen sc1
    s_branch fs_121
fs_120:
    buffer_store_dwordx2 v[6:7], v5, s[4:7], s24 offen
fs_121:
    s_mov_b32 exec_hi, -1
    s_add_u32 s38, s38, 1
    s_lshl_b32 s24, s38, 4
    s_add_u32 s24, s24, s32
    s_add_u32 s24, s24, s91
    v_mov_b32 v6, s24
    v_mov_b32 v7, s33
    s_waitcnt vmcnt(0) lgkmcnt(0)
    s_mov_b64 exec, 1
    s_cmp_eq_u32 s62, 1
    s_cbranch_scc1 fs_122
    buffer_store_dwordx2 v[6:7], v96, s[4:7], 0 offen sc1
    s_branch fs_123
fs_122:
    buffer_store_dwordx2 v[6:7], v96, s[4:7], 0 offen
fs_123:
    s_mov_b64 exec, -1
    s_lshl_b32 s65, s38, 4
    s_add_u32 s65, s65, s32
    s_mov_b32 s63, 0
    buffer_load_dwordx2 v[8:9], v98, s[4:7], 0 offen sc1
cw_124:
    s_add_u32 s63, s63, 1
    s_cmp_gt_u32 s63, 200000
    s_cbranch_scc1 L_end
    s_sleep 1
    buffer_load_dwordx2 v[92:93], v98, s[4:7], 0 offen sc1
    s_waitcnt vmcnt(1)
    v_subrev_u32 v8, s65, v8
    v_xor_b32 v9, s33, v9
    v_lshrrev_b32 v8, 12, v8
    v_or_b32 v7, v8, v9
    v_cmp_ne_u32 vcc, 0, v7
    s_cbranch_vccz co_125
    s_sleep 1
    buffer_load_dwordx2 v[8:9], v98, s[4:7], 0 offen sc1
    s_waitcnt vmcnt(1)
    v_subrev_u32 v92, s65, v92
    v_xor_b32 v93, s33, v93
    v_lshrrev_b32 v92, 12, v92
    v_or_b32 v7, v92, v93
    v_cmp_ne_u32 vcc, 0, v7
    s_cbranch_vccnz cw_124
co_125:
    s_lshl_b32 s85, s19, 15
    s_lshl_b32 s26, s20, 14
    s_add_u32 s85, s85, s26
    s_lshl_b32 s26, s21, 11
    s_add_u32 s85, s85, s26
    s_add_u32 s84, s73, s81
    s_add_u32 s84, s84, s85
    s_mov_b32 m0, s85
    s_add_u32 s85, s85, 4096
    buffer_load_dwordx4 v2, s[4:7], s84 offen offset:0 sc1 lds
    buffer_load_dwordx4 v2, s[4:7], s84 offen offset:1024 sc1 lds
    s_add_u32 s84, s84, 4096
    s_mov_b32 m0, s85
    s_add_u32 s85, s85, 4096
    buffer_load_dwordx4 v2, s[4:7], s84 offen offset:0 sc1 lds
    buffer_load_dwordx4 v2, s[4:7], s84 offen offset:1024 sc1 lds
    s_add_u32 s84, s84, 4096
    v_lshlrev_b32 v5, 3, v1
    s_lshr_b32 s24, s81, 2
    s_lshl_b32 s25, s18, 11
    s_add_u32 s24, s24, s25
    s_add_u32 s24, s24, s74
    buffer_load_dwordx2 v[80:81], v5, s[4:7], s24 offen offset:0 sc1
    buffer_load_dwordx2 v[82:83], v5, s[4:7], s24 offen offset:512 sc1
    buffer_load_dwordx2 v[84:85], v5, s[4:7], s24 offen offset:1024 sc1
    buffer_load_dwordx2 v[86:87], v5, s[4:7], s24 offen offset:1536 sc1
    s_waitcnt vmcnt(6)
    s_barrier
    ds_read_b128 v[24:27], v4 offset:0
    ds_read_b128 v[28:31], v3 offset:0
    ds_read_b128 v[32:35], v4 offset:1024
    ds_read_b128 v[36:39], v3 offset:1024
    ds_read_b128 v[100:103], v4 offset:2048
    ds_read_b128 v[104:107], v3 offset:2048
    ds_read_b128 v[108:111], v4 offset:3072
    ds_read_b128 v[112:115], v3 offset:3072
    s_waitcnt lgkmcnt(6)
    v_mfma_f32_32x32x16_bf16 v[40:55], v[192:195], v[24:27], 0
    v_mfma_f32_32x32x16_bf16 v[56:71], v[192:195], v[28:31], 0
    s_mov_b32 m0, s85
    s_add_u32 s85, s85, 4096
    buffer_load_dwordx4 v2, s[4:7], s84 offen offset:0 sc1 lds
    buffer_load_dwordx4 v2, s[4:7], s84 offen offset:1024 sc1 lds
    s_add_u32 s84, s84, 4096
    s_waitcnt vmcnt(6)
    s_barrier
    ds_read_b128 v[24:27], v4 offset:4096
    ds_read_b128 v[28:31], v3 offset:4096
    s_waitcnt lgkmcnt(6)
    v_mfma_f32_32x32x16_bf16 v[40:55], v[196:199], v[32:35], v[40:55]
    v_mfma_f32_32x32x16_bf16 v[56:71], v[196:199], v[36:39], v[56:71]
    ds_read_b128 v[32:35], v4 offset:5120
    ds_read_b128 v[36:39], v3 offset:5120
    s_waitcnt lgkmcnt(6)
    v_mfma_f32_32x32x16_bf16 v[40:55], v[200:203], v[100:103], v[40:55]
    v_mfma_f32_32x32x16_bf16 v[56:71], v[200:203], v[104:107], v[56:71]
    ds_read_b128 v[100:103], v4 offset:6144
    ds_read_b128 v[104:107], v3 offset:6144
    s_waitcnt lgkmcnt(6)
    v_mfma_f32_32x32x16_bf16 v[40:55], v[204:207], v[108:111], v[40:55]
    v_mfma_f32_32x32x16_bf16 v[56:71], v[204:207], v[112:115], v[56:71]
    ds_read_b128 v[108:111], v4 offset:7168
    ds_read_b128 v[112:115], v3 offset:7168
    s_waitcnt lgkmcnt(6)
    v_mfma_f32_32x32x16_bf16 v[40:55], v[208:211], v[24:27], v[40:55]
    v_mfma_f32_32x32x16_bf16 v[56:71], v[208:211], v[28:31], v[56:71]
    s_mov_b32 m0, s85
    s_add_u32 s85, s85, 4096
    buffer_load_dwordx4 v2, s[4:7], s84 offen offset:0 sc1 lds
    buffer_load_dwordx4 v2, s[4:7], s84 offen offset:1024 sc1 lds
    s_add_u32 s84, s84, 4096
    s_waitcnt vmcnt(2)
    v_pk_add_f32 v[80:81], v[80:81], v[84:85]
    v_pk_add_f32 v[82:83], v[82:83], v[86:87]
    v_pk_add_f32 v[80:81], v[80:81], v[82:83]
    s_lshl_b32 s24, s18, 9
    s_add_u32 s24, s24, 131072
    v_lshlrev_b32 v5, 3, v1
    v_add_u32 v5, s24, v5
    ds_write_b64 v5, v[80:81]
    s_waitcnt lgkmcnt(0)
    s_barrier
    ds_read_b128 v[24:27], v4 offset:8192
    ds_read_b128 v[28:31], v3 offset:8192
    s_waitcnt lgkmcnt(6)
    v_mfma_f32_32x32x16_bf16 v[40:55], v[212:215], v[32:35], v[40:55]
    v_mfma_f32_32x32x16_bf16 v[56:71], v[212:215], v[36:39], v[56:71]
    v_lshlrev_b32 v5, 3, v1
    v_add_u32 v5, 131072, v5
    ds_read2st64_b64 v[80:83], v5 offset0:0 offset1:1
    ds_read2st64_b64 v[84:87], v5 offset0:2 offset1:3
    ds_read2st64_b64 v[88:91], v5 offset0:4 offset1:5
    ds_read2st64_b64 v[92:95], v5 offset0:6 offset1:7
    ds_read_b128 v[32:35], v4 offset:9216
    ds_read_b128 v[36:39], v3 offset:9216
    s_waitcnt lgkmcnt(6)
    v_mfma_f32_32x32x16_bf16 v[40:55], v[216:219], v[100:103], v[40:55]
    v_mfma_f32_32x32x16_bf16 v[56:71], v[216:219], v[104:107], v[56:71]
    ds_read_b128 v[100:103], v4 offset:10240
    ds_read_b128 v[104:107], v3 offset:10240
    s_waitcnt lgkmcnt(6)
    v_mfma_f32_32x32x16_bf16 v[40:55], v[220:223], v[108:111], v[40:55]
    v_mfma_f32_32x32x16_bf16 v[56:71], v[220:223], v[112:115], v[56:71]
    ds_read_b128 v[108:111], v4 offset:11264
    ds_read_b128 v[112:115], v3 offset:11264
    s_waitcnt lgkmcnt(6)
    v_mfma_f32_32x32x16_bf16 v[40:55], v[224:227], v[24:27], v[40:55]
    v_mfma_f32_32x32x16_bf16 v[56:71], v[224:227], v[28:31], v[56:71]
    s_waitcnt vmcnt(0)
    s_barrier
    ds_read_b128 v[24:27], v4 offset:12288
    ds_read_b128 v[28:31], v3 offset:12288
    s_waitcnt lgkmcnt(6)
    v_mfma_f32_32x32x16_bf16 v[40:55], v[228:231], v[32:35], v[40:55]
    v_mfma_f32_32x32x16_bf16 v[56:71], v[228:231], v[36:39], v[56:71]
    ds_read_b128 v[32:35], v4 offset:13312
    ds_read_b128 v[36:39], v3 offset:13312
    s_waitcnt lgkmcnt(6)
    v_mfma_f32_32x32x16_bf16 v[40:55], v[232:235], v[100:103], v[40:55]
    v_mfma_f32_32x32x16_bf16 v[56:71], v[232:235], v[104:107], v[56:71]
    v_pk_add_f32 v[80:81], v[80:81], v[88:89]
    v_pk_add_f32 v[82:83], v[82:83], v[90:91]
    v_pk_add_f32 v[84:85], v[84:85], v[92:93]
    v_pk_add_f32 v[86:87], v[86:87], v[94:95]
    v_pk_add_f32 v[80:81], v[80:81], v[84:85]
    v_pk_add_f32 v[82:83], v[82:83], v[86:87]
    v_pk_add_f32 v[10:11], v[80:81], v[82:83]
    v_mul_f32 v10, 0x3b000000, v10
    v_mul_f32 v11, 0x3b000000, v11
    v_fma_f32 v11, -v10, v10, v11
    v_max_f32 v11, 0, v11
    v_cvt_pk_bf16_f32 v11, v11, v11
    v_and_b32 v11, 0xffff0000, v11
    v_add_f32 v11, 0x3727c5ac, v11
    v_cvt_pk_bf16_f32 v11, v11, v11
    v_and_b32 v11, 0xffff0000, v11
    v_sqrt_f32 v11, v11
    s_nop 0
    v_cvt_pk_bf16_f32 v11, v11, v11
    v_and_b32 v11, 0xffff0000, v11
    v_rcp_f32 v11, v11
    v_cvt_pk_bf16_f32 v10, v10, v10
    v_and_b32 v10, 0xffff0000, v10
    ds_read_b128 v[100:103], v4 offset:14336
    ds_read_b128 v[104:107], v3 offset:14336
    s_waitcnt lgkmcnt(6)
    v_mfma_f32_32x32x16_bf16 v[40:55], v[236:239], v[108:111], v[40:55]
    v_mfma_f32_32x32x16_bf16 v[56:71], v[236:239], v[112:115], v[56:71]
    v_mov_b32 v8, v10
    v_mov_b32 v9, v11
    s_cmp_eq_u32 s19, 1
    s_cselect_b64 s[26:27], -1, 0
    v_permlane32_swap_b32 v10, v8
    v_permlane32_swap_b32 v11, v9
    s_nop 1
    v_cndmask_b32_e64 v11, v11, v9, s[26:27]
    v_cndmask_b32_e64 v9, v10, v8, s[26:27]
    v_cndmask_b32_e64 v8, v8, v10, s[26:27]
    v_cvt_pk_bf16_f32 v72, -v9, -v9
    v_cvt_pk_bf16_f32 v73, -v9, -v9
    v_mov_b32 v74, 0
    v_mov_b32 v75, 0
    v_cvt_pk_bf16_f32 v76, -v8, -v8
    v_cvt_pk_bf16_f32 v77, -v8, -v8
    v_mov_b32 v78, 0
    v_mov_b32 v79, 0
    ds_read_b128 v[108:111], v4 offset:15360
    ds_read_b128 v[112:115], v3 offset:15360
    s_waitcnt lgkmcnt(6)
    v_mfma_f32_32x32x16_bf16 v[40:55], v[240:243], v[24:27], v[40:55]
    v_mfma_f32_32x32x16_bf16 v[56:71], v[240:243], v[28:31], v[56:71]
    s_waitcnt lgkmcnt(4)
    v_mfma_f32_32x32x16_bf16 v[40:55], v[244:247], v[32:35], v[40:55]
    v_mfma_f32_32x32x16_bf16 v[56:71], v[244:247], v[36:39], v[56:71]
    s_waitcnt lgkmcnt(2)
    v_mfma_f32_32x32x16_bf16 v[40:55], v[248:251], v[100:103], v[40:55]
    v_mfma_f32_32x32x16_bf16 v[56:71], v[248:251], v[104:107], v[56:71]
    s_waitcnt lgkmcnt(0)
    v_mfma_f32_32x32x16_bf16 v[40:55], v[252:255], v[108:111], v[40:55]
    v_mfma_f32_32x32x16_bf16 v[56:71], v[252:255], v[112:115], v[56:71]
    s_xor_b32 s73, s73, 0x200000
    s_xor_b32 s74, s74, 0xf80000
    v_mfma_f32_32x32x16_bf16 v[40:55], v[12:15], v[72:75], v[40:55]
    v_mfma_f32_32x32x16_bf16 v[56:71], v[12:15], v[76:79], v[56:71]
    s_xor_b32 s24, s18, 1
    s_lshl_b32 s24, s24, 12
    s_add_u32 s24, s24, 65536
    v_add_u32 v5, s24, v2
    s_nop 8
    ds_write_b128 v5, v[56:59] offset:0
    ds_write_b128 v5, v[60:63] offset:1024
    ds_write_b128 v5, v[64:67] offset:2048
    ds_write_b128 v5, v[68:71] offset:3072
    s_waitcnt lgkmcnt(0)
    s_barrier
    s_lshl_b32 s24, s18, 12
    s_add_u32 s24, s24, 65536
    v_add_u32 v5, s24, v2
    ds_read_b128 v[56:59], v5 offset:0
    ds_read_b128 v[60:63], v5 offset:1024
    ds_read_b128 v[64:67], v5 offset:2048
    ds_read_b128 v[68:71], v5 offset:3072
    s_lshl_b32 s24, s20, 12
    s_lshl_b32 s25, s21, 13
    s_add_u32 s24, s24, s25
    s_lshl_b32 s25, s19, 10
    s_add_u32 s24, s24, s25
    s_add_u32 s24, s24, 135168
    v_and_b32 v7, 31, v1
    v_lshlrev_b32 v7, 5, v7
    v_lshrrev_b32 v6, 5, v1
    v_lshl_add_u32 v7, v6, 4, v7
    v_add_u32 v7, s24, v7
    s_waitcnt lgkmcnt(0)
    v_pk_add_f32 v[40:41], v[40:41], v[56:57]
    v_pk_add_f32 v[42:43], v[42:43], v[58:59]
    v_pk_add_f32 v[44:45], v[44:45], v[60:61]
    v_pk_add_f32 v[46:47], v[46:47], v[62:63]
    v_pk_add_f32 v[48:49], v[48:49], v[64:65]
    v_pk_add_f32 v[50:51], v[50:51], v[66:67]
    v_pk_add_f32 v[52:53], v[52:53], v[68:69]
    v_pk_add_f32 v[54:55], v[54:55], v[70:71]
    s_cmp_lg_u32 s21, 0
    s_cbranch_scc1 role_126
    v_mul_f32 v9, 0x3fb8aa3b, v11
    v_mul_f32 v56, v40, v9
    v_mul_f32 v57, v41, v9
    v_mul_f32 v58, v42, v9
    v_mul_f32 v59, v43, v9
    v_mul_f32 v60, v44, v9
    v_mul_f32 v61, v45, v9
    v_mul_f32 v62, v46, v9
    v_mul_f32 v63, v47, v9
    v_mul_f32 v64, v48, v9
    v_mul_f32 v65, v49, v9
    v_mul_f32 v66, v50, v9
    v_mul_f32 v67, v51, v9
    v_mul_f32 v68, v52, v9
    v_mul_f32 v69, v53, v9
    v_mul_f32 v70, v54, v9
    v_mul_f32 v71, v55, v9
    v_exp_f32_e64 v56, v56 clamp
    v_exp_f32_e64 v57, v57 clamp
    v_exp_f32_e64 v58, v58 clamp
    v_exp_f32_e64 v59, v59 clamp
    v_exp_f32_e64 v60, v60 clamp
    v_exp_f32_e64 v61, v61 clamp
    v_exp_f32_e64 v62, v62 clamp
    v_exp_f32_e64 v63, v63 clamp
    v_exp_f32_e64 v64, v64 clamp
    v_exp_f32_e64 v65, v65 clamp
    v_exp_f32_e64 v66, v66 clamp
    v_exp_f32_e64 v67, v67 clamp
    v_exp_f32_e64 v68, v68 clamp
    v_exp_f32_e64 v69, v69 clamp
    v_exp_f32_e64 v70, v70 clamp
    v_exp_f32_e64 v71, v71 clamp
    v_fmaak_f32 v40, v40, v11, 0x358637bd
    v_max_f32 v40, 0x358637bd, v40
    v_fmaak_f32 v41, v41, v11, 0x358637bd
    v_max_f32 v41, 0x358637bd, v41
    v_fmaak_f32 v42, v42, v11, 0x358637bd
    v_max_f32 v42, 0x358637bd, v42
    v_fmaak_f32 v43, v43, v11, 0x358637bd
    v_max_f32 v43, 0x358637bd, v43
    v_fmaak_f32 v44, v44, v11, 0x358637bd
    v_max_f32 v44, 0x358637bd, v44
    v_fmaak_f32 v45, v45, v11, 0x358637bd
    v_max_f32 v45, 0x358637bd, v45
    v_fmaak_f32 v46, v46, v11, 0x358637bd
    v_max_f32 v46, 0x358637bd, v46
    v_fmaak_f32 v47, v47, v11, 0x358637bd
    v_max_f32 v47, 0x358637bd, v47
    v_fmaak_f32 v48, v48, v11, 0x358637bd
    v_max_f32 v48, 0x358637bd, v48
    v_fmaak_f32 v49, v49, v11, 0x358637bd
    v_max_f32 v49, 0x358637bd, v49
    v_fmaak_f32 v50, v50, v11, 0x358637bd
    v_max_f32 v50, 0x358637bd, v50
    v_fmaak_f32 v51, v51, v11, 0x358637bd
    v_max_f32 v51, 0x358637bd, v51
    v_fmaak_f32 v52, v52, v11, 0x358637bd
    v_max_f32 v52, 0x358637bd, v52
    v_fmaak_f32 v53, v53, v11, 0x358637bd
    v_max_f32 v53, 0x358637bd, v53
    v_fmaak_f32 v54, v54, v11, 0x358637bd
    v_max_f32 v54, 0x358637bd, v54
    v_fmaak_f32 v55, v55, v11, 0x358637bd
    v_max_f32 v55, 0x358637bd, v55
    v_pk_add_f32 v[40:41], v[40:41], v[56:57]
    v_pk_add_f32 v[42:43], v[42:43], v[58:59]
    v_pk_add_f32 v[44:45], v[44:45], v[60:61]
    v_pk_add_f32 v[46:47], v[46:47], v[62:63]
    v_pk_add_f32 v[48:49], v[48:49], v[64:65]
    v_pk_add_f32 v[50:51], v[50:51], v[66:67]
    v_pk_add_f32 v[52:53], v[52:53], v[68:69]
    v_pk_add_f32 v[54:55], v[54:55], v[70:71]
    v_cvt_pk_bf16_f32 v24, v40, v41
    v_cvt_pk_bf16_f32 v25, v42, v43
    v_cvt_pk_bf16_f32 v26, v44, v45
    v_cvt_pk_bf16_f32 v27, v46, v47
    v_cvt_pk_bf16_f32 v28, v48, v49
    v_cvt_pk_bf16_f32 v29, v50, v51
    v_cvt_pk_bf16_f32 v30, v52, v53
    v_cvt_pk_bf16_f32 v31, v54, v55
role_126:
    s_cmp_lg_u32 s21, 1
    s_cbranch_scc1 role_127
    v_mul_f32 v40, v40, v11
    v_mul_f32 v41, v41, v11
    v_mul_f32 v42, v42, v11
    v_mul_f32 v43, v43, v11
    v_mul_f32 v44, v44, v11
    v_mul_f32 v45, v45, v11
    v_mul_f32 v46, v46, v11
    v_mul_f32 v47, v47, v11
    v_mul_f32 v48, v48, v11
    v_mul_f32 v49, v49, v11
    v_mul_f32 v50, v50, v11
    v_mul_f32 v51, v51, v11
    v_mul_f32 v52, v52, v11
    v_mul_f32 v53, v53, v11
    v_mul_f32 v54, v54, v11
    v_mul_f32 v55, v55, v11
    v_cvt_pk_bf16_f32 v24, v40, v41
    v_cvt_pk_bf16_f32 v25, v42, v43
    v_cvt_pk_bf16_f32 v26, v44, v45
    v_cvt_pk_bf16_f32 v27, v46, v47
    v_cvt_pk_bf16_f32 v28, v48, v49
    v_cvt_pk_bf16_f32 v29, v50, v51
    v_cvt_pk_bf16_f32 v30, v52, v53
    v_cvt_pk_bf16_f32 v31, v54, v55
role_127:
    ds_write_b128 v7, v[24:27]
    ds_write_b128 v7, v[28:31] offset:2048
    s_waitcnt lgkmcnt(0)
    s_barrier
    s_cmp_lg_u32 s21, 1
    s_cbranch_scc1 ie_128
    ds_read_b128 v[24:27], v4 offset:0
    ds_read_b128 v[28:31], v3 offset:0
    ds_read_b128 v[32:35], v4 offset:1024
    ds_read_b128 v[36:39], v3 offset:1024
    ds_read_b128 v[100:103], v4 offset:2048
    ds_read_b128 v[104:107], v3 offset:2048
    ds_read_b128 v[108:111], v4 offset:3072
    ds_read_b128 v[112:115], v3 offset:3072
    s_waitcnt lgkmcnt(6)
    v_mfma_f32_32x32x16_bf16 v[40:55], v[128:131], v[24:27], 0
    v_mfma_f32_32x32x16_bf16 v[56:71], v[128:131], v[28:31], 0
    ds_read_b128 v[24:27], v4 offset:4096
    ds_read_b128 v[28:31], v3 offset:4096
    s_waitcnt lgkmcnt(6)
    v_mfma_f32_32x32x16_bf16 v[40:55], v[132:135], v[32:35], v[40:55]
    v_mfma_f32_32x32x16_bf16 v[56:71], v[132:135], v[36:39], v[56:71]
    ds_read_b128 v[32:35], v4 offset:5120
    ds_read_b128 v[36:39], v3 offset:5120
    s_waitcnt lgkmcnt(6)
    v_mfma_f32_32x32x16_bf16 v[40:55], v[136:139], v[100:103], v[40:55]
    v_mfma_f32_32x32x16_bf16 v[56:71], v[136:139], v[104:107], v[56:71]
    ds_read_b128 v[100:103], v4 offset:6144
    ds_read_b128 v[104:107], v3 offset:6144
    s_waitcnt lgkmcnt(6)
    v_mfma_f32_32x32x16_bf16 v[40:55], v[140:143], v[108:111], v[40:55]
    v_mfma_f32_32x32x16_bf16 v[56:71], v[140:143], v[112:115], v[56:71]
    ds_read_b128 v[108:111], v4 offset:7168
    ds_read_b128 v[112:115], v3 offset:7168
    s_waitcnt lgkmcnt(6)
    v_mfma_f32_32x32x16_bf16 v[40:55], v[144:147], v[24:27], v[40:55]
    v_mfma_f32_32x32x16_bf16 v[56:71], v[144:147], v[28:31], v[56:71]
    ds_read_b128 v[24:27], v4 offset:8192
    ds_read_b128 v[28:31], v3 offset:8192
    s_waitcnt lgkmcnt(6)
    v_mfma_f32_32x32x16_bf16 v[40:55], v[148:151], v[32:35], v[40:55]
    v_mfma_f32_32x32x16_bf16 v[56:71], v[148:151], v[36:39], v[56:71]
    ds_read_b128 v[32:35], v4 offset:9216
    ds_read_b128 v[36:39], v3 offset:9216
    s_waitcnt lgkmcnt(6)
    v_mfma_f32_32x32x16_bf16 v[40:55], v[152:155], v[100:103], v[40:55]
    v_mfma_f32_32x32x16_bf16 v[56:71], v[152:155], v[104:107], v[56:71]
    ds_read_b128 v[100:103], v4 offset:10240
    ds_read_b128 v[104:107], v3 offset:10240
    s_waitcnt lgkmcnt(6)
    v_mfma_f32_32x32x16_bf16 v[40:55], v[156:159], v[108:111], v[40:55]
    v_mfma_f32_32x32x16_bf16 v[56:71], v[156:159], v[112:115], v[56:71]
    ds_read_b128 v[108:111], v4 offset:11264
    ds_read_b128 v[112:115], v3 offset:11264
    s_waitcnt lgkmcnt(6)
    v_mfma_f32_32x32x16_bf16 v[40:55], v[160:163], v[24:27], v[40:55]
    v_mfma_f32_32x32x16_bf16 v[56:71], v[160:163], v[28:31], v[56:71]
    ds_read_b128 v[24:27], v4 offset:12288
    ds_read_b128 v[28:31], v3 offset:12288
    s_waitcnt lgkmcnt(6)
    v_mfma_f32_32x32x16_bf16 v[40:55], v[164:167], v[32:35], v[40:55]
    v_mfma_f32_32x32x16_bf16 v[56:71], v[164:167], v[36:39], v[56:71]
    ds_read_b128 v[32:35], v4 offset:13312
    ds_read_b128 v[36:39], v3 offset:13312
    s_waitcnt lgkmcnt(6)
    v_mfma_f32_32x32x16_bf16 v[40:55], v[168:171], v[100:103], v[40:55]
    v_mfma_f32_32x32x16_bf16 v[56:71], v[168:171], v[104:107], v[56:71]
    ds_read_b128 v[100:103], v4 offset:14336
    ds_read_b128 v[104:107], v3 offset:14336
    s_waitcnt lgkmcnt(6)
    v_mfma_f32_32x32x16_bf16 v[40:55], v[172:175], v[108:111], v[40:55]
    v_mfma_f32_32x32x16_bf16 v[56:71], v[172:175], v[112:115], v[56:71]
    ds_read_b128 v[108:111], v4 offset:15360
    ds_read_b128 v[112:115], v3 offset:15360
    s_waitcnt lgkmcnt(6)
    v_mfma_f32_32x32x16_bf16 v[40:55], v[176:179], v[24:27], v[40:55]
    v_mfma_f32_32x32x16_bf16 v[56:71], v[176:179], v[28:31], v[56:71]
    s_waitcnt lgkmcnt(4)
    v_mfma_f32_32x32x16_bf16 v[40:55], v[180:183], v[32:35], v[40:55]
    v_mfma_f32_32x32x16_bf16 v[56:71], v[180:183], v[36:39], v[56:71]
    s_waitcnt lgkmcnt(2)
    v_mfma_f32_32x32x16_bf16 v[40:55], v[184:187], v[100:103], v[40:55]
    v_mfma_f32_32x32x16_bf16 v[56:71], v[184:187], v[104:107], v[56:71]
    s_waitcnt lgkmcnt(0)
    v_mfma_f32_32x32x16_bf16 v[40:55], v[188:191], v[108:111], v[40:55]
    v_mfma_f32_32x32x16_bf16 v[56:71], v[188:191], v[112:115], v[56:71]
    v_mfma_f32_32x32x16_bf16 v[40:55], v[14:17], v[72:75], v[40:55]
    v_mfma_f32_32x32x16_bf16 v[56:71], v[14:17], v[76:79], v[56:71]
    s_lshl_b32 s24, s20, 13
    s_mul_i32 s25, s19, 6144
    s_add_u32 s24, s24, s25
    s_add_u32 s24, s24, 65536
    v_add_u32 v5, s24, v2
    v_xor_b32 v6, 4096, v5
    s_nop 6
    ds_write_b128 v5, v[40:43] offset:0
    ds_write_b128 v5, v[44:47] offset:1024
    ds_write_b128 v6, v[56:59] offset:0
    ds_write_b128 v6, v[60:63] offset:1024
    ds_write_b128 v6, v[64:67] offset:16384
    ds_write_b128 v6, v[68:71] offset:17408
    s_waitcnt lgkmcnt(0)
    s_barrier
    s_lshl_b32 s24, s18, 12
    s_add_u32 s24, s24, 65536
    v_add_u32 v5, s24, v2
    s_cmp_eq_u32 s21, 1
    s_cbranch_scc1 rr_130
    ds_read_b128 v[40:43], v5 offset:0
    ds_read_b128 v[44:47], v5 offset:1024
    ds_read_b128 v[48:51], v5 offset:2048
    ds_read_b128 v[52:55], v5 offset:3072
    s_waitcnt lgkmcnt(0)
    v_pk_add_f32 v[40:41], v[40:41], v[48:49]
    v_pk_add_f32 v[42:43], v[42:43], v[50:51]
    v_pk_add_f32 v[44:45], v[44:45], v[52:53]
    v_pk_add_f32 v[46:47], v[46:47], v[54:55]
    s_branch rr_131
rr_130:
    s_xor_b32 s24, s19, 1
    s_lshl_b32 s24, s24, 11
    v_add_u32 v5, s24, v5
    ds_read_b128 v[56:59], v5
    ds_read_b128 v[60:63], v5 offset:1024
    s_waitcnt lgkmcnt(0)
    v_pk_add_f32 v[40:41], v[48:49], v[56:57]
    v_pk_add_f32 v[42:43], v[50:51], v[58:59]
    v_pk_add_f32 v[44:45], v[52:53], v[60:61]
    v_pk_add_f32 v[46:47], v[54:55], v[62:63]
rr_131:
    v_mul_f32 v9, 0x3fb8aa3b, v11
    v_mul_f32 v48, v40, v9
    v_mul_f32 v49, v41, v9
    v_mul_f32 v50, v42, v9
    v_mul_f32 v51, v43, v9
    v_mul_f32 v52, v44, v9
    v_mul_f32 v53, v45, v9
    v_mul_f32 v54, v46, v9
    v_mul_f32 v55, v47, v9
    v_exp_f32_e64 v48, v48 clamp
    v_exp_f32_e64 v49, v49 clamp
    v_exp_f32_e64 v50, v50 clamp
    v_exp_f32_e64 v51, v51 clamp
    v_exp_f32_e64 v52, v52 clamp
    v_exp_f32_e64 v53, v53 clamp
    v_exp_f32_e64 v54, v54 clamp
    v_exp_f32_e64 v55, v55 clamp
    v_fmaak_f32 v40, v40, v11, 0x358637bd
    v_max_f32 v40, 0x358637bd, v40
    v_fmaak_f32 v41, v41, v11, 0x358637bd
    v_max_f32 v41, 0x358637bd, v41
    v_fmaak_f32 v42, v42, v11, 0x358637bd
    v_max_f32 v42, 0x358637bd, v42
    v_fmaak_f32 v43, v43, v11, 0x358637bd
    v_max_f32 v43, 0x358637bd, v43
    v_fmaak_f32 v44, v44, v11, 0x358637bd
    v_max_f32 v44, 0x358637bd, v44
    v_fmaak_f32 v45, v45, v11, 0x358637bd
    v_max_f32 v45, 0x358637bd, v45
    v_fmaak_f32 v46, v46, v11, 0x358637bd
    v_max_f32 v46, 0x358637bd, v46
    v_fmaak_f32 v47, v47, v11, 0x358637bd
    v_max_f32 v47, 0x358637bd, v47
    v_pk_add_f32 v[40:41], v[40:41], v[48:49]
    v_pk_add_f32 v[42:43], v[42:43], v[50:51]
    v_pk_add_f32 v[44:45], v[44:45], v[52:53]
    v_pk_add_f32 v[46:47], v[46:47], v[54:55]
    v_cvt_pk_bf16_f32 v88, v40, v41
    v_cvt_pk_bf16_f32 v89, v42, v43
    v_cvt_pk_bf16_f32 v90, v44, v45
    v_cvt_pk_bf16_f32 v91, v46, v47
    s_and_b32 s70, s18, 3
    s_lshl_b32 s70, s70, 14
    s_mov_b32 s12, s48
    s_mov_b32 s13, s49
    s_mov_b32 s14, 0x80000
    s_mov_b32 s15, 0x00020000
    s_mov_b32 s69, 1024
    s_mov_b32 s68, 0
    v_lshrrev_b32 v94, 2, v1
    v_mul_lo_u32 v94, v94, s69
    v_and_b32 v7, 3, v1
    v_lshl_add_u32 v94, v7, 4, v94
    s_lshl_b32 s69, s69, 4
    s_lshl_b32 s24, s19, 4
    s_mul_i32 s24, s24, s69
    s_add_u32 s68, s68, s24
    s_add_u32 s68, s68, s80
    v_lshrrev_b32 v95, 5, v1
    v_lshlrev_b32 v95, 8, v95
    v_bfe_u32 v7, v1, 2, 2
    v_lshl_add_u32 v95, v7, 6, v95
    v_bfe_u32 v7, v1, 4, 1
    v_lshl_add_u32 v95, v7, 5, v95
    v_and_b32 v7, 3, v1
    v_lshl_add_u32 v95, v7, 3, v95
    v_add_u32 v95, s70, v95
    s_add_u32 m0, s70, 0
    s_nop 0
    buffer_load_dwordx4 v94, s[12:15], s68 offen lds
    s_add_u32 s68, s68, s69
    s_add_u32 m0, s70, 1024
    s_nop 0
    buffer_load_dwordx4 v94, s[12:15], s68 offen lds
    s_add_u32 s68, s68, s69
    s_add_u32 m0, s70, 2048
    s_nop 0
    buffer_load_dwordx4 v94, s[12:15], s68 offen lds
    s_add_u32 s68, s68, s69
    s_add_u32 m0, s70, 3072
    s_nop 0
    buffer_load_dwordx4 v94, s[12:15], s68 offen lds
    s_add_u32 s68, s68, s69
    s_add_u32 m0, s70, 4096
    s_nop 0
    buffer_load_dwordx4 v94, s[12:15], s68 offen lds
    s_add_u32 s68, s68, s69
    s_add_u32 m0, s70, 5120
    s_nop 0
    buffer_load_dwordx4 v94, s[12:15], s68 offen lds
    s_add_u32 s68, s68, s69
    s_add_u32 m0, s70, 6144
    s_nop 0
    buffer_load_dwordx4 v94, s[12:15], s68 offen lds
    s_add_u32 s68, s68, s69
    s_add_u32 m0, s70, 7168
    s_nop 0
    buffer_load_dwordx4 v94, s[12:15], s68 offen lds
    s_add_u32 s68, s68, s69
    s_add_u32 m0, s70, 8192
    s_nop 0
    buffer_load_dwordx4 v94, s[12:15], s68 offen lds
    s_add_u32 s68, s68, s69
    s_add_u32 m0, s70, 9216
    s_nop 0
    buffer_load_dwordx4 v94, s[12:15], s68 offen lds
    s_add_u32 s68, s68, s69
    s_add_u32 m0, s70, 10240
    s_nop 0
    buffer_load_dwordx4 v94, s[12:15], s68 offen lds
    s_add_u32 s68, s68, s69
    s_add_u32 m0, s70, 11264
    s_nop 0
    buffer_load_dwordx4 v94, s[12:15], s68 offen lds
    s_add_u32 s68, s68, s69
    s_add_u32 m0, s70, 12288
    s_nop 0
    buffer_load_dwordx4 v94, s[12:15], s68 offen lds
    s_add_u32 s68, s68, s69
    s_add_u32 m0, s70, 13312
    s_nop 0
    buffer_load_dwordx4 v94, s[12:15], s68 offen lds
    s_add_u32 s68, s68, s69
    s_add_u32 m0, s70, 14336
    s_nop 0
    buffer_load_dwordx4 v94, s[12:15], s68 offen lds
    s_add_u32 s68, s68, s69
    s_add_u32 m0, s70, 15360
    s_nop 0
    buffer_load_dwordx4 v94, s[12:15], s68 offen lds
    s_add_u32 s68, s68, s69
    s_waitcnt vmcnt(15)
    ds_read_b64_tr_b16 v[192:193], v95 offset:0
    ds_read_b64_tr_b16 v[194:195], v95 offset:512
    s_waitcnt vmcnt(14)
    ds_read_b64_tr_b16 v[196:197], v95 offset:1024
    ds_read_b64_tr_b16 v[198:199], v95 offset:1536
    s_waitcnt vmcnt(13)
    ds_read_b64_tr_b16 v[200:201], v95 offset:2048
    ds_read_b64_tr_b16 v[202:203], v95 offset:2560
    s_waitcnt vmcnt(12)
    ds_read_b64_tr_b16 v[204:205], v95 offset:3072
    ds_read_b64_tr_b16 v[206:207], v95 offset:3584
    s_waitcnt vmcnt(11)
    ds_read_b64_tr_b16 v[208:209], v95 offset:4096
    ds_read_b64_tr_b16 v[210:211], v95 offset:4608
    s_waitcnt vmcnt(10)
    ds_read_b64_tr_b16 v[212:213], v95 offset:5120
    ds_read_b64_tr_b16 v[214:215], v95 offset:5632
    s_waitcnt vmcnt(9)
    ds_read_b64_tr_b16 v[216:217], v95 offset:6144
    ds_read_b64_tr_b16 v[218:219], v95 offset:6656
    s_waitcnt vmcnt(8)
    ds_read_b64_tr_b16 v[220:221], v95 offset:7168
    ds_read_b64_tr_b16 v[222:223], v95 offset:7680
    s_waitcnt vmcnt(7)
    ds_read_b64_tr_b16 v[224:225], v95 offset:8192
    ds_read_b64_tr_b16 v[226:227], v95 offset:8704
    s_waitcnt vmcnt(6)
    ds_read_b64_tr_b16 v[228:229], v95 offset:9216
    ds_read_b64_tr_b16 v[230:231], v95 offset:9728
    s_waitcnt vmcnt(5)
    ds_read_b64_tr_b16 v[232:233], v95 offset:10240
    ds_read_b64_tr_b16 v[234:235], v95 offset:10752
    s_waitcnt vmcnt(4)
    ds_read_b64_tr_b16 v[236:237], v95 offset:11264
    ds_read_b64_tr_b16 v[238:239], v95 offset:11776
    s_waitcnt vmcnt(3)
    ds_read_b64_tr_b16 v[240:241], v95 offset:12288
    ds_read_b64_tr_b16 v[242:243], v95 offset:12800
    s_waitcnt vmcnt(2)
    ds_read_b64_tr_b16 v[244:245], v95 offset:13312
    ds_read_b64_tr_b16 v[246:247], v95 offset:13824
    s_waitcnt vmcnt(1)
    ds_read_b64_tr_b16 v[248:249], v95 offset:14336
    ds_read_b64_tr_b16 v[250:251], v95 offset:14848
    s_waitcnt vmcnt(0)
    ds_read_b64_tr_b16 v[252:253], v95 offset:15360
    ds_read_b64_tr_b16 v[254:255], v95 offset:15872
    s_waitcnt lgkmcnt(0)
    s_branch ie_129
ie_128:
    v_lshrrev_b32 v5, 4, v1
    v_lshlrev_b32 v5, 8, v5
    v_bfe_u32 v6, v1, 2, 2
    v_lshl_add_u32 v5, v6, 5, v5
    v_and_b32 v6, 1, v1
    v_lshl_add_u32 v5, v6, 4, v5
    v_bfe_u32 v6, v1, 1, 1
    v_lshl_add_u32 v5, v6, 3, v5
    s_lshl_b32 s24, s18, 11
    s_add_u32 s24, s24, 135168
    v_add_u32 v5, s24, v5
    ds_read_b64_tr_b16 v[24:25], v5 offset:0
    ds_read_b64_tr_b16 v[32:33], v5 offset:8192
    ds_read_b64_tr_b16 v[26:27], v5 offset:128
    ds_read_b64_tr_b16 v[34:35], v5 offset:8320
    ds_read_b64_tr_b16 v[28:29], v5 offset:1024
    ds_read_b64_tr_b16 v[36:37], v5 offset:9216
    ds_read_b64_tr_b16 v[30:31], v5 offset:1152
    ds_read_b64_tr_b16 v[38:39], v5 offset:9344
    v_mov_b32 v48, v0
    v_mov_b32 v49, v0
    v_mov_b32 v50, v0
    v_mov_b32 v51, v0
    s_lshl_b32 s26, s17, 2
    s_add_u32 s26, s26, s18
    s_lshl_b32 s27, s26, 14
    s_add_u32 s27, s27, s23
    s_add_u32 s27, s27, 0x8a8000
    s_lshl_b32 s28, s26, 11
    s_add_u32 s28, s28, s23
    s_add_u32 s28, s28, 0x9a8000
    s_lshl_b32 s29, s26, 12
    s_add_u32 s29, s29, 0xb20000
    s_waitcnt lgkmcnt(0)
    v_mfma_f32_16x16x32_bf16 v[40:43], v[24:27], v[32:35], 0
    v_mfma_f32_16x16x32_bf16 v[44:47], v[24:27], v[48:51], 0
    v_mfma_f32_16x16x32_bf16 v[40:43], v[28:31], v[36:39], v[40:43]
    v_mfma_f32_16x16x32_bf16 v[44:47], v[28:31], v[48:51], v[44:47]
    s_lshl_b32 s24, s16, 9
    s_add_u32 s24, s24, s27
    s_lshl_b32 s25, s16, 6
    s_add_u32 s25, s25, s28
    v_and_b32 v6, 48, v1
    v_lshlrev_b32 v5, 3, v1
    s_nop 2
    v_cvt_pk_bf16_f32 v40, v40, v41
    v_cvt_pk_bf16_f32 v41, v42, v43
    v_min_u32 v40, -2, v40
    v_min_u32 v41, -2, v41
    v_min_u32 v44, -2, v44
    v_min_u32 v45, -2, v45
    v_min_u32 v46, -2, v46
    v_min_u32 v47, -2, v47
    buffer_store_dwordx2 v[40:41], v5, s[4:7], s24 offen sc1
    s_mov_b32 exec_lo, 0x00010001
    s_mov_b32 exec_hi, 0x00010001
    buffer_store_dwordx4 v[44:47], v6, s[4:7], s25 offen sc1
    s_mov_b64 exec, -1
    s_mov_b32 s12, s44
    s_mov_b32 s13, s45
    s_mov_b32 s14, 0x80000
    s_mov_b32 s15, 0x00020000
    s_mov_b32 s69, 1024
    s_mov_b32 s68, 0
    v_lshrrev_b32 v94, 2, v1
    v_mul_lo_u32 v94, v94, s69
    v_and_b32 v7, 3, v1
    v_lshl_add_u32 v94, v7, 4, v94
    s_lshl_b32 s69, s69, 4
    s_lshl_b32 s24, s19, 4
    s_mul_i32 s24, s24, s69
    s_add_u32 s68, s68, s24
    s_add_u32 s68, s68, s80
    s_and_b32 s70, s18, 3
    s_lshl_b32 s70, s70, 13
    s_add_u32 s70, s70, 98304
    v_lshrrev_b32 v95, 5, v1
    v_lshlrev_b32 v95, 8, v95
    v_bfe_u32 v7, v1, 2, 2
    v_lshl_add_u32 v95, v7, 6, v95
    v_bfe_u32 v7, v1, 4, 1
    v_lshl_add_u32 v95, v7, 5, v95
    v_and_b32 v7, 3, v1
    v_lshl_add_u32 v95, v7, 3, v95
    v_add_u32 v95, s70, v95
    s_add_u32 m0, s70, 0
    s_nop 0
    buffer_load_dwordx4 v94, s[12:15], s68 offen lds
    s_add_u32 s68, s68, s69
    s_add_u32 m0, s70, 1024
    s_nop 0
    buffer_load_dwordx4 v94, s[12:15], s68 offen lds
    s_add_u32 s68, s68, s69
    s_add_u32 m0, s70, 2048
    s_nop 0
    buffer_load_dwordx4 v94, s[12:15], s68 offen lds
    s_add_u32 s68, s68, s69
    s_add_u32 m0, s70, 3072
    s_nop 0
    buffer_load_dwordx4 v94, s[12:15], s68 offen lds
    s_add_u32 s68, s68, s69
    s_add_u32 m0, s70, 4096
    s_nop 0
    buffer_load_dwordx4 v94, s[12:15], s68 offen lds
    s_add_u32 s68, s68, s69
    s_add_u32 m0, s70, 5120
    s_nop 0
    buffer_load_dwordx4 v94, s[12:15], s68 offen lds
    s_add_u32 s68, s68, s69
    s_add_u32 m0, s70, 6144
    s_nop 0
    buffer_load_dwordx4 v94, s[12:15], s68 offen lds
    s_add_u32 s68, s68, s69
    s_add_u32 m0, s70, 7168
    s_nop 0
    buffer_load_dwordx4 v94, s[12:15], s68 offen lds
    s_add_u32 s68, s68, s69
    s_waitcnt vmcnt(0)
    ds_read_b64_tr_b16 v[128:129], v95 offset:0
    ds_read_b64_tr_b16 v[130:131], v95 offset:512
    ds_read_b64_tr_b16 v[132:133], v95 offset:1024
    ds_read_b64_tr_b16 v[134:135], v95 offset:1536
    ds_read_b64_tr_b16 v[136:137], v95 offset:2048
    ds_read_b64_tr_b16 v[138:139], v95 offset:2560
    ds_read_b64_tr_b16 v[140:141], v95 offset:3072
    ds_read_b64_tr_b16 v[142:143], v95 offset:3584
    ds_read_b64_tr_b16 v[144:145], v95 offset:4096
    ds_read_b64_tr_b16 v[146:147], v95 offset:4608
    ds_read_b64_tr_b16 v[148:149], v95 offset:5120
    ds_read_b64_tr_b16 v[150:151], v95 offset:5632
    ds_read_b64_tr_b16 v[152:153], v95 offset:6144
    ds_read_b64_tr_b16 v[154:155], v95 offset:6656
    ds_read_b64_tr_b16 v[156:157], v95 offset:7168
    ds_read_b64_tr_b16 v[158:159], v95 offset:7680
    s_waitcnt lgkmcnt(0)
    s_add_u32 m0, s70, 0
    s_nop 0
    buffer_load_dwordx4 v94, s[12:15], s68 offen lds
    s_add_u32 s68, s68, s69
    s_add_u32 m0, s70, 1024
    s_nop 0
    buffer_load_dwordx4 v94, s[12:15], s68 offen lds
    s_add_u32 s68, s68, s69
    s_add_u32 m0, s70, 2048
    s_nop 0
    buffer_load_dwordx4 v94, s[12:15], s68 offen lds
    s_add_u32 s68, s68, s69
    s_add_u32 m0, s70, 3072
    s_nop 0
    buffer_load_dwordx4 v94, s[12:15], s68 offen lds
    s_add_u32 s68, s68, s69
    s_add_u32 m0, s70, 4096
    s_nop 0
    buffer_load_dwordx4 v94, s[12:15], s68 offen lds
    s_add_u32 s68, s68, s69
    s_add_u32 m0, s70, 5120
    s_nop 0
    buffer_load_dwordx4 v94, s[12:15], s68 offen lds
    s_add_u32 s68, s68, s69
    s_add_u32 m0, s70, 6144
    s_nop 0
    buffer_load_dwordx4 v94, s[12:15], s68 offen lds
    s_add_u32 s68, s68, s69
    s_add_u32 m0, s70, 7168
    s_nop 0
    buffer_load_dwordx4 v94, s[12:15], s68 offen lds
    s_add_u32 s68, s68, s69
    s_waitcnt lgkmcnt(0)
    s_barrier
    s_lshl_b32 s24, s18, 12
    s_add_u32 s24, s24, 65536
    v_add_u32 v5, s24, v2
    s_cmp_eq_u32 s21, 1
    s_cbranch_scc1 rr_132
    ds_read_b128 v[40:43], v5 offset:0
    ds_read_b128 v[44:47], v5 offset:1024
    ds_read_b128 v[48:51], v5 offset:2048
    ds_read_b128 v[52:55], v5 offset:3072
    s_waitcnt lgkmcnt(0)
    v_pk_add_f32 v[40:41], v[40:41], v[48:49]
    v_pk_add_f32 v[42:43], v[42:43], v[50:51]
    v_pk_add_f32 v[44:45], v[44:45], v[52:53]
    v_pk_add_f32 v[46:47], v[46:47], v[54:55]
    s_branch rr_133
rr_132:
    s_xor_b32 s24, s19, 1
    s_lshl_b32 s24, s24, 11
    v_add_u32 v5, s24, v5
    ds_read_b128 v[56:59], v5
    ds_read_b128 v[60:63], v5 offset:1024
    s_waitcnt lgkmcnt(0)
    v_pk_add_f32 v[40:41], v[48:49], v[56:57]
    v_pk_add_f32 v[42:43], v[50:51], v[58:59]
    v_pk_add_f32 v[44:45], v[52:53], v[60:61]
    v_pk_add_f32 v[46:47], v[54:55], v[62:63]
rr_133:
    v_mul_f32 v9, 0x3fb8aa3b, v11
    v_mul_f32 v48, v40, v9
    v_mul_f32 v49, v41, v9
    v_mul_f32 v50, v42, v9
    v_mul_f32 v51, v43, v9
    v_mul_f32 v52, v44, v9
    v_mul_f32 v53, v45, v9
    v_mul_f32 v54, v46, v9
    v_mul_f32 v55, v47, v9
    v_exp_f32_e64 v48, v48 clamp
    v_exp_f32_e64 v49, v49 clamp
    v_exp_f32_e64 v50, v50 clamp
    v_exp_f32_e64 v51, v51 clamp
    v_exp_f32_e64 v52, v52 clamp
    v_exp_f32_e64 v53, v53 clamp
    v_exp_f32_e64 v54, v54 clamp
    v_exp_f32_e64 v55, v55 clamp
    v_fmaak_f32 v40, v40, v11, 0x358637bd
    v_max_f32 v40, 0x358637bd, v40
    v_fmaak_f32 v41, v41, v11, 0x358637bd
    v_max_f32 v41, 0x358637bd, v41
    v_fmaak_f32 v42, v42, v11, 0x358637bd
    v_max_f32 v42, 0x358637bd, v42
    v_fmaak_f32 v43, v43, v11, 0x358637bd
    v_max_f32 v43, 0x358637bd, v43
    v_fmaak_f32 v44, v44, v11, 0x358637bd
    v_max_f32 v44, 0x358637bd, v44
    v_fmaak_f32 v45, v45, v11, 0x358637bd
    v_max_f32 v45, 0x358637bd, v45
    v_fmaak_f32 v46, v46, v11, 0x358637bd
    v_max_f32 v46, 0x358637bd, v46
    v_fmaak_f32 v47, v47, v11, 0x358637bd
    v_max_f32 v47, 0x358637bd, v47
    v_pk_add_f32 v[40:41], v[40:41], v[48:49]
    v_pk_add_f32 v[42:43], v[42:43], v[50:51]
    v_pk_add_f32 v[44:45], v[44:45], v[52:53]
    v_pk_add_f32 v[46:47], v[46:47], v[54:55]
    v_cvt_pk_bf16_f32 v88, v40, v41
    v_cvt_pk_bf16_f32 v89, v42, v43
    v_cvt_pk_bf16_f32 v90, v44, v45
    v_cvt_pk_bf16_f32 v91, v46, v47
    s_lshl_b32 s26, s17, 2
    s_add_u32 s26, s26, s18
    s_lshl_b32 s27, s26, 14
    s_add_u32 s27, s27, s23
    s_add_u32 s27, s27, 0x8a8000
    s_lshl_b32 s28, s26, 11
    s_add_u32 s28, s28, s23
    s_add_u32 s28, s28, 0x9a8000
    s_lshl_b32 s29, s26, 12
    s_add_u32 s29, s29, 0xb20000
    s_mov_b32 s71, s27
    v_and_b32 v6, 48, v1
    v_and_b32 v5, 15, v1
    v_lshl_add_u32 v5, v5, 6, v6
    s_mov_b32 s63, 0
pl_134:
    s_add_u32 s63, s63, 1
    s_cmp_gt_u32 s63, 200000
    s_cbranch_scc1 L_end
    buffer_load_dwordx4 v[100:103], v5, s[4:7], s28 offen sc1
    buffer_load_dwordx4 v[104:107], v5, s[4:7], s28 offen offset:1024 sc1
    s_waitcnt vmcnt(0)
    v_max3_u32 v7, v100, v101, v102
    v_max3_u32 v8, v103, v104, v105
    v_max3_u32 v7, v7, v106, v107
    v_max_u32 v7, v7, v8
    v_cmp_eq_u32 vcc, -1, v7
    s_cbranch_vccnz pl_134
    s_mov_b32 s86, 0
    s_mov_b32 s87, 0
gat_136:
    s_add_u32 s87, s87, 1
    s_cmp_gt_u32 s87, 200000
    s_cbranch_scc1 L_end
    s_mov_b32 s24, s71
    buffer_load_dwordx4 v[192:195], v2, s[4:7], s24 offen offset:0 sc1
    buffer_load_dwordx4 v[196:199], v2, s[4:7], s24 offen offset:1024 sc1
    buffer_load_dwordx4 v[200:203], v2, s[4:7], s24 offen offset:2048 sc1
    buffer_load_dwordx4 v[204:207], v2, s[4:7], s24 offen offset:3072 sc1
    s_add_u32 s24, s24, 4096
    buffer_load_dwordx4 v[208:211], v2, s[4:7], s24 offen offset:0 sc1
    buffer_load_dwordx4 v[212:215], v2, s[4:7], s24 offen offset:1024 sc1
    buffer_load_dwordx4 v[216:219], v2, s[4:7], s24 offen offset:2048 sc1
    buffer_load_dwordx4 v[220:223], v2, s[4:7], s24 offen offset:3072 sc1
    s_add_u32 s24, s24, 4096
    buffer_load_dwordx4 v[224:227], v2, s[4:7], s24 offen offset:0 sc1
    buffer_load_dwordx4 v[228:231], v2, s[4:7], s24 offen offset:1024 sc1
    buffer_load_dwordx4 v[232:235], v2, s[4:7], s24 offen offset:2048 sc1
    buffer_load_dwordx4 v[236:239], v2, s[4:7], s24 offen offset:3072 sc1
    s_add_u32 s24, s24, 4096
    buffer_load_dwordx4 v[240:243], v2, s[4:7], s24 offen offset:0 sc1
    buffer_load_dwordx4 v[244:247], v2, s[4:7], s24 offen offset:1024 sc1
    buffer_load_dwordx4 v[248:251], v2, s[4:7], s24 offen offset:2048 sc1
    buffer_load_dwordx4 v[252:255], v2, s[4:7], s24 offen offset:3072 sc1
    s_cmp_lg_u32 s86, 0
    s_cbranch_scc1 gs_137
    s_mov_b32 s86, 1
    s_branch gs_137_j
gs_137:
    s_waitcnt vmcnt(0)
gs_137_j:
    v_pk_add_f32 v[108:109], v[100:101], v[104:105]
    v_pk_add_f32 v[110:111], v[102:103], v[106:107]
    s_nop 1
    v_add_f32_dpp v108, v108, v108 row_ror:8 row_mask:0xf bank_mask:0xf
    v_add_f32_dpp v109, v109, v109 row_ror:8 row_mask:0xf bank_mask:0xf
    v_add_f32_dpp v110, v110, v110 row_ror:8 row_mask:0xf bank_mask:0xf
    v_add_f32_dpp v111, v111, v111 row_ror:8 row_mask:0xf bank_mask:0xf
    s_nop 1
    v_add_f32_dpp v108, v108, v108 row_ror:4 row_mask:0xf bank_mask:0xf
    v_add_f32_dpp v109, v109, v109 row_ror:4 row_mask:0xf bank_mask:0xf
    v_add_f32_dpp v110, v110, v110 row_ror:4 row_mask:0xf bank_mask:0xf
    v_add_f32_dpp v111, v111, v111 row_ror:4 row_mask:0xf bank_mask:0xf
    s_nop 1
    v_add_f32_dpp v108, v108, v108 row_ror:2 row_mask:0xf bank_mask:0xf
    v_add_f32_dpp v109, v109, v109 row_ror:2 row_mask:0xf bank_mask:0xf
    v_add_f32_dpp v110, v110, v110 row_ror:2 row_mask:0xf bank_mask:0xf
    v_add_f32_dpp v111, v111, v111 row_ror:2 row_mask:0xf bank_mask:0xf
    s_nop 1
    v_add_f32_dpp v108, v108, v108 row_ror:1 row_mask:0xf bank_mask:0xf
    v_add_f32_dpp v109, v109, v109 row_ror:1 row_mask:0xf bank_mask:0xf
    v_add_f32_dpp v110, v110, v110 row_ror:1 row_mask:0xf bank_mask:0xf
    v_add_f32_dpp v111, v111, v111 row_ror:1 row_mask:0xf bank_mask:0xf
    v_cvt_pk_bf16_f32 v108, v108, v109
    v_cvt_pk_bf16_f32 v109, v110, v111
    s_mov_b32 s24, 0x00110011
    s_mov_b32 s25, 0x00110011
    v_cndmask_b32_e64 v108, 0, v108, s[24:25]
    v_cndmask_b32_e64 v109, 0, v109, s[24:25]
    v_and_b32 v5, 15, v1
    v_lshlrev_b32 v5, 4, v5
    v_bfe_u32 v6, v1, 4, 1
    v_lshl_add_u32 v5, v6, 9, v5
    v_lshrrev_b32 v6, 5, v1
    v_lshl_add_u32 v5, v6, 3, v5
    s_lshl_b32 s24, s18, 11
    s_add_u32 s24, s24, 135168
    v_add_u32 v5, s24, v5
    ds_write_b64 v5, v[108:109] offset:256
    v_and_b32 v5, 7, v1
    v_lshlrev_b32 v5, 5, v5
    v_bfe_u32 v6, v1, 3, 1
    v_lshl_add_u32 v5, v6, 9, v5
    v_bfe_u32 v6, v1, 4, 1
    v_lshl_add_u32 v5, v6, 3, v5
    v_add_u32 v5, s24, v5
    v_mov_b32 v7, 0
    v_mov_b32 v48, 0x00003f80
    v_mov_b32 v49, 0x3f800000
    v_mov_b32 v40, 0
    v_mov_b32 v41, 0
    v_mov_b32 v42, 0
    v_mov_b32 v43, 0
    v_mov_b32 v44, 0
    v_mov_b32 v45, 0
    v_mov_b32 v46, 0
    v_mov_b32 v47, 0
    s_waitcnt vmcnt(15)
    v_max3_u32 v7, v7, v192, v193
    v_max3_u32 v7, v7, v194, v195
    v_dot2_f32_bf16 v40, v192, v48, v40
    v_dot2_f32_bf16 v41, v192, v49, v41
    v_dot2_f32_bf16 v42, v193, v48, v42
    v_dot2_f32_bf16 v43, v193, v49, v43
    v_dot2_f32_bf16 v44, v194, v48, v44
    v_dot2_f32_bf16 v45, v194, v49, v45
    v_dot2_f32_bf16 v46, v195, v48, v46
    v_dot2_f32_bf16 v47, v195, v49, v47
    s_waitcnt vmcnt(14)
    v_max3_u32 v7, v7, v196, v197
    v_max3_u32 v7, v7, v198, v199
    v_dot2_f32_bf16 v40, v196, v48, v40
    v_dot2_f32_bf16 v41, v196, v49, v41
    v_dot2_f32_bf16 v42, v197, v48, v42
    v_dot2_f32_bf16 v43, v197, v49, v43
    v_dot2_f32_bf16 v44, v198, v48, v44
    v_dot2_f32_bf16 v45, v198, v49, v45
    v_dot2_f32_bf16 v46, v199, v48, v46
    v_dot2_f32_bf16 v47, v199, v49, v47
    s_waitcnt vmcnt(13)
    v_max3_u32 v7, v7, v200, v201
    v_max3_u32 v7, v7, v202, v203
    v_dot2_f32_bf16 v40, v200, v48, v40
    v_dot2_f32_bf16 v41, v200, v49, v41
    v_dot2_f32_bf16 v42, v201, v48, v42
    v_dot2_f32_bf16 v43, v201, v49, v43
    v_dot2_f32_bf16 v44, v202, v48, v44
    v_dot2_f32_bf16 v45, v202, v49, v45
    v_dot2_f32_bf16 v46, v203, v48, v46
    v_dot2_f32_bf16 v47, v203, v49, v47
    s_waitcnt vmcnt(12)
    v_max3_u32 v7, v7, v204, v205
    v_max3_u32 v7, v7, v206, v207
    v_dot2_f32_bf16 v40, v204, v48, v40
    v_dot2_f32_bf16 v41, v204, v49, v41
    v_dot2_f32_bf16 v42, v205, v48, v42
    v_dot2_f32_bf16 v43, v205, v49, v43
    v_dot2_f32_bf16 v44, v206, v48, v44
    v_dot2_f32_bf16 v45, v206, v49, v45
    v_dot2_f32_bf16 v46, v207, v48, v46
    v_dot2_f32_bf16 v47, v207, v49, v47
    s_waitcnt vmcnt(11)
    v_max3_u32 v7, v7, v208, v209
    v_max3_u32 v7, v7, v210, v211
    v_dot2_f32_bf16 v40, v208, v48, v40
    v_dot2_f32_bf16 v41, v208, v49, v41
    v_dot2_f32_bf16 v42, v209, v48, v42
    v_dot2_f32_bf16 v43, v209, v49, v43
    v_dot2_f32_bf16 v44, v210, v48, v44
    v_dot2_f32_bf16 v45, v210, v49, v45
    v_dot2_f32_bf16 v46, v211, v48, v46
    v_dot2_f32_bf16 v47, v211, v49, v47
    s_waitcnt vmcnt(10)
    v_max3_u32 v7, v7, v212, v213
    v_max3_u32 v7, v7, v214, v215
    v_dot2_f32_bf16 v40, v212, v48, v40
    v_dot2_f32_bf16 v41, v212, v49, v41
    v_dot2_f32_bf16 v42, v213, v48, v42
    v_dot2_f32_bf16 v43, v213, v49, v43
    v_dot2_f32_bf16 v44, v214, v48, v44
    v_dot2_f32_bf16 v45, v214, v49, v45
    v_dot2_f32_bf16 v46, v215, v48, v46
    v_dot2_f32_bf16 v47, v215, v49, v47
    s_waitcnt vmcnt(9)
    v_max3_u32 v7, v7, v216, v217
    v_max3_u32 v7, v7, v218, v219
    v_dot2_f32_bf16 v40, v216, v48, v40
    v_dot2_f32_bf16 v41, v216, v49, v41
    v_dot2_f32_bf16 v42, v217, v48, v42
    v_dot2_f32_bf16 v43, v217, v49, v43
    v_dot2_f32_bf16 v44, v218, v48, v44
    v_dot2_f32_bf16 v45, v218, v49, v45
    v_dot2_f32_bf16 v46, v219, v48, v46
    v_dot2_f32_bf16 v47, v219, v49, v47
    s_waitcnt vmcnt(8)
    v_max3_u32 v7, v7, v220, v221
    v_max3_u32 v7, v7, v222, v223
    v_dot2_f32_bf16 v40, v220, v48, v40
    v_dot2_f32_bf16 v41, v220, v49, v41
    v_dot2_f32_bf16 v42, v221, v48, v42
    v_dot2_f32_bf16 v43, v221, v49, v43
    v_dot2_f32_bf16 v44, v222, v48, v44
    v_dot2_f32_bf16 v45, v222, v49, v45
    v_dot2_f32_bf16 v46, v223, v48, v46
    v_dot2_f32_bf16 v47, v223, v49, v47
    s_waitcnt vmcnt(7)
    v_max3_u32 v7, v7, v224, v225
    v_max3_u32 v7, v7, v226, v227
    v_dot2_f32_bf16 v40, v224, v48, v40
    v_dot2_f32_bf16 v41, v224, v49, v41
    v_dot2_f32_bf16 v42, v225, v48, v42
    v_dot2_f32_bf16 v43, v225, v49, v43
    v_dot2_f32_bf16 v44, v226, v48, v44
    v_dot2_f32_bf16 v45, v226, v49, v45
    v_dot2_f32_bf16 v46, v227, v48, v46
    v_dot2_f32_bf16 v47, v227, v49, v47
    s_waitcnt vmcnt(6)
    v_max3_u32 v7, v7, v228, v229
    v_max3_u32 v7, v7, v230, v231
    v_dot2_f32_bf16 v40, v228, v48, v40
    v_dot2_f32_bf16 v41, v228, v49, v41
    v_dot2_f32_bf16 v42, v229, v48, v42
    v_dot2_f32_bf16 v43, v229, v49, v43
    v_dot2_f32_bf16 v44, v230, v48, v44
    v_dot2_f32_bf16 v45, v230, v49, v45
    v_dot2_f32_bf16 v46, v231, v48, v46
    v_dot2_f32_bf16 v47, v231, v49, v47
    s_waitcnt vmcnt(5)
    v_max3_u32 v7, v7, v232, v233
    v_max3_u32 v7, v7, v234, v235
    v_dot2_f32_bf16 v40, v232, v48, v40
    v_dot2_f32_bf16 v41, v232, v49, v41
    v_dot2_f32_bf16 v42, v233, v48, v42
    v_dot2_f32_bf16 v43, v233, v49, v43
    v_dot2_f32_bf16 v44, v234, v48, v44
    v_dot2_f32_bf16 v45, v234, v49, v45
    v_dot2_f32_bf16 v46, v235, v48, v46
    v_dot2_f32_bf16 v47, v235, v49, v47
    s_waitcnt vmcnt(4)
    v_max3_u32 v7, v7, v236, v237
    v_max3_u32 v7, v7, v238, v239
    v_dot2_f32_bf16 v40, v236, v48, v40
    v_dot2_f32_bf16 v41, v236, v49, v41
    v_dot2_f32_bf16 v42, v237, v48, v42
    v_dot2_f32_bf16 v43, v237, v49, v43
    v_dot2_f32_bf16 v44, v238, v48, v44
    v_dot2_f32_bf16 v45, v238, v49, v45
    v_dot2_f32_bf16 v46, v239, v48, v46
    v_dot2_f32_bf16 v47, v239, v49, v47
    s_waitcnt vmcnt(3)
    v_max3_u32 v7, v7, v240, v241
    v_max3_u32 v7, v7, v242, v243
    v_dot2_f32_bf16 v40, v240, v48, v40
    v_dot2_f32_bf16 v41, v240, v49, v41
    v_dot2_f32_bf16 v42, v241, v48, v42
    v_dot2_f32_bf16 v43, v241, v49, v43
    v_dot2_f32_bf16 v44, v242, v48, v44
    v_dot2_f32_bf16 v45, v242, v49, v45
    v_dot2_f32_bf16 v46, v243, v48, v46
    v_dot2_f32_bf16 v47, v243, v49, v47
    s_waitcnt vmcnt(2)
    v_max3_u32 v7, v7, v244, v245
    v_max3_u32 v7, v7, v246, v247
    v_dot2_f32_bf16 v40, v244, v48, v40
    v_dot2_f32_bf16 v41, v244, v49, v41
    v_dot2_f32_bf16 v42, v245, v48, v42
    v_dot2_f32_bf16 v43, v245, v49, v43
    v_dot2_f32_bf16 v44, v246, v48, v44
    v_dot2_f32_bf16 v45, v246, v49, v45
    v_dot2_f32_bf16 v46, v247, v48, v46
    v_dot2_f32_bf16 v47, v247, v49, v47
    s_waitcnt vmcnt(1)
    v_max3_u32 v7, v7, v248, v249
    v_max3_u32 v7, v7, v250, v251
    v_dot2_f32_bf16 v40, v248, v48, v40
    v_dot2_f32_bf16 v41, v248, v49, v41
    v_dot2_f32_bf16 v42, v249, v48, v42
    v_dot2_f32_bf16 v43, v249, v49, v43
    v_dot2_f32_bf16 v44, v250, v48, v44
    v_dot2_f32_bf16 v45, v250, v49, v45
    v_dot2_f32_bf16 v46, v251, v48, v46
    v_dot2_f32_bf16 v47, v251, v49, v47
    s_waitcnt vmcnt(0)
    v_max3_u32 v7, v7, v252, v253
    v_max3_u32 v7, v7, v254, v255
    v_dot2_f32_bf16 v40, v252, v48, v40
    v_dot2_f32_bf16 v41, v252, v49, v41
    v_dot2_f32_bf16 v42, v253, v48, v42
    v_dot2_f32_bf16 v43, v253, v49, v43
    v_dot2_f32_bf16 v44, v254, v48, v44
    v_dot2_f32_bf16 v45, v254, v49, v45
    v_dot2_f32_bf16 v46, v255, v48, v46
    v_dot2_f32_bf16 v47, v255, v49, v47
    v_cmp_eq_u32 vcc, -1, v7
    s_cbranch_vccnz gat_136
    s_nop 1
    v_mov_b32 v56, v40
    v_mov_b32 v57, v41
    v_mov_b32 v58, v42
    v_mov_b32 v59, v43
    v_mov_b32 v60, v44
    v_mov_b32 v61, v45
    v_mov_b32 v62, v46
    v_mov_b32 v63, v47
    s_nop 1
    v_permlane32_swap_b32 v40, v56
    v_permlane32_swap_b32 v41, v57
    v_permlane32_swap_b32 v42, v58
    v_permlane32_swap_b32 v43, v59
    v_permlane32_swap_b32 v44, v60
    v_permlane32_swap_b32 v45, v61
    v_permlane32_swap_b32 v46, v62
    v_permlane32_swap_b32 v47, v63
    s_nop 1
    v_pk_add_f32 v[40:41], v[40:41], v[56:57]
    v_pk_add_f32 v[42:43], v[42:43], v[58:59]
    v_pk_add_f32 v[44:45], v[44:45], v[60:61]
    v_pk_add_f32 v[46:47], v[46:47], v[62:63]
    v_cvt_pk_bf16_f32 v40, v40, v41
    v_cvt_pk_bf16_f32 v41, v42, v43
    v_cvt_pk_bf16_f32 v42, v44, v45
    v_cvt_pk_bf16_f32 v43, v46, v47
    ds_write_b64 v5, v[40:41]
    ds_write_b64 v5, v[42:43] offset:16
ie_129:
    s_waitcnt lgkmcnt(0)
    s_barrier
    s_lshl_b32 s24, s20, 1
    s_add_u32 s24, s24, s21
    s_lshl_b32 s24, s24, 11
    s_add_u32 s24, s24, 135168
    v_add_u32 v6, s24, v2
    ds_read_b128 v[28:31], v6
    s_waitcnt lgkmcnt(0)
    v_mfma_f32_32x32x16_bf16 v[56:71], v[28:31], v[88:91], 0
    s_nop 11
    v_add_f32 v8, 0x358637bd, v64
    v_rcp_f32 v8, v8
    s_nop 0
    v_mul_f32 v56, v56, v8
    v_mul_f32 v57, v57, v8
    v_mul_f32 v58, v58, v8
    v_mul_f32 v59, v59, v8
    v_mul_f32 v60, v60, v8
    v_mul_f32 v61, v61, v8
    v_mul_f32 v62, v62, v8
    v_mul_f32 v63, v63, v8
    v_cvt_pk_bf16_f32 v32, v56, v57
    v_cvt_pk_bf16_f32 v33, v58, v59
    v_cvt_pk_bf16_f32 v34, v60, v61
    v_cvt_pk_bf16_f32 v35, v62, v63
    s_add_u32 s24, s22, s73
    s_cmp_eq_u32 s62, 1
    s_cbranch_scc1 fs_138
    buffer_store_dwordx4 v[32:35], v2, s[4:7], s24 offen sc1
    s_branch fs_139
fs_138:
    buffer_store_dwordx4 v[32:35], v2, s[4:7], s24 offen
fs_139:
    s_add_u32 s38, s38, 1
    s_lshl_b32 s24, s38, 4
    s_add_u32 s24, s24, s32
    s_add_u32 s24, s24, s91
    v_mov_b32 v6, s24
    v_mov_b32 v7, s33
    s_waitcnt vmcnt(0) lgkmcnt(0)
    s_mov_b64 exec, 1
    s_cmp_eq_u32 s62, 1
    s_cbranch_scc1 fs_140
    buffer_store_dwordx2 v[6:7], v96, s[4:7], 0 offen sc1
    s_branch fs_141
fs_140:
    buffer_store_dwordx2 v[6:7], v96, s[4:7], 0 offen
fs_141:
    s_mov_b64 exec, -1
    s_cmp_lg_u32 s21, 0
    s_cbranch_scc1 role_142
    ds_read_b64_tr_b16 v[160:161], v95 offset:0
    ds_read_b64_tr_b16 v[162:163], v95 offset:512
    ds_read_b64_tr_b16 v[164:165], v95 offset:1024
    ds_read_b64_tr_b16 v[166:167], v95 offset:1536
    ds_read_b64_tr_b16 v[168:169], v95 offset:2048
    ds_read_b64_tr_b16 v[170:171], v95 offset:2560
    ds_read_b64_tr_b16 v[172:173], v95 offset:3072
    ds_read_b64_tr_b16 v[174:175], v95 offset:3584
    ds_read_b64_tr_b16 v[176:177], v95 offset:4096
    ds_read_b64_tr_b16 v[178:179], v95 offset:4608
    ds_read_b64_tr_b16 v[180:181], v95 offset:5120
    ds_read_b64_tr_b16 v[182:183], v95 offset:5632
    ds_read_b64_tr_b16 v[184:185], v95 offset:6144
    ds_read_b64_tr_b16 v[186:187], v95 offset:6656
    ds_read_b64_tr_b16 v[188:189], v95 offset:7168
    ds_read_b64_tr_b16 v[190:191], v95 offset:7680
    s_waitcnt lgkmcnt(0)
role_142:
    s_branch L_layer
L_final:
    s_mov_b32 s12, s56
    s_mov_b32 s13, s57
    s_mov_b32 s14, 0x200000
    s_mov_b32 s15, 0x00020000
    s_nop 1
    v_permlane32_swap_b32 v20, v22
    v_permlane32_swap_b32 v21, v23
    v_and_b32 v5, 31, v1
    v_lshlrev_b32 v5, 10, v5
    v_lshrrev_b32 v6, 5, v1
    v_lshl_add_u32 v5, v6, 4, v5
    s_lshl_b32 s25, s19, 15
    s_add_u32 s24, s81, s25
    s_lshl_b32 s25, s17, 7
    s_add_u32 s24, s24, s25
    s_lshl_b32 s25, s20, 6
    s_add_u32 s24, s24, s25
    s_lshl_b32 s25, s21, 5
    s_add_u32 s24, s24, s25
    buffer_store_dwordx4 v[20:23], v5, s[12:15], s24 offen
    s_waitcnt vmcnt(0)
L_end:
    s_endpgm
.section .rodata,"a"
.p2align 6
.amdhsa_kernel interleave_layers__linear_attn_block__grouped_kv_mqa__prompt_kernel
  .amdhsa_next_free_vgpr 256
  .amdhsa_next_free_sgpr 96
  .amdhsa_accum_offset 256
  .amdhsa_group_segment_fixed_size 0
  .amdhsa_kernarg_size 88
  .amdhsa_user_sgpr_count 2
  .amdhsa_user_sgpr_kernarg_segment_ptr 1
  .amdhsa_system_sgpr_workgroup_id_x 1
  .amdhsa_float_denorm_mode_32 3
.end_amdhsa_kernel
```
